```python
import torch

def _softmax(x, axis=-1):
    return torch.softmax(x, dim=axis)
def _gelu(x):
    return torch.nn.functional.gelu(x, approximate="tanh")
def _silu(x):
    return torch.nn.functional.silu(x)
def _sigmoid(x):
    return torch.sigmoid(x)
def _layernorm(x, axis=-1, eps=1e-5):
    m = x.mean(dim=axis, keepdim=True)
    v = x.var(dim=axis, keepdim=True, unbiased=False)
    return (x - m) / torch.sqrt(v + eps)
def _scatter_add(tgt, idx, src, axis=0):
    return tgt.clone().index_add_(axis, idx, src)
def _segment_sum(src, seg, n):
    out = torch.zeros((n,) + src.shape[1:], dtype=src.dtype)
    return out.index_add_(0, seg, src)
def _pad(x, pw):
    flat = tuple(v for pair in reversed(pw) for v in pair)
    return torch.nn.functional.pad(x, flat)

kernel_name = 'sequential_preLN__mha_block__glu_gated_reglu__prompt'

def setup_inputs():

    _w = (lambda a: (lambda t: t.to(torch.bfloat16) if t.is_floating_point() else t)(torch.as_tensor(a)))
    def _A_setup():
        B, S, D, H = 1, 2048, 448, 16
        return {
            "x": _w((lambda *s: torch.randn(*s, dtype=torch.bfloat16) * 0.05)(B, S, D)),
            "wqkv": _w((lambda *s: torch.randn(*s, dtype=torch.bfloat16) * 0.05)(D, 3 * D)),
            "wo": _w((lambda *s: torch.randn(*s, dtype=torch.bfloat16) * 0.05)(D, D)),
        }
    _A_in = _A_setup()

    def _B_setup():
        B, S, D, F = 1, 2048, 448, 1792
        return {
            "x": _w((lambda *s: torch.randn(*s, dtype=torch.bfloat16) * 0.05)(B, S, D)),
            "W_gate": _w((lambda *s: torch.randn(*s, dtype=torch.bfloat16) * 0.4)(D, F) * (2.0 / D) ** 0.5),
            "W_up": _w((lambda *s: torch.randn(*s, dtype=torch.bfloat16) * 0.4)(D, F) * (2.0 / D) ** 0.5),
            "W_down": _w((lambda *s: torch.randn(*s, dtype=torch.bfloat16) * 0.4)(F, D) * (1.0 / F) ** 0.5),
        }
    _B_in = _B_setup()

    return {
        "A_x": _A_in["x"],
        "A_wqkv": _A_in["wqkv"],
        "A_wo": _A_in["wo"],
        "B_x": _B_in["x"],
        "B_W_gate": _B_in["W_gate"],
        "B_W_up": _B_in["W_up"],
        "B_W_down": _B_in["W_down"],
    }

def reference(A_x, A_wqkv, A_wo, B_x, B_W_gate, B_W_up, B_W_down):
    def _A_ref(x, wqkv, wo):
        B, S, D = x.shape
        H = 16
        Dh = D // H
        qkv = (lambda x, *d: x.permute(*d))((x @ wqkv).reshape(B, S, 3, H, Dh), 2, 0, 3, 1, 4)
        q, k, v = qkv[0], qkv[1], qkv[2]
        scores = torch.einsum("bhqd,bhkd->bhqk", q, k) * (Dh ** -0.5)
        p = _softmax(scores, axis=-1)
        o = torch.einsum("bhqk,bhkd->bhqd", p, v)
        return (lambda x, *d: x.permute(*d))(o, 0, 2, 1, 3).reshape(B, S, D) @ wo

    def _B_ref(x, W_gate, W_up, W_down):
        gate = torch.einsum("bsd,df->bsf", x, W_gate)
        up = torch.einsum("bsd,df->bsf", x, W_up)
        gate = gate * (lambda x, dt: x.to(dt))(gate > 0, gate.dtype)
        h = gate * up
        return torch.einsum("bsf,fd->bsd", h, W_down)

    x = A_x
    h = x + _A_ref(_layernorm(x, axis=-1), A_wqkv, A_wo)
    h2 = h + _B_ref(_layernorm(h, axis=-1), B_W_gate, B_W_up, B_W_down)
    return h2
```

```asm
; @launch kernel=sequential_preLN__mha_block__glu_gated_reglu__prompt_kernel grid=(256,1,1) block=(512,1,1) lds=163840
.amdgcn_target "amdgcn-amd-amdhsa--gfx950"
.text
.globl sequential_preLN__mha_block__glu_gated_reglu__prompt_kernel
.p2align 8
.type sequential_preLN__mha_block__glu_gated_reglu__prompt_kernel,@function
sequential_preLN__mha_block__glu_gated_reglu__prompt_kernel:
    s_cmp_lt_u32 s2, 256
    s_cbranch_scc1 L_k_go_1
    s_endpgm
L_k_go_1:
    s_load_dwordx16 s[40:55], s[0:1], 0
    s_load_dwordx4 s[56:59], s[0:1], 64
    v_and_b32 v1, 63, v0
    v_lshrrev_b32 v2, 6, v0
    s_and_b32 s29, s2, 7
    v_readfirstlane_b32 s28, v2
    s_lshr_b32 s30, s2, 3
    s_lshr_b32 s31, s30, 4
    s_lshl_b32 s29, s29, 1
    s_add_u32 s29, s29, s31
    s_and_b32 s30, s30, 15
    s_and_b32 s35, s28, 3
    v_lshlrev_b32 v2, 4, v1
    s_mov_b32 s25, 0
    s_cmp_lt_u32 s28, 4
    s_cbranch_scc1 L_k_main_2
    s_setprio 0
    v_lshrrev_b32 v3, 2, v1
    v_mul_u32_u24 v42, 2688, v3
    v_and_b32 v3, 3, v1
    v_lshl_add_u32 v42, v3, 4, v42
    v_lshrrev_b32 v3, 3, v1
    v_mul_u32_u24 v40, 896, v3
    v_lshrrev_b32 v3, 4, v1
    v_and_b32 v4, 7, v1
    v_xor_b32 v3, v3, v4
    v_xor_b32 v4, 4, v3
    v_lshl_add_u32 v41, v4, 4, v40
    v_lshl_add_u32 v40, v3, 4, v40
    s_mul_i32 s62, s30, 114688
    s_mul_i32 s34, s35, 28672
    s_add_u32 s62, s62, s34
    s_mul_i32 s63, s29, 56
    s_mul_i32 s34, s35, 43008
    s_add_u32 s63, s63, s34
    s_mul_i32 s64, s35, 4096
    s_mul_i32 s65, s35, 1024
    s_waitcnt lgkmcnt(0)
    s_add_u32 s4, s58, 18874368
    s_addc_u32 s5, s59, 0
    s_load_dword s24, s[4:5], 0
    s_mov_b32 s20, s58
    s_mov_b32 s21, s59
    s_mov_b32 s22, 20971520
    s_mov_b32 s23, 0x20000
    s_mov_b32 s8, s40
    s_mov_b32 s9, s41
    s_mov_b32 s10, 1835008
    s_mov_b32 s11, 0x20000
    s_mov_b32 s12, s42
    s_mov_b32 s13, s43
    s_mov_b32 s14, 1204224
    s_mov_b32 s15, 0x20000
    s_add_u32 m0, s65, 16384
    s_add_u32 s31, s63, 896
    buffer_load_dwordx4 v42, s[12:15], s31 offen  lds
    s_add_u32 m0, s65, 20480
    s_add_u32 s31, s63, 1792
    buffer_load_dwordx4 v42, s[12:15], s31 offen  lds
    s_add_u32 m0, s64, 0
    s_add_u32 s31, s62, 0
    buffer_load_dwordx4 v40, s[8:11], s31 offen  lds
    s_add_u32 m0, s64, 1024
    s_add_u32 s31, s62, 7168
    buffer_load_dwordx4 v41, s[8:11], s31 offen  lds
    s_add_u32 m0, s64, 2048
    s_add_u32 s31, s62, 14336
    buffer_load_dwordx4 v40, s[8:11], s31 offen  lds
    s_add_u32 m0, s64, 3072
    s_add_u32 s31, s62, 21504
    buffer_load_dwordx4 v41, s[8:11], s31 offen  lds
    s_add_u32 m0, s65, 40960
    s_add_u32 s31, s63, 172928
    buffer_load_dwordx4 v42, s[12:15], s31 offen  lds
    s_add_u32 m0, s65, 45056
    s_add_u32 s31, s63, 173824
    buffer_load_dwordx4 v42, s[12:15], s31 offen  lds
    s_add_u32 m0, s64, 24576
    s_add_u32 s31, s62, 128
    buffer_load_dwordx4 v40, s[8:11], s31 offen  lds
    s_add_u32 m0, s64, 25600
    s_add_u32 s31, s62, 7296
    buffer_load_dwordx4 v41, s[8:11], s31 offen  lds
    s_add_u32 m0, s64, 26624
    s_add_u32 s31, s62, 14464
    buffer_load_dwordx4 v40, s[8:11], s31 offen  lds
    s_add_u32 m0, s64, 27648
    s_add_u32 s31, s62, 21632
    buffer_load_dwordx4 v41, s[8:11], s31 offen  lds
    s_bitcmp1_b32 s35, 0
    s_cselect_b32 s16, s50, s48
    s_cselect_b32 s17, s51, s49
    s_cselect_b32 s37, 14496, 0
    s_mov_b32 s18, 1605632
    s_mov_b32 s19, 0x20000
    s_lshr_b32 s31, s35, 1
    s_mul_i32 s32, s31, 7168
    s_add_u32 s37, s37, s32
    s_mul_i32 s36, s31, 114688
    s_mul_i32 s34, s30, 224
    s_add_u32 s36, s36, s34
    s_and_b32 s31, s30, 1
    s_lshl_b32 s32, s31, 5
    s_mul_i32 s31, s31, 192
    s_sub_u32 s31, 192, s31
    v_add_u32 v3, 0, v1
    v_mul_u32_u24 v8, 1171, v3
    v_lshrrev_b32 v8, 16, v8
    v_mul_u32_u24 v4, 56, v8
    v_sub_u32 v3, v3, v4
    v_mul_u32_u24 v8, 14336, v8
    v_cmp_gt_u32 vcc, 48, v3
    v_mul_u32_u24 v4, 5462, v3
    v_lshrrev_b32 v4, 16, v4
    v_mul_u32_u24 v4, 3392, v4
    v_lshl_add_u32 v4, v3, 4, v4
    v_add_u32 v4, s32, v4
    v_bfe_u32 v5, v3, 1, 2
    v_mul_u32_u24 v5, 3584, v5
    v_and_b32 v3, 1, v3
    v_lshl_add_u32 v5, v3, 4, v5
    v_add_u32 v5, s31, v5
    v_cndmask_b32 v3, v5, v4, vcc
    v_add_u32 v8, v8, v3
    v_add_u32 v3, 64, v1
    v_mul_u32_u24 v9, 1171, v3
    v_lshrrev_b32 v9, 16, v9
    v_mul_u32_u24 v4, 56, v9
    v_sub_u32 v3, v3, v4
    v_mul_u32_u24 v9, 14336, v9
    v_cmp_gt_u32 vcc, 48, v3
    v_mul_u32_u24 v4, 5462, v3
    v_lshrrev_b32 v4, 16, v4
    v_mul_u32_u24 v4, 3392, v4
    v_lshl_add_u32 v4, v3, 4, v4
    v_add_u32 v4, s32, v4
    v_bfe_u32 v5, v3, 1, 2
    v_mul_u32_u24 v5, 3584, v5
    v_and_b32 v3, 1, v3
    v_lshl_add_u32 v5, v3, 4, v5
    v_add_u32 v5, s31, v5
    v_cndmask_b32 v3, v5, v4, vcc
    v_add_u32 v9, v9, v3
    v_add_u32 v3, 128, v1
    v_mul_u32_u24 v10, 1171, v3
    v_lshrrev_b32 v10, 16, v10
    v_mul_u32_u24 v4, 56, v10
    v_sub_u32 v3, v3, v4
    v_mul_u32_u24 v10, 14336, v10
    v_cmp_gt_u32 vcc, 48, v3
    v_mul_u32_u24 v4, 5462, v3
    v_lshrrev_b32 v4, 16, v4
    v_mul_u32_u24 v4, 3392, v4
    v_lshl_add_u32 v4, v3, 4, v4
    v_add_u32 v4, s32, v4
    v_bfe_u32 v5, v3, 1, 2
    v_mul_u32_u24 v5, 3584, v5
    v_and_b32 v3, 1, v3
    v_lshl_add_u32 v5, v3, 4, v5
    v_add_u32 v5, s31, v5
    v_cndmask_b32 v3, v5, v4, vcc
    v_add_u32 v10, v10, v3
    v_add_u32 v3, 192, v1
    v_mul_u32_u24 v11, 1171, v3
    v_lshrrev_b32 v11, 16, v11
    v_mul_u32_u24 v4, 56, v11
    v_sub_u32 v3, v3, v4
    v_mul_u32_u24 v11, 14336, v11
    v_cmp_gt_u32 vcc, 48, v3
    v_mul_u32_u24 v4, 5462, v3
    v_lshrrev_b32 v4, 16, v4
    v_mul_u32_u24 v4, 3392, v4
    v_lshl_add_u32 v4, v3, 4, v4
    v_add_u32 v4, s32, v4
    v_bfe_u32 v5, v3, 1, 2
    v_mul_u32_u24 v5, 3584, v5
    v_and_b32 v3, 1, v3
    v_lshl_add_u32 v5, v3, 4, v5
    v_add_u32 v5, s31, v5
    v_cndmask_b32 v3, v5, v4, vcc
    v_add_u32 v11, v11, v3
    v_add_u32 v3, 256, v1
    v_mul_u32_u24 v12, 1171, v3
    v_lshrrev_b32 v12, 16, v12
    v_mul_u32_u24 v4, 56, v12
    v_sub_u32 v3, v3, v4
    v_mul_u32_u24 v12, 14336, v12
    v_cmp_gt_u32 vcc, 48, v3
    v_mul_u32_u24 v4, 5462, v3
    v_lshrrev_b32 v4, 16, v4
    v_mul_u32_u24 v4, 3392, v4
    v_lshl_add_u32 v4, v3, 4, v4
    v_add_u32 v4, s32, v4
    v_bfe_u32 v5, v3, 1, 2
    v_mul_u32_u24 v5, 3584, v5
    v_and_b32 v3, 1, v3
    v_lshl_add_u32 v5, v3, 4, v5
    v_add_u32 v5, s31, v5
    v_cndmask_b32 v3, v5, v4, vcc
    v_add_u32 v12, v12, v3
    v_add_u32 v3, 320, v1
    v_mul_u32_u24 v13, 1171, v3
    v_lshrrev_b32 v13, 16, v13
    v_mul_u32_u24 v4, 56, v13
    v_sub_u32 v3, v3, v4
    v_mul_u32_u24 v13, 14336, v13
    v_cmp_gt_u32 vcc, 48, v3
    v_mul_u32_u24 v4, 5462, v3
    v_lshrrev_b32 v4, 16, v4
    v_mul_u32_u24 v4, 3392, v4
    v_lshl_add_u32 v4, v3, 4, v4
    v_add_u32 v4, s32, v4
    v_bfe_u32 v5, v3, 1, 2
    v_mul_u32_u24 v5, 3584, v5
    v_and_b32 v3, 1, v3
    v_lshl_add_u32 v5, v3, 4, v5
    v_add_u32 v5, s31, v5
    v_cndmask_b32 v3, v5, v4, vcc
    v_add_u32 v13, v13, v3
    v_add_u32 v3, 384, v1
    v_mul_u32_u24 v14, 1171, v3
    v_lshrrev_b32 v14, 16, v14
    v_mul_u32_u24 v4, 56, v14
    v_sub_u32 v3, v3, v4
    v_mul_u32_u24 v14, 14336, v14
    v_cmp_gt_u32 vcc, 48, v3
    v_mul_u32_u24 v4, 5462, v3
    v_lshrrev_b32 v4, 16, v4
    v_mul_u32_u24 v4, 3392, v4
    v_lshl_add_u32 v4, v3, 4, v4
    v_add_u32 v4, s32, v4
    v_bfe_u32 v5, v3, 1, 2
    v_mul_u32_u24 v5, 3584, v5
    v_and_b32 v3, 1, v3
    v_lshl_add_u32 v5, v3, 4, v5
    v_add_u32 v5, s31, v5
    v_cndmask_b32 v3, v5, v4, vcc
    v_add_u32 v14, v14, v3
    s_and_b32 s60, s30, 3
    s_lshr_b32 s61, s30, 2
    s_lshl_b32 s31, s29, 2
    s_add_u32 s61, s61, s31
    v_lshrrev_b32 v3, 2, v1
    v_mul_u32_u24 v15, 896, v3
    v_and_b32 v3, 3, v1
    v_lshl_add_u32 v15, v3, 4, v15
    s_mul_i32 s38, s60, 224
    s_and_b32 s38, s38, -64
    s_lshl_b32 s31, s35, 6
    s_add_u32 s38, s38, s31
    v_bfe_u32 v3, v1, 2, 2
    v_lshrrev_b32 v16, 5, v1
    v_lshl_add_u32 v3, v16, 2, v3
    v_mul_u32_u24 v16, 64, v3
    v_bfe_u32 v3, v1, 4, 1
    v_mul_u32_u24 v3, 32, v3
    v_add_u32 v16, v16, v3
    v_and_b32 v3, 3, v1
    v_lshl_add_u32 v16, v3, 3, v16
    v_add_u32 v16, s37, v16
    v_lshlrev_b32 v17, 2, v1
    v_and_b32 v3, 31, v1
    v_lshl_add_u32 v18, v3, 6, s37
    v_lshrrev_b32 v3, 5, v1
    v_lshl_add_u32 v18, v3, 3, v18
    s_lshr_b32 s3, s30, 1
    s_mul_i32 s27, s35, 401408
    s_mul_i32 s34, s3, 128
    s_add_u32 s27, s27, s34
    v_lshrrev_b32 v3, 3, v1
    v_mul_u32_u24 v5, 896, v3
    v_bfe_u32 v3, v1, 4, 1
    v_lshlrev_b32 v3, 2, v3
    v_and_b32 v4, 7, v1
    v_xor_b32 v3, v3, v4
    v_lshl_add_u32 v5, v3, 4, v5
    v_bfe_u32 v3, v1, 2, 2
    v_lshrrev_b32 v6, 5, v1
    v_lshl_add_u32 v3, v6, 2, v3
    v_mul_u32_u24 v6, 128, v3
    v_bfe_u32 v3, v1, 4, 1
    v_mul_u32_u24 v3, 32, v3
    v_add_u32 v6, v6, v3
    v_and_b32 v3, 3, v1
    v_lshl_add_u32 v6, v3, 3, v6
    v_lshrrev_b32 v3, 3, v1
    v_xor_b32 v3, s35, v3
    v_and_b32 v3, 1, v3
    v_lshl_add_u32 v6, v3, 6, v6
    v_xor_b32 v7, 64, v6
    v_add_u32 v22, s37, v6
    v_add_u32 v23, s37, v7
    s_mul_i32 s6, s29, 262144
    s_mul_i32 s34, s35, 4096
    s_add_u32 s6, s6, s34
    s_add_u32 s6, s6, 2097152
    s_mul_i32 s7, s35, 16384
    s_add_u32 s7, s7, 86528
    v_bfe_u32 v3, v1, 2, 2
    v_lshrrev_b32 v44, 5, v1
    v_lshl_add_u32 v3, v44, 3, v3
    v_mul_u32_u24 v44, 64, v3
    v_bfe_u32 v3, v1, 4, 1
    v_mul_u32_u24 v3, 32, v3
    v_add_u32 v44, v44, v3
    v_and_b32 v3, 3, v1
    v_lshl_add_u32 v44, v3, 3, v44
    v_add_u32 v44, s65, v44
    v_add_u32 v45, 49152, v44
    v_mov_b32 v4, 0x3f803f80
    v_lshrrev_b32 v3, 2, v1
    v_xor_b32 v3, v3, v1
    v_and_b32 v3, 4, v3
    v_cmp_eq_u32 vcc, 0, v3
    s_nop 1
    v_cndmask_b32 v48, 0, v4, vcc
    v_cndmask_b32 v49, 0, v4, vcc
    v_cndmask_b32 v50, 0, v4, vcc
    v_cndmask_b32 v51, 0, v4, vcc
    s_waitcnt lgkmcnt(0)
    s_mul_i32 s24, s24, 0x9E3779B1
    s_add_u32 s24, s24, 0x7F4A7C15
    s_waitcnt vmcnt(6)
    s_barrier
    ds_read_b64_tr_b16 v[72:73], v44 offset:16384
    ds_read_b64_tr_b16 v[74:75], v44 offset:16640
    ds_read_b64_tr_b16 v[76:77], v44 offset:20480
    ds_read_b64_tr_b16 v[78:79], v44 offset:20736
    s_add_u32 m0, s65, 65536
    s_add_u32 s31, s63, 344960
    buffer_load_dwordx4 v42, s[12:15], s31 offen  lds
    s_add_u32 m0, s65, 69632
    s_add_u32 s31, s63, 345856
    buffer_load_dwordx4 v42, s[12:15], s31 offen  lds
    s_add_u32 m0, s64, 49152
    s_add_u32 s31, s62, 256
    buffer_load_dwordx4 v40, s[8:11], s31 offen  lds
    s_add_u32 m0, s64, 50176
    s_add_u32 s31, s62, 7424
    buffer_load_dwordx4 v41, s[8:11], s31 offen  lds
    s_add_u32 m0, s64, 51200
    s_add_u32 s31, s62, 14592
    buffer_load_dwordx4 v40, s[8:11], s31 offen  lds
    s_add_u32 m0, s64, 52224
    s_add_u32 s31, s62, 21760
    buffer_load_dwordx4 v41, s[8:11], s31 offen  lds
    s_waitcnt lgkmcnt(0)
    v_mfma_f32_16x16x32_bf16 v[52:55], v[48:51], v[72:75], 0
    v_mfma_f32_16x16x32_bf16 v[56:59], v[48:51], v[76:79], 0
    v_add_u32 v44, 24576, v44
    s_waitcnt vmcnt(6)
    s_barrier
    ds_read_b64_tr_b16 v[72:73], v44 offset:16384
    ds_read_b64_tr_b16 v[74:75], v44 offset:16640
    ds_read_b64_tr_b16 v[76:77], v44 offset:20480
    ds_read_b64_tr_b16 v[78:79], v44 offset:20736
    s_add_u32 m0, s65, 90112
    s_add_u32 s31, s63, 516992
    buffer_load_dwordx4 v42, s[12:15], s31 offen  lds
    s_add_u32 m0, s65, 94208
    s_add_u32 s31, s63, 517888
    buffer_load_dwordx4 v42, s[12:15], s31 offen  lds
    s_add_u32 m0, s64, 73728
    s_add_u32 s31, s62, 384
    buffer_load_dwordx4 v40, s[8:11], s31 offen  lds
    s_add_u32 m0, s64, 74752
    s_add_u32 s31, s62, 7552
    buffer_load_dwordx4 v41, s[8:11], s31 offen  lds
    s_add_u32 m0, s64, 75776
    s_add_u32 s31, s62, 14720
    buffer_load_dwordx4 v40, s[8:11], s31 offen  lds
    s_add_u32 m0, s64, 76800
    s_add_u32 s31, s62, 21888
    buffer_load_dwordx4 v41, s[8:11], s31 offen  lds
    s_waitcnt lgkmcnt(0)
    v_mfma_f32_16x16x32_bf16 v[52:55], v[48:51], v[72:75], v[52:55]
    v_mfma_f32_16x16x32_bf16 v[56:59], v[48:51], v[76:79], v[56:59]
    v_add_u32 v44, 24576, v44
    s_waitcnt vmcnt(6)
    s_barrier
    ds_read_b64_tr_b16 v[72:73], v44 offset:16384
    ds_read_b64_tr_b16 v[74:75], v44 offset:16640
    ds_read_b64_tr_b16 v[76:77], v44 offset:20480
    ds_read_b64_tr_b16 v[78:79], v44 offset:20736
    s_mul_i32 s32, s29, 128
    s_add_u32 s32, s32, 18878464
    s_mov_b64 exec, 0xffff
    buffer_load_dword v19, v17, s[20:23], s32 offen sc1
    s_mov_b64 exec, -1
    s_add_u32 m0, s65, 114688
    s_add_u32 s31, s63, 689024
    buffer_load_dwordx4 v42, s[12:15], s31 offen  lds
    s_add_u32 m0, s65, 118784
    s_add_u32 s31, s63, 689920
    buffer_load_dwordx4 v42, s[12:15], s31 offen  lds
    s_add_u32 m0, s64, 98304
    s_add_u32 s31, s62, 512
    buffer_load_dwordx4 v40, s[8:11], s31 offen  lds
    s_add_u32 m0, s64, 99328
    s_add_u32 s31, s62, 7680
    buffer_load_dwordx4 v41, s[8:11], s31 offen  lds
    s_add_u32 m0, s64, 100352
    s_add_u32 s31, s62, 14848
    buffer_load_dwordx4 v40, s[8:11], s31 offen  lds
    s_add_u32 m0, s64, 101376
    s_add_u32 s31, s62, 22016
    buffer_load_dwordx4 v41, s[8:11], s31 offen  lds
    s_waitcnt lgkmcnt(0)
    v_mfma_f32_16x16x32_bf16 v[52:55], v[48:51], v[72:75], v[52:55]
    v_mfma_f32_16x16x32_bf16 v[56:59], v[48:51], v[76:79], v[56:59]
    v_add_u32 v44, 24576, v44
    s_waitcnt vmcnt(7)
    s_barrier
    ds_read_b64_tr_b16 v[72:73], v44 offset:16384
    ds_read_b64_tr_b16 v[74:75], v44 offset:16640
    ds_read_b64_tr_b16 v[76:77], v44 offset:20480
    ds_read_b64_tr_b16 v[78:79], v44 offset:20736
    s_add_u32 m0, s65, 16384
    s_add_u32 s31, s63, 861056
    buffer_load_dwordx4 v42, s[12:15], s31 offen  lds
    s_add_u32 m0, s65, 20480
    s_add_u32 s31, s63, 861952
    buffer_load_dwordx4 v42, s[12:15], s31 offen  lds
    s_add_u32 m0, s64, 0
    s_add_u32 s31, s62, 640
    buffer_load_dwordx4 v40, s[8:11], s31 offen  lds
    s_add_u32 m0, s64, 1024
    s_add_u32 s31, s62, 7808
    buffer_load_dwordx4 v41, s[8:11], s31 offen  lds
    s_add_u32 m0, s64, 2048
    s_add_u32 s31, s62, 14976
    buffer_load_dwordx4 v40, s[8:11], s31 offen  lds
    s_add_u32 m0, s64, 3072
    s_add_u32 s31, s62, 22144
    buffer_load_dwordx4 v41, s[8:11], s31 offen  lds
    s_waitcnt lgkmcnt(0)
    v_mfma_f32_16x16x32_bf16 v[52:55], v[48:51], v[72:75], v[52:55]
    v_mfma_f32_16x16x32_bf16 v[56:59], v[48:51], v[76:79], v[56:59]
    v_add_u32 v44, 24576, v44
    s_waitcnt vmcnt(6)
    s_barrier
    ds_read_b64_tr_b16 v[72:73], v44 offset:16384
    ds_read_b64_tr_b16 v[74:75], v44 offset:16640
    ds_read_b64_tr_b16 v[76:77], v44 offset:20480
    ds_read_b64_tr_b16 v[78:79], v44 offset:20736
    s_add_u32 m0, s65, 40960
    s_add_u32 s31, s63, 1033088
    buffer_load_dwordx4 v42, s[12:15], s31 offen  lds
    s_add_u32 m0, s65, 45056
    s_add_u32 s31, s63, 1033984
    buffer_load_dwordx4 v42, s[12:15], s31 offen  lds
    s_add_u32 m0, s64, 24576
    s_add_u32 s31, s62, 768
    buffer_load_dwordx4 v40, s[8:11], s31 offen  lds
    s_add_u32 m0, s64, 25600
    s_add_u32 s31, s62, 7936
    buffer_load_dwordx4 v41, s[8:11], s31 offen  lds
    s_add_u32 m0, s64, 26624
    s_add_u32 s31, s62, 15104
    buffer_load_dwordx4 v40, s[8:11], s31 offen  lds
    s_add_u32 m0, s64, 27648
    s_add_u32 s31, s62, 22272
    buffer_load_dwordx4 v41, s[8:11], s31 offen  lds
    s_waitcnt lgkmcnt(0)
    v_mfma_f32_16x16x32_bf16 v[52:55], v[48:51], v[72:75], v[52:55]
    v_mfma_f32_16x16x32_bf16 v[56:59], v[48:51], v[76:79], v[56:59]
    v_add_u32 v44, 4294868992, v44
    s_waitcnt vmcnt(6)
    s_barrier
    ds_read_b64_tr_b16 v[72:73], v44 offset:16384
    ds_read_b64_tr_b16 v[74:75], v44 offset:16640
    ds_read_b64_tr_b16 v[76:77], v44 offset:20480
    ds_read_b64_tr_b16 v[78:79], v44 offset:20736
    s_add_u32 m0, s65, 49152
    s_add_u32 s31, s63, 0
    buffer_load_dwordx4 v42, s[12:15], s31 offen  lds
    s_add_u32 m0, s65, 53248
    s_add_u32 s31, s63, 172032
    buffer_load_dwordx4 v42, s[12:15], s31 offen  lds
    s_add_u32 m0, s65, 57344
    s_add_u32 s31, s63, 344064
    buffer_load_dwordx4 v42, s[12:15], s31 offen  lds
    s_add_u32 m0, s65, 61440
    s_add_u32 s31, s63, 516096
    buffer_load_dwordx4 v42, s[12:15], s31 offen  lds
    s_waitcnt lgkmcnt(0)
    v_mfma_f32_16x16x32_bf16 v[52:55], v[48:51], v[72:75], v[52:55]
    v_mfma_f32_16x16x32_bf16 v[56:59], v[48:51], v[76:79], v[56:59]
    v_add_u32 v44, 24576, v44
    s_waitcnt vmcnt(4)
    s_barrier
    ds_read_b64_tr_b16 v[72:73], v44 offset:16384
    ds_read_b64_tr_b16 v[74:75], v44 offset:16640
    ds_read_b64_tr_b16 v[76:77], v44 offset:20480
    ds_read_b64_tr_b16 v[78:79], v44 offset:20736
    s_add_u32 m0, s65, 65536
    s_add_u32 s31, s63, 688128
    buffer_load_dwordx4 v42, s[12:15], s31 offen  lds
    s_add_u32 m0, s65, 69632
    s_add_u32 s31, s63, 860160
    buffer_load_dwordx4 v42, s[12:15], s31 offen  lds
    s_add_u32 m0, s65, 73728
    s_add_u32 s31, s63, 1032192
    buffer_load_dwordx4 v42, s[12:15], s31 offen  lds
    s_waitcnt lgkmcnt(0)
    v_mfma_f32_16x16x32_bf16 v[52:55], v[48:51], v[72:75], v[52:55]
    v_mfma_f32_16x16x32_bf16 v[56:59], v[48:51], v[76:79], v[56:59]
    s_mul_i32 s32, s35, 4
    s_add_u32 s32, s32, 152064
    v_add_u32 v3, s32, v2
    s_nop 4
    ds_write_b32 v3, v52
    ds_write_b32 v3, v56 offset:1024
    s_waitcnt lgkmcnt(0)
    s_barrier
    s_getreg_b32 s32, hwreg(HW_REG_XCC_ID, 0, 4)
    s_xor_b32 s32, s32, s24
    s_mov_b64 exec, 0xffff
    v_cmp_ne_u32 vcc, s32, v19
    s_mov_b64 exec, -1
    s_cbranch_vccz L_k_hok_3
    v_lshlrev_b32 v4, 2, v1
    s_mul_i32 s32, s29, 128
    s_add_u32 s32, s32, 18878464
    s_mov_b32 exec_lo, 0xffff
    s_mov_b32 exec_hi, 0
    s_mov_b32 s26, 0
L_k_poll_4:
    buffer_load_dword v3, v4, s[20:23], s32 offen sc1
    s_add_u32 s26, s26, 1
    s_cmp_gt_u32 s26, 0x40000
    s_waitcnt vmcnt(0)
    s_cbranch_scc1 L_k_pd_5
    v_xor_b32 v3, s24, v3
    v_cmp_lt_u32 vcc, 15, v3
    s_cbranch_vccnz L_k_poll_4
L_k_pd_5:
    s_getreg_b32 s32, hwreg(HW_REG_XCC_ID, 0, 4)
    v_cmp_ne_u32 vcc, s32, v3
    s_nop 1
    s_cmp_lg_u64 vcc, 0
    s_cselect_b32 s25, 1, 0
    s_mov_b64 exec, -1
L_k_hok_3:
    v_mov_b32 v3, 154880
    v_mov_b32 v4, s25
    ds_write_b32 v3, v4
    s_waitcnt vmcnt(0) lgkmcnt(0)
    s_barrier
    ds_read_b64_tr_b16 v[72:73], v45 offset:0
    ds_read_b64_tr_b16 v[74:75], v45 offset:256
    ds_read_b64_tr_b16 v[76:77], v45 offset:4096
    ds_read_b64_tr_b16 v[78:79], v45 offset:4352
    ds_read_b64_tr_b16 v[80:81], v45 offset:8192
    ds_read_b64_tr_b16 v[82:83], v45 offset:8448
    ds_read_b64_tr_b16 v[84:85], v45 offset:12288
    ds_read_b64_tr_b16 v[86:87], v45 offset:12544
    ds_read_b64_tr_b16 v[88:89], v45 offset:16384
    ds_read_b64_tr_b16 v[90:91], v45 offset:16640
    ds_read_b64_tr_b16 v[92:93], v45 offset:20480
    ds_read_b64_tr_b16 v[94:95], v45 offset:20736
    ds_read_b64_tr_b16 v[96:97], v45 offset:24576
    ds_read_b64_tr_b16 v[98:99], v45 offset:24832
    s_mul_i32 s32, s35, 4
    s_add_u32 s32, s32, 78848
    v_add_u32 v3, s32, v2
    s_waitcnt lgkmcnt(0)
    v_mfma_f32_16x16x32_bf16 v[52:55], v[48:51], v[72:75], 0
    v_mfma_f32_16x16x32_bf16 v[52:55], v[48:51], v[76:79], v[52:55]
    v_mfma_f32_16x16x32_bf16 v[52:55], v[48:51], v[80:83], v[52:55]
    v_mfma_f32_16x16x32_bf16 v[52:55], v[48:51], v[84:87], v[52:55]
    v_mfma_f32_16x16x32_bf16 v[52:55], v[48:51], v[88:91], v[52:55]
    v_mfma_f32_16x16x32_bf16 v[52:55], v[48:51], v[92:95], v[52:55]
    v_mfma_f32_16x16x32_bf16 v[52:55], v[48:51], v[96:99], v[52:55]
    s_nop 7
    ds_write_b32 v3, v52
    s_waitcnt lgkmcnt(0)
    s_barrier
    s_setprio 2
    s_mov_b32 s12, s44
    s_mov_b32 s13, s45
    s_mov_b32 s14, 401408
    s_mov_b32 s15, 0x20000
    s_mul_i32 s32, s29, 256
    s_mul_i32 s34, s35, 64
    s_add_u32 s32, s32, s34
    s_add_u32 s32, s32, 18882560
    s_mov_b32 exec_lo, 0xffff
    s_mov_b32 exec_hi, 0
    s_mov_b32 s26, 0
L_k_poll_6:
    buffer_load_dword v3, v17, s[20:23], s32 offen sc1
    s_add_u32 s26, s26, 1
    s_cmp_gt_u32 s26, 0x40000
    s_waitcnt vmcnt(0)
    s_cbranch_scc1 L_k_pd_7
    v_cmp_ne_u32 vcc, s24, v3
    s_cbranch_vccnz L_k_poll_6
L_k_pd_7:
    s_cmp_eq_u32 s25, 0
    s_cbranch_scc1 L_k_pf_8
    buffer_inv sc1
    s_waitcnt vmcnt(0)
L_k_pf_8:
    s_mov_b64 exec, -1
    s_add_u32 m0, s7, 4096
    s_add_u32 s31, s30, 1
    s_and_b32 s31, s31, 15
    s_lshl_b32 s31, s31, 14
    s_add_u32 s31, s31, s6
    buffer_load_dwordx4 v2, s[20:23], s31 offen offset:0 sc1 lds
    buffer_load_dwordx4 v2, s[20:23], s31 offen offset:1024 sc1 lds
    buffer_load_dwordx4 v2, s[20:23], s31 offen offset:2048 sc1 lds
    buffer_load_dwordx4 v2, s[20:23], s31 offen offset:3072 sc1 lds
    s_barrier
    s_add_u32 m0, s7, 8192
    s_add_u32 s31, s30, 2
    s_and_b32 s31, s31, 15
    s_lshl_b32 s31, s31, 14
    s_add_u32 s31, s31, s6
    buffer_load_dwordx4 v2, s[20:23], s31 offen offset:0 sc1 lds
    buffer_load_dwordx4 v2, s[20:23], s31 offen offset:1024 sc1 lds
    buffer_load_dwordx4 v2, s[20:23], s31 offen offset:2048 sc1 lds
    buffer_load_dwordx4 v2, s[20:23], s31 offen offset:3072 sc1 lds
    s_waitcnt vmcnt(4)
    s_barrier
    s_add_u32 m0, s7, 12288
    s_add_u32 s31, s30, 3
    s_and_b32 s31, s31, 15
    s_lshl_b32 s31, s31, 14
    s_add_u32 s31, s31, s6
    buffer_load_dwordx4 v2, s[20:23], s31 offen offset:0 sc1 lds
    buffer_load_dwordx4 v2, s[20:23], s31 offen offset:1024 sc1 lds
    buffer_load_dwordx4 v2, s[20:23], s31 offen offset:2048 sc1 lds
    buffer_load_dwordx4 v2, s[20:23], s31 offen offset:3072 sc1 lds
    s_add_u32 m0, s7, 0
    s_add_u32 s31, s30, 4
    s_and_b32 s31, s31, 15
    s_lshl_b32 s31, s31, 14
    s_add_u32 s31, s31, s6
    buffer_load_dwordx4 v2, s[20:23], s31 offen offset:0 sc1 lds
    buffer_load_dwordx4 v2, s[20:23], s31 offen offset:1024 sc1 lds
    buffer_load_dwordx4 v2, s[20:23], s31 offen offset:2048 sc1 lds
    buffer_load_dwordx4 v2, s[20:23], s31 offen offset:3072 sc1 lds
    s_waitcnt vmcnt(8)
    s_barrier
    s_add_u32 m0, s7, 4096
    s_add_u32 s31, s30, 5
    s_and_b32 s31, s31, 15
    s_lshl_b32 s31, s31, 14
    s_add_u32 s31, s31, s6
    buffer_load_dwordx4 v2, s[20:23], s31 offen offset:0 sc1 lds
    buffer_load_dwordx4 v2, s[20:23], s31 offen offset:1024 sc1 lds
    buffer_load_dwordx4 v2, s[20:23], s31 offen offset:2048 sc1 lds
    buffer_load_dwordx4 v2, s[20:23], s31 offen offset:3072 sc1 lds
    s_waitcnt vmcnt(8)
    s_barrier
    s_add_u32 m0, s7, 8192
    s_add_u32 s31, s30, 6
    s_and_b32 s31, s31, 15
    s_lshl_b32 s31, s31, 14
    s_add_u32 s31, s31, s6
    buffer_load_dwordx4 v2, s[20:23], s31 offen offset:0 sc1 lds
    buffer_load_dwordx4 v2, s[20:23], s31 offen offset:1024 sc1 lds
    buffer_load_dwordx4 v2, s[20:23], s31 offen offset:2048 sc1 lds
    buffer_load_dwordx4 v2, s[20:23], s31 offen offset:3072 sc1 lds
    s_waitcnt vmcnt(8)
    s_barrier
    s_add_u32 m0, s7, 12288
    s_add_u32 s31, s30, 7
    s_and_b32 s31, s31, 15
    s_lshl_b32 s31, s31, 14
    s_add_u32 s31, s31, s6
    buffer_load_dwordx4 v2, s[20:23], s31 offen offset:0 sc1 lds
    buffer_load_dwordx4 v2, s[20:23], s31 offen offset:1024 sc1 lds
    buffer_load_dwordx4 v2, s[20:23], s31 offen offset:2048 sc1 lds
    buffer_load_dwordx4 v2, s[20:23], s31 offen offset:3072 sc1 lds
    s_waitcnt vmcnt(8)
    s_barrier
    s_add_u32 m0, s7, 0
    s_add_u32 s31, s30, 8
    s_and_b32 s31, s31, 15
    s_lshl_b32 s31, s31, 14
    s_add_u32 s31, s31, s6
    buffer_load_dwordx4 v2, s[20:23], s31 offen offset:0 sc1 lds
    buffer_load_dwordx4 v2, s[20:23], s31 offen offset:1024 sc1 lds
    buffer_load_dwordx4 v2, s[20:23], s31 offen offset:2048 sc1 lds
    buffer_load_dwordx4 v2, s[20:23], s31 offen offset:3072 sc1 lds
    s_waitcnt vmcnt(8)
    s_barrier
    s_add_u32 m0, s7, 4096
    s_add_u32 s31, s30, 9
    s_and_b32 s31, s31, 15
    s_lshl_b32 s31, s31, 14
    s_add_u32 s31, s31, s6
    buffer_load_dwordx4 v2, s[20:23], s31 offen offset:0 sc1 lds
    buffer_load_dwordx4 v2, s[20:23], s31 offen offset:1024 sc1 lds
    buffer_load_dwordx4 v2, s[20:23], s31 offen offset:2048 sc1 lds
    buffer_load_dwordx4 v2, s[20:23], s31 offen offset:3072 sc1 lds
    s_add_u32 m0, s37, 0
    s_add_u32 s31, s38, 0
    buffer_load_dwordx4 v15, s[12:15], s31 offen  lds
    s_add_u32 m0, s37, 1024
    s_add_u32 s31, s38, 14336
    buffer_load_dwordx4 v15, s[12:15], s31 offen  lds
    s_add_u32 m0, s37, 2048
    s_add_u32 s31, s38, 28672
    buffer_load_dwordx4 v15, s[12:15], s31 offen  lds
    s_add_u32 m0, s37, 3072
    s_add_u32 s31, s38, 43008
    buffer_load_dwordx4 v15, s[12:15], s31 offen  lds
    s_add_u32 m0, s37, 4096
    s_add_u32 s31, s38, 57344
    buffer_load_dwordx4 v15, s[12:15], s31 offen  lds
    s_add_u32 m0, s37, 5120
    s_add_u32 s31, s38, 71680
    buffer_load_dwordx4 v15, s[12:15], s31 offen  lds
    s_waitcnt vmcnt(14)
    s_barrier
    s_add_u32 m0, s7, 8192
    s_add_u32 s31, s30, 10
    s_and_b32 s31, s31, 15
    s_lshl_b32 s31, s31, 14
    s_add_u32 s31, s31, s6
    buffer_load_dwordx4 v2, s[20:23], s31 offen offset:0 sc1 lds
    buffer_load_dwordx4 v2, s[20:23], s31 offen offset:1024 sc1 lds
    buffer_load_dwordx4 v2, s[20:23], s31 offen offset:2048 sc1 lds
    buffer_load_dwordx4 v2, s[20:23], s31 offen offset:3072 sc1 lds
    s_add_u32 m0, s37, 6144
    s_add_u32 s31, s38, 86016
    buffer_load_dwordx4 v15, s[12:15], s31 offen  lds
    s_add_u32 m0, s37, 28832
    s_add_u32 s31, s38, 100352
    buffer_load_dwordx4 v15, s[12:15], s31 offen  lds
    s_add_u32 m0, s37, 29856
    s_add_u32 s31, s38, 114688
    buffer_load_dwordx4 v15, s[12:15], s31 offen  lds
    s_add_u32 m0, s37, 30880
    s_add_u32 s31, s38, 129024
    buffer_load_dwordx4 v15, s[12:15], s31 offen  lds
    s_add_u32 m0, s37, 31904
    s_add_u32 s31, s38, 143360
    buffer_load_dwordx4 v15, s[12:15], s31 offen  lds
    s_add_u32 m0, s37, 32928
    s_add_u32 s31, s38, 157696
    buffer_load_dwordx4 v15, s[12:15], s31 offen  lds
    s_waitcnt vmcnt(20)
    s_barrier
    s_add_u32 m0, s7, 12288
    s_add_u32 s31, s30, 11
    s_and_b32 s31, s31, 15
    s_lshl_b32 s31, s31, 14
    s_add_u32 s31, s31, s6
    buffer_load_dwordx4 v2, s[20:23], s31 offen offset:0 sc1 lds
    buffer_load_dwordx4 v2, s[20:23], s31 offen offset:1024 sc1 lds
    buffer_load_dwordx4 v2, s[20:23], s31 offen offset:2048 sc1 lds
    buffer_load_dwordx4 v2, s[20:23], s31 offen offset:3072 sc1 lds
    s_add_u32 m0, s37, 33952
    s_add_u32 s31, s38, 172032
    buffer_load_dwordx4 v15, s[12:15], s31 offen  lds
    s_add_u32 m0, s37, 34976
    s_add_u32 s31, s38, 186368
    buffer_load_dwordx4 v15, s[12:15], s31 offen  lds
    s_add_u32 m0, s37, 57664
    s_add_u32 s31, s38, 200704
    buffer_load_dwordx4 v15, s[12:15], s31 offen  lds
    s_add_u32 m0, s37, 58688
    s_add_u32 s31, s38, 215040
    buffer_load_dwordx4 v15, s[12:15], s31 offen  lds
    s_add_u32 m0, s37, 59712
    s_add_u32 s31, s38, 229376
    buffer_load_dwordx4 v15, s[12:15], s31 offen  lds
    s_add_u32 m0, s37, 60736
    s_add_u32 s31, s38, 243712
    buffer_load_dwordx4 v15, s[12:15], s31 offen  lds
    s_waitcnt vmcnt(26)
    s_barrier
    s_add_u32 m0, s7, 0
    s_add_u32 s31, s30, 12
    s_and_b32 s31, s31, 15
    s_lshl_b32 s31, s31, 14
    s_add_u32 s31, s31, s6
    buffer_load_dwordx4 v2, s[20:23], s31 offen offset:0 sc1 lds
    buffer_load_dwordx4 v2, s[20:23], s31 offen offset:1024 sc1 lds
    buffer_load_dwordx4 v2, s[20:23], s31 offen offset:2048 sc1 lds
    buffer_load_dwordx4 v2, s[20:23], s31 offen offset:3072 sc1 lds
    s_add_u32 m0, s37, 61760
    s_add_u32 s31, s38, 258048
    buffer_load_dwordx4 v15, s[12:15], s31 offen  lds
    s_add_u32 m0, s37, 62784
    s_add_u32 s31, s38, 272384
    buffer_load_dwordx4 v15, s[12:15], s31 offen  lds
    s_add_u32 m0, s37, 63808
    s_add_u32 s31, s38, 286720
    buffer_load_dwordx4 v15, s[12:15], s31 offen  lds
    s_waitcnt vmcnt(22)
    s_cmp_lg_u32 s35, 0
    s_cbranch_scc1 L_k_wn_10
    ds_read_b64_tr_b16 v[72:73], v16 offset:0
    ds_read_b64_tr_b16 v[74:75], v16 offset:512
    ds_read_b64_tr_b16 v[76:77], v16 offset:1024
    ds_read_b64_tr_b16 v[78:79], v16 offset:1536
    ds_read_b64_tr_b16 v[80:81], v16 offset:1792
    ds_read_b64_tr_b16 v[82:83], v16 offset:2304
    ds_read_b64_tr_b16 v[84:85], v16 offset:2816
    ds_read_b64_tr_b16 v[86:87], v16 offset:3328
    ds_read_b64_tr_b16 v[88:89], v16 offset:3584
    ds_read_b64_tr_b16 v[90:91], v16 offset:4096
    ds_read_b64_tr_b16 v[92:93], v16 offset:4608
    ds_read_b64_tr_b16 v[94:95], v16 offset:5120
    ds_read_b64_tr_b16 v[96:97], v16 offset:5376
    ds_read_b64_tr_b16 v[98:99], v16 offset:5888
    ds_read_b64_tr_b16 v[100:101], v16 offset:6400
    ds_read_b64_tr_b16 v[102:103], v16 offset:6912
    s_branch L_k_wj_9
L_k_wn_10:
    s_cmp_lg_u32 s35, 1
    s_cbranch_scc1 L_k_wn_11
    ds_read_b64_tr_b16 v[168:169], v16 offset:0
    ds_read_b64_tr_b16 v[170:171], v16 offset:512
    ds_read_b64_tr_b16 v[172:173], v16 offset:1024
    ds_read_b64_tr_b16 v[174:175], v16 offset:1536
    ds_read_b64_tr_b16 v[176:177], v16 offset:1792
    ds_read_b64_tr_b16 v[178:179], v16 offset:2304
    ds_read_b64_tr_b16 v[180:181], v16 offset:2816
    ds_read_b64_tr_b16 v[182:183], v16 offset:3328
    ds_read_b64_tr_b16 v[184:185], v16 offset:3584
    ds_read_b64_tr_b16 v[186:187], v16 offset:4096
    ds_read_b64_tr_b16 v[188:189], v16 offset:4608
    ds_read_b64_tr_b16 v[190:191], v16 offset:5120
    ds_read_b64_tr_b16 v[192:193], v16 offset:5376
    ds_read_b64_tr_b16 v[194:195], v16 offset:5888
    ds_read_b64_tr_b16 v[196:197], v16 offset:6400
    ds_read_b64_tr_b16 v[198:199], v16 offset:6912
    s_branch L_k_wj_9
L_k_wn_11:
    s_cmp_lg_u32 s35, 2
    s_cbranch_scc1 L_k_wn_12
    ds_read_b64_tr_b16 v[136:137], v16 offset:0
    ds_read_b64_tr_b16 v[138:139], v16 offset:512
    ds_read_b64_tr_b16 v[140:141], v16 offset:1024
    ds_read_b64_tr_b16 v[142:143], v16 offset:1536
    ds_read_b64_tr_b16 v[144:145], v16 offset:1792
    ds_read_b64_tr_b16 v[146:147], v16 offset:2304
    ds_read_b64_tr_b16 v[148:149], v16 offset:2816
    ds_read_b64_tr_b16 v[150:151], v16 offset:3328
    ds_read_b64_tr_b16 v[152:153], v16 offset:3584
    ds_read_b64_tr_b16 v[154:155], v16 offset:4096
    ds_read_b64_tr_b16 v[156:157], v16 offset:4608
    ds_read_b64_tr_b16 v[158:159], v16 offset:5120
    ds_read_b64_tr_b16 v[160:161], v16 offset:5376
    ds_read_b64_tr_b16 v[162:163], v16 offset:5888
    ds_read_b64_tr_b16 v[164:165], v16 offset:6400
    ds_read_b64_tr_b16 v[166:167], v16 offset:6912
    s_branch L_k_wj_9
L_k_wn_12:
    ds_read_b64_tr_b16 v[104:105], v16 offset:0
    ds_read_b64_tr_b16 v[106:107], v16 offset:512
    ds_read_b64_tr_b16 v[108:109], v16 offset:1024
    ds_read_b64_tr_b16 v[110:111], v16 offset:1536
    ds_read_b64_tr_b16 v[112:113], v16 offset:1792
    ds_read_b64_tr_b16 v[114:115], v16 offset:2304
    ds_read_b64_tr_b16 v[116:117], v16 offset:2816
    ds_read_b64_tr_b16 v[118:119], v16 offset:3328
    ds_read_b64_tr_b16 v[120:121], v16 offset:3584
    ds_read_b64_tr_b16 v[122:123], v16 offset:4096
    ds_read_b64_tr_b16 v[124:125], v16 offset:4608
    ds_read_b64_tr_b16 v[126:127], v16 offset:5120
    ds_read_b64_tr_b16 v[128:129], v16 offset:5376
    ds_read_b64_tr_b16 v[130:131], v16 offset:5888
    ds_read_b64_tr_b16 v[132:133], v16 offset:6400
    ds_read_b64_tr_b16 v[134:135], v16 offset:6912
L_k_wj_9:
    s_waitcnt lgkmcnt(0)
    s_add_u32 m0, s37, 0
    s_add_u32 s31, s38, 301056
    buffer_load_dwordx4 v15, s[12:15], s31 offen  lds
    s_add_u32 m0, s37, 1024
    s_add_u32 s31, s38, 315392
    buffer_load_dwordx4 v15, s[12:15], s31 offen  lds
    s_add_u32 m0, s37, 2048
    s_add_u32 s31, s38, 329728
    buffer_load_dwordx4 v15, s[12:15], s31 offen  lds
    s_waitcnt vmcnt(26)
    s_barrier
    s_add_u32 m0, s7, 4096
    s_add_u32 s31, s30, 13
    s_and_b32 s31, s31, 15
    s_lshl_b32 s31, s31, 14
    s_add_u32 s31, s31, s6
    buffer_load_dwordx4 v2, s[20:23], s31 offen offset:0 sc1 lds
    buffer_load_dwordx4 v2, s[20:23], s31 offen offset:1024 sc1 lds
    buffer_load_dwordx4 v2, s[20:23], s31 offen offset:2048 sc1 lds
    buffer_load_dwordx4 v2, s[20:23], s31 offen offset:3072 sc1 lds
    s_mul_i32 s32, s61, 28672
    s_mul_i32 s34, s60, 7168
    s_add_u32 s32, s32, s34
    s_mul_i32 s34, s35, 1792
    s_add_u32 s32, s32, s34
    s_add_u32 s32, s32, 8388608
    s_mov_b32 exec_lo, 0x3fff
    s_mov_b32 exec_hi, 0x0
    v_mul_u32_u24 v4, 128, v1
    buffer_load_dword v71, v4, s[20:23], s32 offen sc1
    s_mov_b64 exec, -1
    s_mul_i32 s32, s61, 4096
    s_mul_i32 s34, s60, 1024
    s_add_u32 s32, s32, s34
    s_mul_i32 s34, s35, 256
    s_add_u32 s32, s32, s34
    s_add_u32 s32, s32, 19660800
    s_mov_b32 exec_lo, 0x3
    s_mov_b32 exec_hi, 0x0
    v_mul_u32_u24 v4, 128, v1
    buffer_load_dword v71, v4, s[20:23], s32 offen sc1
    s_mov_b64 exec, -1
    s_mul_i32 s32, s29, 512
    s_mul_i32 s34, s35, 128
    s_add_u32 s32, s32, s34
    s_add_u32 s32, s32, 18894848
    s_mov_b32 exec_lo, 0x7
    s_mov_b32 exec_hi, 0x0
    v_mul_u32_u24 v4, 12288, v1
    buffer_load_dword v71, v4, s[20:23], s32 offen sc1
    s_mov_b64 exec, -1
    s_add_u32 m0, s37, 3072
    s_add_u32 s31, s38, 344064
    buffer_load_dwordx4 v15, s[12:15], s31 offen  lds
    s_add_u32 m0, s37, 4096
    s_add_u32 s31, s38, 358400
    buffer_load_dwordx4 v15, s[12:15], s31 offen  lds
    s_add_u32 m0, s37, 5120
    s_add_u32 s31, s38, 372736
    buffer_load_dwordx4 v15, s[12:15], s31 offen  lds
    s_add_u32 m0, s37, 6144
    s_add_u32 s31, s38, 387072
    buffer_load_dwordx4 v15, s[12:15], s31 offen  lds
    s_waitcnt vmcnt(25)
    s_cmp_lg_u32 s35, 0
    s_cbranch_scc1 L_k_wn_15
    ds_read_b64_tr_b16 v[104:105], v16 offset:28832
    ds_read_b64_tr_b16 v[106:107], v16 offset:29344
    ds_read_b64_tr_b16 v[108:109], v16 offset:29856
    ds_read_b64_tr_b16 v[110:111], v16 offset:30368
    ds_read_b64_tr_b16 v[112:113], v16 offset:30624
    ds_read_b64_tr_b16 v[114:115], v16 offset:31136
    ds_read_b64_tr_b16 v[116:117], v16 offset:31648
    ds_read_b64_tr_b16 v[118:119], v16 offset:32160
    ds_read_b64_tr_b16 v[120:121], v16 offset:32416
    ds_read_b64_tr_b16 v[122:123], v16 offset:32928
    ds_read_b64_tr_b16 v[124:125], v16 offset:33440
    ds_read_b64_tr_b16 v[126:127], v16 offset:33952
    ds_read_b64_tr_b16 v[128:129], v16 offset:34208
    ds_read_b64_tr_b16 v[130:131], v16 offset:34720
    ds_read_b64_tr_b16 v[132:133], v16 offset:35232
    ds_read_b64_tr_b16 v[134:135], v16 offset:35744
    s_branch L_k_wj_14
L_k_wn_15:
    s_cmp_lg_u32 s35, 1
    s_cbranch_scc1 L_k_wn_16
    ds_read_b64_tr_b16 v[72:73], v16 offset:28832
    ds_read_b64_tr_b16 v[74:75], v16 offset:29344
    ds_read_b64_tr_b16 v[76:77], v16 offset:29856
    ds_read_b64_tr_b16 v[78:79], v16 offset:30368
    ds_read_b64_tr_b16 v[80:81], v16 offset:30624
    ds_read_b64_tr_b16 v[82:83], v16 offset:31136
    ds_read_b64_tr_b16 v[84:85], v16 offset:31648
    ds_read_b64_tr_b16 v[86:87], v16 offset:32160
    ds_read_b64_tr_b16 v[88:89], v16 offset:32416
    ds_read_b64_tr_b16 v[90:91], v16 offset:32928
    ds_read_b64_tr_b16 v[92:93], v16 offset:33440
    ds_read_b64_tr_b16 v[94:95], v16 offset:33952
    ds_read_b64_tr_b16 v[96:97], v16 offset:34208
    ds_read_b64_tr_b16 v[98:99], v16 offset:34720
    ds_read_b64_tr_b16 v[100:101], v16 offset:35232
    ds_read_b64_tr_b16 v[102:103], v16 offset:35744
    s_branch L_k_wj_14
L_k_wn_16:
    s_cmp_lg_u32 s35, 2
    s_cbranch_scc1 L_k_wn_17
    ds_read_b64_tr_b16 v[168:169], v16 offset:28832
    ds_read_b64_tr_b16 v[170:171], v16 offset:29344
    ds_read_b64_tr_b16 v[172:173], v16 offset:29856
    ds_read_b64_tr_b16 v[174:175], v16 offset:30368
    ds_read_b64_tr_b16 v[176:177], v16 offset:30624
    ds_read_b64_tr_b16 v[178:179], v16 offset:31136
    ds_read_b64_tr_b16 v[180:181], v16 offset:31648
    ds_read_b64_tr_b16 v[182:183], v16 offset:32160
    ds_read_b64_tr_b16 v[184:185], v16 offset:32416
    ds_read_b64_tr_b16 v[186:187], v16 offset:32928
    ds_read_b64_tr_b16 v[188:189], v16 offset:33440
    ds_read_b64_tr_b16 v[190:191], v16 offset:33952
    ds_read_b64_tr_b16 v[192:193], v16 offset:34208
    ds_read_b64_tr_b16 v[194:195], v16 offset:34720
    ds_read_b64_tr_b16 v[196:197], v16 offset:35232
    ds_read_b64_tr_b16 v[198:199], v16 offset:35744
    s_branch L_k_wj_14
L_k_wn_17:
    ds_read_b64_tr_b16 v[136:137], v16 offset:28832
    ds_read_b64_tr_b16 v[138:139], v16 offset:29344
    ds_read_b64_tr_b16 v[140:141], v16 offset:29856
    ds_read_b64_tr_b16 v[142:143], v16 offset:30368
    ds_read_b64_tr_b16 v[144:145], v16 offset:30624
    ds_read_b64_tr_b16 v[146:147], v16 offset:31136
    ds_read_b64_tr_b16 v[148:149], v16 offset:31648
    ds_read_b64_tr_b16 v[150:151], v16 offset:32160
    ds_read_b64_tr_b16 v[152:153], v16 offset:32416
    ds_read_b64_tr_b16 v[154:155], v16 offset:32928
    ds_read_b64_tr_b16 v[156:157], v16 offset:33440
    ds_read_b64_tr_b16 v[158:159], v16 offset:33952
    ds_read_b64_tr_b16 v[160:161], v16 offset:34208
    ds_read_b64_tr_b16 v[162:163], v16 offset:34720
    ds_read_b64_tr_b16 v[164:165], v16 offset:35232
    ds_read_b64_tr_b16 v[166:167], v16 offset:35744
L_k_wj_14:
    s_waitcnt lgkmcnt(0)
    s_mov_b32 s12, s52
    s_mov_b32 s13, s53
    s_mov_b32 s14, 1605632
    s_mov_b32 s15, 0x20000
    s_add_u32 m0, s37, 28832
    s_add_u32 s31, s27, 0
    buffer_load_dwordx4 v5, s[12:15], s31 offen  lds
    s_add_u32 m0, s37, 29856
    s_add_u32 s31, s27, 7168
    buffer_load_dwordx4 v5, s[12:15], s31 offen  lds
    s_waitcnt vmcnt(29)
    s_barrier
    s_add_u32 m0, s7, 8192
    s_add_u32 s31, s30, 14
    s_and_b32 s31, s31, 15
    s_lshl_b32 s31, s31, 14
    s_add_u32 s31, s31, s6
    buffer_load_dwordx4 v2, s[20:23], s31 offen offset:0 sc1 lds
    buffer_load_dwordx4 v2, s[20:23], s31 offen offset:1024 sc1 lds
    buffer_load_dwordx4 v2, s[20:23], s31 offen offset:2048 sc1 lds
    buffer_load_dwordx4 v2, s[20:23], s31 offen offset:3072 sc1 lds
    s_add_u32 m0, s37, 30880
    s_add_u32 s31, s27, 14336
    buffer_load_dwordx4 v5, s[12:15], s31 offen  lds
    s_add_u32 m0, s37, 31904
    s_add_u32 s31, s27, 21504
    buffer_load_dwordx4 v5, s[12:15], s31 offen  lds
    s_add_u32 m0, s37, 32928
    s_add_u32 s31, s27, 28672
    buffer_load_dwordx4 v5, s[12:15], s31 offen  lds
    s_add_u32 m0, s37, 33952
    s_add_u32 s31, s27, 35840
    buffer_load_dwordx4 v5, s[12:15], s31 offen  lds
    s_add_u32 m0, s37, 34976
    s_add_u32 s31, s27, 43008
    buffer_load_dwordx4 v5, s[12:15], s31 offen  lds
    s_waitcnt vmcnt(25)
    s_cmp_lg_u32 s35, 0
    s_cbranch_scc1 L_k_wn_20
    ds_read_b64_tr_b16 v[136:137], v16 offset:57664
    ds_read_b64_tr_b16 v[138:139], v16 offset:58176
    ds_read_b64_tr_b16 v[140:141], v16 offset:58688
    ds_read_b64_tr_b16 v[142:143], v16 offset:59200
    ds_read_b64_tr_b16 v[144:145], v16 offset:59456
    ds_read_b64_tr_b16 v[146:147], v16 offset:59968
    ds_read_b64_tr_b16 v[148:149], v16 offset:60480
    ds_read_b64_tr_b16 v[150:151], v16 offset:60992
    ds_read_b64_tr_b16 v[152:153], v16 offset:61248
    ds_read_b64_tr_b16 v[154:155], v16 offset:61760
    ds_read_b64_tr_b16 v[156:157], v16 offset:62272
    ds_read_b64_tr_b16 v[158:159], v16 offset:62784
    ds_read_b64_tr_b16 v[160:161], v16 offset:63040
    ds_read_b64_tr_b16 v[162:163], v16 offset:63552
    ds_read_b64_tr_b16 v[164:165], v16 offset:64064
    ds_read_b64_tr_b16 v[166:167], v16 offset:64576
    s_branch L_k_wj_19
L_k_wn_20:
    s_cmp_lg_u32 s35, 1
    s_cbranch_scc1 L_k_wn_21
    ds_read_b64_tr_b16 v[104:105], v16 offset:57664
    ds_read_b64_tr_b16 v[106:107], v16 offset:58176
    ds_read_b64_tr_b16 v[108:109], v16 offset:58688
    ds_read_b64_tr_b16 v[110:111], v16 offset:59200
    ds_read_b64_tr_b16 v[112:113], v16 offset:59456
    ds_read_b64_tr_b16 v[114:115], v16 offset:59968
    ds_read_b64_tr_b16 v[116:117], v16 offset:60480
    ds_read_b64_tr_b16 v[118:119], v16 offset:60992
    ds_read_b64_tr_b16 v[120:121], v16 offset:61248
    ds_read_b64_tr_b16 v[122:123], v16 offset:61760
    ds_read_b64_tr_b16 v[124:125], v16 offset:62272
    ds_read_b64_tr_b16 v[126:127], v16 offset:62784
    ds_read_b64_tr_b16 v[128:129], v16 offset:63040
    ds_read_b64_tr_b16 v[130:131], v16 offset:63552
    ds_read_b64_tr_b16 v[132:133], v16 offset:64064
    ds_read_b64_tr_b16 v[134:135], v16 offset:64576
    s_branch L_k_wj_19
L_k_wn_21:
    s_cmp_lg_u32 s35, 2
    s_cbranch_scc1 L_k_wn_22
    ds_read_b64_tr_b16 v[72:73], v16 offset:57664
    ds_read_b64_tr_b16 v[74:75], v16 offset:58176
    ds_read_b64_tr_b16 v[76:77], v16 offset:58688
    ds_read_b64_tr_b16 v[78:79], v16 offset:59200
    ds_read_b64_tr_b16 v[80:81], v16 offset:59456
    ds_read_b64_tr_b16 v[82:83], v16 offset:59968
    ds_read_b64_tr_b16 v[84:85], v16 offset:60480
    ds_read_b64_tr_b16 v[86:87], v16 offset:60992
    ds_read_b64_tr_b16 v[88:89], v16 offset:61248
    ds_read_b64_tr_b16 v[90:91], v16 offset:61760
    ds_read_b64_tr_b16 v[92:93], v16 offset:62272
    ds_read_b64_tr_b16 v[94:95], v16 offset:62784
    ds_read_b64_tr_b16 v[96:97], v16 offset:63040
    ds_read_b64_tr_b16 v[98:99], v16 offset:63552
    ds_read_b64_tr_b16 v[100:101], v16 offset:64064
    ds_read_b64_tr_b16 v[102:103], v16 offset:64576
    s_branch L_k_wj_19
L_k_wn_22:
    ds_read_b64_tr_b16 v[168:169], v16 offset:57664
    ds_read_b64_tr_b16 v[170:171], v16 offset:58176
    ds_read_b64_tr_b16 v[172:173], v16 offset:58688
    ds_read_b64_tr_b16 v[174:175], v16 offset:59200
    ds_read_b64_tr_b16 v[176:177], v16 offset:59456
    ds_read_b64_tr_b16 v[178:179], v16 offset:59968
    ds_read_b64_tr_b16 v[180:181], v16 offset:60480
    ds_read_b64_tr_b16 v[182:183], v16 offset:60992
    ds_read_b64_tr_b16 v[184:185], v16 offset:61248
    ds_read_b64_tr_b16 v[186:187], v16 offset:61760
    ds_read_b64_tr_b16 v[188:189], v16 offset:62272
    ds_read_b64_tr_b16 v[190:191], v16 offset:62784
    ds_read_b64_tr_b16 v[192:193], v16 offset:63040
    ds_read_b64_tr_b16 v[194:195], v16 offset:63552
    ds_read_b64_tr_b16 v[196:197], v16 offset:64064
    ds_read_b64_tr_b16 v[198:199], v16 offset:64576
L_k_wj_19:
    s_waitcnt lgkmcnt(0)
    s_add_u32 m0, s37, 57664
    s_add_u32 s31, s27, 50176
    buffer_load_dwordx4 v5, s[12:15], s31 offen  lds
    s_add_u32 m0, s37, 58688
    s_add_u32 s31, s27, 57344
    buffer_load_dwordx4 v5, s[12:15], s31 offen  lds
    s_waitcnt vmcnt(30)
    s_barrier
    s_add_u32 m0, s7, 12288
    s_add_u32 s31, s30, 15
    s_and_b32 s31, s31, 15
    s_lshl_b32 s31, s31, 14
    s_add_u32 s31, s31, s6
    buffer_load_dwordx4 v2, s[20:23], s31 offen offset:0 sc1 lds
    buffer_load_dwordx4 v2, s[20:23], s31 offen offset:1024 sc1 lds
    buffer_load_dwordx4 v2, s[20:23], s31 offen offset:2048 sc1 lds
    buffer_load_dwordx4 v2, s[20:23], s31 offen offset:3072 sc1 lds
    s_add_u32 m0, s37, 59712
    s_add_u32 s31, s27, 64512
    buffer_load_dwordx4 v5, s[12:15], s31 offen  lds
    s_add_u32 m0, s37, 60736
    s_add_u32 s31, s27, 71680
    buffer_load_dwordx4 v5, s[12:15], s31 offen  lds
    s_add_u32 m0, s37, 61760
    s_add_u32 s31, s27, 78848
    buffer_load_dwordx4 v5, s[12:15], s31 offen  lds
    s_add_u32 m0, s37, 62784
    s_add_u32 s31, s27, 86016
    buffer_load_dwordx4 v5, s[12:15], s31 offen  lds
    s_add_u32 m0, s37, 63808
    s_add_u32 s31, s27, 93184
    buffer_load_dwordx4 v5, s[12:15], s31 offen  lds
    s_waitcnt vmcnt(22)
    s_cmp_lg_u32 s35, 0
    s_cbranch_scc1 L_k_wn_25
    ds_read_b64_tr_b16 v[168:169], v16 offset:0
    ds_read_b64_tr_b16 v[170:171], v16 offset:512
    ds_read_b64_tr_b16 v[172:173], v16 offset:1024
    ds_read_b64_tr_b16 v[174:175], v16 offset:1536
    ds_read_b64_tr_b16 v[176:177], v16 offset:1792
    ds_read_b64_tr_b16 v[178:179], v16 offset:2304
    ds_read_b64_tr_b16 v[180:181], v16 offset:2816
    ds_read_b64_tr_b16 v[182:183], v16 offset:3328
    ds_read_b64_tr_b16 v[184:185], v16 offset:3584
    ds_read_b64_tr_b16 v[186:187], v16 offset:4096
    ds_read_b64_tr_b16 v[188:189], v16 offset:4608
    ds_read_b64_tr_b16 v[190:191], v16 offset:5120
    ds_read_b64_tr_b16 v[192:193], v16 offset:5376
    ds_read_b64_tr_b16 v[194:195], v16 offset:5888
    ds_read_b64_tr_b16 v[196:197], v16 offset:6400
    ds_read_b64_tr_b16 v[198:199], v16 offset:6912
    s_branch L_k_wj_24
L_k_wn_25:
    s_cmp_lg_u32 s35, 1
    s_cbranch_scc1 L_k_wn_26
    ds_read_b64_tr_b16 v[136:137], v16 offset:0
    ds_read_b64_tr_b16 v[138:139], v16 offset:512
    ds_read_b64_tr_b16 v[140:141], v16 offset:1024
    ds_read_b64_tr_b16 v[142:143], v16 offset:1536
    ds_read_b64_tr_b16 v[144:145], v16 offset:1792
    ds_read_b64_tr_b16 v[146:147], v16 offset:2304
    ds_read_b64_tr_b16 v[148:149], v16 offset:2816
    ds_read_b64_tr_b16 v[150:151], v16 offset:3328
    ds_read_b64_tr_b16 v[152:153], v16 offset:3584
    ds_read_b64_tr_b16 v[154:155], v16 offset:4096
    ds_read_b64_tr_b16 v[156:157], v16 offset:4608
    ds_read_b64_tr_b16 v[158:159], v16 offset:5120
    ds_read_b64_tr_b16 v[160:161], v16 offset:5376
    ds_read_b64_tr_b16 v[162:163], v16 offset:5888
    ds_read_b64_tr_b16 v[164:165], v16 offset:6400
    ds_read_b64_tr_b16 v[166:167], v16 offset:6912
    s_branch L_k_wj_24
L_k_wn_26:
    s_cmp_lg_u32 s35, 2
    s_cbranch_scc1 L_k_wn_27
    ds_read_b64_tr_b16 v[104:105], v16 offset:0
    ds_read_b64_tr_b16 v[106:107], v16 offset:512
    ds_read_b64_tr_b16 v[108:109], v16 offset:1024
    ds_read_b64_tr_b16 v[110:111], v16 offset:1536
    ds_read_b64_tr_b16 v[112:113], v16 offset:1792
    ds_read_b64_tr_b16 v[114:115], v16 offset:2304
    ds_read_b64_tr_b16 v[116:117], v16 offset:2816
    ds_read_b64_tr_b16 v[118:119], v16 offset:3328
    ds_read_b64_tr_b16 v[120:121], v16 offset:3584
    ds_read_b64_tr_b16 v[122:123], v16 offset:4096
    ds_read_b64_tr_b16 v[124:125], v16 offset:4608
    ds_read_b64_tr_b16 v[126:127], v16 offset:5120
    ds_read_b64_tr_b16 v[128:129], v16 offset:5376
    ds_read_b64_tr_b16 v[130:131], v16 offset:5888
    ds_read_b64_tr_b16 v[132:133], v16 offset:6400
    ds_read_b64_tr_b16 v[134:135], v16 offset:6912
    s_branch L_k_wj_24
L_k_wn_27:
    ds_read_b64_tr_b16 v[72:73], v16 offset:0
    ds_read_b64_tr_b16 v[74:75], v16 offset:512
    ds_read_b64_tr_b16 v[76:77], v16 offset:1024
    ds_read_b64_tr_b16 v[78:79], v16 offset:1536
    ds_read_b64_tr_b16 v[80:81], v16 offset:1792
    ds_read_b64_tr_b16 v[82:83], v16 offset:2304
    ds_read_b64_tr_b16 v[84:85], v16 offset:2816
    ds_read_b64_tr_b16 v[86:87], v16 offset:3328
    ds_read_b64_tr_b16 v[88:89], v16 offset:3584
    ds_read_b64_tr_b16 v[90:91], v16 offset:4096
    ds_read_b64_tr_b16 v[92:93], v16 offset:4608
    ds_read_b64_tr_b16 v[94:95], v16 offset:5120
    ds_read_b64_tr_b16 v[96:97], v16 offset:5376
    ds_read_b64_tr_b16 v[98:99], v16 offset:5888
    ds_read_b64_tr_b16 v[100:101], v16 offset:6400
    ds_read_b64_tr_b16 v[102:103], v16 offset:6912
L_k_wj_24:
    s_waitcnt lgkmcnt(0)
    s_mov_b32 exec_lo, 0
    v_mov_b32 v102, 0
    v_mov_b32 v103, 0
    v_mov_b32 v134, 0
    v_mov_b32 v135, 0
    v_mov_b32 v166, 0
    v_mov_b32 v167, 0
    v_mov_b32 v198, 0
    v_mov_b32 v199, 0
    s_mov_b32 exec_lo, -1
    s_mul_i32 s32, s61, 28672
    s_add_u32 s38, s38, s32
    s_add_u32 m0, s37, 0
    s_add_u32 s31, s38, 0
    buffer_load_dwordx4 v15, s[8:11], s31 offen  lds
    s_add_u32 m0, s37, 1024
    s_add_u32 s31, s38, 14336
    buffer_load_dwordx4 v15, s[8:11], s31 offen  lds
    s_lshr_b32 s33, s2, 3
    s_lshr_b32 s31, s35, 1
    s_mul_i32 s32, s33, 7168
    s_mul_i32 s34, s31, 3584
    s_add_u32 s32, s32, s34
    s_add_u32 s32, s32, 458752
    s_mov_b32 exec_lo, 0xfffffff
    s_mov_b32 exec_hi, 0x0
    v_mul_u32_u24 v4, 128, v1
    buffer_load_dword v71, v4, s[16:19], s32 offen sc1
    s_mov_b64 exec, -1
    s_waitcnt vmcnt(32)
    s_barrier
    s_waitcnt vmcnt(14)
    ds_read_b64_tr_b16 v[200:201], v22 offset:28832
    ds_read_b64_tr_b16 v[204:205], v23 offset:28832
    ds_read_b64_tr_b16 v[202:203], v22 offset:29856
    ds_read_b64_tr_b16 v[206:207], v23 offset:29856
    ds_read_b64_tr_b16 v[208:209], v22 offset:30880
    ds_read_b64_tr_b16 v[212:213], v23 offset:30880
    ds_read_b64_tr_b16 v[210:211], v22 offset:31904
    ds_read_b64_tr_b16 v[214:215], v23 offset:31904
    ds_read_b64_tr_b16 v[216:217], v22 offset:32928
    ds_read_b64_tr_b16 v[220:221], v23 offset:32928
    ds_read_b64_tr_b16 v[218:219], v22 offset:33952
    ds_read_b64_tr_b16 v[222:223], v23 offset:33952
    ds_read_b64_tr_b16 v[224:225], v22 offset:34976
    ds_read_b64_tr_b16 v[228:229], v23 offset:34976
    s_waitcnt lgkmcnt(0)
    s_add_u32 m0, s37, 28832
    s_add_u32 s31, s36, 229376
    buffer_load_dwordx4 v8, s[16:19], s31 offen  lds
    s_add_u32 m0, s37, 29856
    s_add_u32 s31, s36, 229376
    buffer_load_dwordx4 v9, s[16:19], s31 offen  lds
    s_add_u32 m0, s37, 30880
    s_add_u32 s31, s36, 229376
    buffer_load_dwordx4 v10, s[16:19], s31 offen  lds
    s_add_u32 m0, s37, 31904
    s_add_u32 s31, s36, 229376
    buffer_load_dwordx4 v11, s[16:19], s31 offen  lds
    s_add_u32 m0, s37, 32928
    s_add_u32 s31, s36, 229376
    buffer_load_dwordx4 v12, s[16:19], s31 offen  lds
    s_add_u32 m0, s37, 33952
    s_add_u32 s31, s36, 229376
    buffer_load_dwordx4 v13, s[16:19], s31 offen  lds
    s_add_u32 m0, s37, 34976
    s_add_u32 s31, s36, 229376
    buffer_load_dwordx4 v14, s[16:19], s31 offen  lds
    s_lshr_b32 s33, s2, 3
    s_lshr_b32 s31, s35, 1
    s_mul_i32 s32, s33, 7168
    s_mul_i32 s34, s31, 3584
    s_add_u32 s32, s32, s34
    s_add_u32 s32, s32, 688128
    s_mov_b32 exec_lo, 0xfffffff
    s_mov_b32 exec_hi, 0x0
    v_mul_u32_u24 v4, 128, v1
    buffer_load_dword v71, v4, s[16:19], s32 offen sc1
    s_mov_b64 exec, -1
    s_waitcnt vmcnt(27)
    s_barrier
    s_waitcnt vmcnt(9)
    ds_read_b64 v[56:57], v18 offset:0
    ds_read_b64 v[58:59], v18 offset:16
    ds_read_b64 v[60:61], v18 offset:32
    ds_read_b64 v[62:63], v18 offset:48
    s_waitcnt lgkmcnt(0)
    s_waitcnt vmcnt(11)
    ds_read_b64_tr_b16 v[226:227], v22 offset:57664
    ds_read_b64_tr_b16 v[230:231], v23 offset:57664
    ds_read_b64_tr_b16 v[232:233], v22 offset:58688
    ds_read_b64_tr_b16 v[236:237], v23 offset:58688
    ds_read_b64_tr_b16 v[234:235], v22 offset:59712
    ds_read_b64_tr_b16 v[238:239], v23 offset:59712
    ds_read_b64_tr_b16 v[240:241], v22 offset:60736
    ds_read_b64_tr_b16 v[244:245], v23 offset:60736
    ds_read_b64_tr_b16 v[242:243], v22 offset:61760
    ds_read_b64_tr_b16 v[246:247], v23 offset:61760
    ds_read_b64_tr_b16 v[248:249], v22 offset:62784
    ds_read_b64_tr_b16 v[252:253], v23 offset:62784
    ds_read_b64_tr_b16 v[250:251], v22 offset:63808
    ds_read_b64_tr_b16 v[254:255], v23 offset:63808
    s_waitcnt lgkmcnt(0)
    s_add_u32 m0, s37, 0
    s_add_u32 s31, s36, 0
    buffer_load_dwordx4 v8, s[16:19], s31 offen  lds
    s_add_u32 m0, s37, 1024
    s_add_u32 s31, s36, 0
    buffer_load_dwordx4 v9, s[16:19], s31 offen  lds
    s_add_u32 m0, s37, 2048
    s_add_u32 s31, s36, 0
    buffer_load_dwordx4 v10, s[16:19], s31 offen  lds
    s_add_u32 m0, s37, 3072
    s_add_u32 s31, s36, 0
    buffer_load_dwordx4 v11, s[16:19], s31 offen  lds
    s_add_u32 m0, s37, 4096
    s_add_u32 s31, s36, 0
    buffer_load_dwordx4 v12, s[16:19], s31 offen  lds
    s_add_u32 m0, s37, 5120
    s_add_u32 s31, s36, 0
    buffer_load_dwordx4 v13, s[16:19], s31 offen  lds
    s_add_u32 m0, s37, 6144
    s_add_u32 s31, s36, 0
    buffer_load_dwordx4 v14, s[16:19], s31 offen  lds
    s_waitcnt vmcnt(23)
    s_barrier
    s_lshr_b32 s33, s2, 3
    s_lshr_b32 s31, s35, 1
    s_mul_i32 s32, s33, 7168
    s_mul_i32 s34, s31, 3584
    s_add_u32 s32, s32, s34
    s_add_u32 s32, s32, 917504
    s_mov_b32 exec_lo, 0xfffffff
    s_mov_b32 exec_hi, 0x0
    v_mul_u32_u24 v4, 128, v1
    buffer_load_dword v71, v4, s[16:19], s32 offen sc1
    s_mov_b64 exec, -1
    s_mov_b32 s39, 0
    v_add_u32 v15, 152064, v2
L_k_Hre_29:
    s_waitcnt vmcnt(0) lgkmcnt(0)
    s_barrier
    ds_read_b128 v[20:23], v15
    ds_read_b128 v[24:27], v15 offset:1024
    s_waitcnt lgkmcnt(0)
    v_add_f32 v20, v20, v21
    v_add_f32 v22, v22, v23
    v_add_f32 v20, v20, v22
    v_add_f32 v24, v24, v25
    v_add_f32 v26, v26, v27
    v_add_f32 v24, v24, v26
    v_mov_b32 v21, 0x1f800000
    v_mov_b32 v22, 0x5f800000
    v_cmp_nle_f32 vcc, v21, v20
    v_cmp_nle_f32 s[62:63], v21, v24
    v_cmp_nge_f32 s[64:65], v22, v20
    v_cmp_nge_f32 s[66:67], v22, v24
    s_nop 0
    s_or_b64 vcc, vcc, s[62:63]
    s_or_b64 s[64:65], s[64:65], s[66:67]
    s_or_b64 vcc, vcc, s[64:65]
    s_cbranch_scc0 L_k_Hok_30
    s_cmp_eq_u32 s39, 0
    s_cbranch_scc1 L_k_Hfb_31
L_k_Hok_30:
    s_barrier
    v_lshlrev_b32 v4, 2, v1
    s_mul_i32 s32, s61, 128
    s_mul_i32 s34, s35, 16
    s_add_u32 s32, s32, s34
    s_add_u32 s32, s32, 18894848
    s_mul_i32 s38, s61, 32768
    s_mul_i32 s34, s35, 8192
    s_add_u32 s38, s38, s34
    s_add_u32 s38, s38, 6291456
    s_mul_i32 s33, s35, 8192
    s_add_u32 s33, s33, 115456
    s_add_u32 s31, s35, 0
    s_and_b32 s31, s31, 3
    s_lshl_b32 s31, s31, 13
    s_add_u32 s31, s31, 115456
    v_add_u32 v68, s31, v2
    s_add_u32 s31, s35, 1
    s_and_b32 s31, s31, 3
    s_lshl_b32 s31, s31, 13
    s_add_u32 s31, s31, 115456
    v_add_u32 v69, s31, v2
    s_add_u32 s31, s35, 2
    s_and_b32 s31, s31, 3
    s_lshl_b32 s31, s31, 13
    s_add_u32 s31, s31, 115456
    v_add_u32 v70, s31, v2
    s_add_u32 s31, s35, 3
    s_and_b32 s31, s31, 3
    s_lshl_b32 s31, s31, 13
    s_add_u32 s31, s31, 115456
    v_add_u32 v71, s31, v2
    v_lshlrev_b32 v40, 16, v56
    v_and_b32 v41, 0xffff0000, v56
    v_lshlrev_b32 v42, 16, v57
    v_and_b32 v43, 0xffff0000, v57
    v_lshlrev_b32 v44, 16, v58
    v_and_b32 v45, 0xffff0000, v58
    v_lshlrev_b32 v46, 16, v59
    v_and_b32 v47, 0xffff0000, v59
    v_lshlrev_b32 v48, 16, v60
    v_and_b32 v49, 0xffff0000, v60
    v_lshlrev_b32 v50, 16, v61
    v_and_b32 v51, 0xffff0000, v61
    v_lshlrev_b32 v52, 16, v62
    v_and_b32 v53, 0xffff0000, v62
    v_lshlrev_b32 v54, 16, v63
    v_and_b32 v55, 0xffff0000, v63
    s_mov_b32 exec_lo, 0xf
    s_mov_b32 exec_hi, 0
    s_mov_b32 s26, 0
L_k_poll_32:
    buffer_load_dword v3, v4, s[20:23], s32 offen sc1
    s_add_u32 s26, s26, 1
    s_cmp_gt_u32 s26, 0x40000
    s_waitcnt vmcnt(0)
    s_cbranch_scc1 L_k_pd_33
    v_cmp_ne_u32 vcc, s24, v3
    s_cbranch_vccnz L_k_poll_32
L_k_pd_33:
    s_cmp_eq_u32 s25, 0
    s_cbranch_scc1 L_k_pf_34
    buffer_inv sc1
    s_waitcnt vmcnt(0)
L_k_pf_34:
    s_mov_b64 exec, -1
    s_add_u32 m0, s33, 0
    s_add_u32 s31, s38, 0
    buffer_load_dwordx4 v2, s[20:23], s31 offen offset:0 sc1 lds
    buffer_load_dwordx4 v2, s[20:23], s31 offen offset:1024 sc1 lds
    buffer_load_dwordx4 v2, s[20:23], s31 offen offset:2048 sc1 lds
    buffer_load_dwordx4 v2, s[20:23], s31 offen offset:3072 sc1 lds
    s_add_u32 m0, s33, 4096
    s_add_u32 s31, s38, 4096
    buffer_load_dwordx4 v2, s[20:23], s31 offen offset:0 sc1 lds
    buffer_load_dwordx4 v2, s[20:23], s31 offen offset:1024 sc1 lds
    buffer_load_dwordx4 v2, s[20:23], s31 offen offset:2048 sc1 lds
    buffer_load_dwordx4 v2, s[20:23], s31 offen offset:3072 sc1 lds
    s_waitcnt vmcnt(4)
    ds_read_b128 v[16:19], v68 offset:0
    ds_read_b128 v[20:23], v68 offset:1024
    ds_read_b128 v[24:27], v68 offset:2048
    ds_read_b128 v[28:31], v68 offset:3072
    s_waitcnt vmcnt(0)
    ds_read_b128 v[32:35], v68 offset:4096
    s_waitcnt lgkmcnt(4)
    v_mfma_f32_32x32x16_bf16 v[40:55], v[72:75], v[16:19], v[40:55]
    ds_read_b128 v[36:39], v68 offset:5120
    s_waitcnt lgkmcnt(4)
    v_mfma_f32_32x32x16_bf16 v[40:55], v[76:79], v[20:23], v[40:55]
    ds_read_b128 v[16:19], v68 offset:6144
    s_waitcnt lgkmcnt(4)
    v_mfma_f32_32x32x16_bf16 v[40:55], v[80:83], v[24:27], v[40:55]
    ds_read_b128 v[20:23], v68 offset:7168
    s_waitcnt lgkmcnt(4)
    v_mfma_f32_32x32x16_bf16 v[40:55], v[84:87], v[28:31], v[40:55]
    s_waitcnt lgkmcnt(3)
    v_mfma_f32_32x32x16_bf16 v[40:55], v[88:91], v[32:35], v[40:55]
    s_waitcnt lgkmcnt(2)
    v_mfma_f32_32x32x16_bf16 v[40:55], v[92:95], v[36:39], v[40:55]
    s_barrier
    ds_read_b128 v[24:27], v69 offset:0
    ds_read_b128 v[28:31], v69 offset:1024
    ds_read_b128 v[32:35], v69 offset:2048
    s_waitcnt lgkmcnt(4)
    v_mfma_f32_32x32x16_bf16 v[40:55], v[96:99], v[16:19], v[40:55]
    ds_read_b128 v[36:39], v69 offset:3072
    s_waitcnt lgkmcnt(4)
    v_mfma_f32_32x32x16_bf16 v[40:55], v[100:103], v[20:23], v[40:55]
    ds_read_b128 v[16:19], v69 offset:4096
    s_waitcnt lgkmcnt(4)
    v_mfma_f32_32x32x16_bf16 v[40:55], v[104:107], v[24:27], v[40:55]
    ds_read_b128 v[20:23], v69 offset:5120
    s_waitcnt lgkmcnt(4)
    v_mfma_f32_32x32x16_bf16 v[40:55], v[108:111], v[28:31], v[40:55]
    ds_read_b128 v[24:27], v69 offset:6144
    s_waitcnt lgkmcnt(4)
    v_mfma_f32_32x32x16_bf16 v[40:55], v[112:115], v[32:35], v[40:55]
    ds_read_b128 v[28:31], v69 offset:7168
    s_waitcnt lgkmcnt(4)
    v_mfma_f32_32x32x16_bf16 v[40:55], v[116:119], v[36:39], v[40:55]
    ds_read_b128 v[32:35], v70 offset:0
    s_waitcnt lgkmcnt(4)
    v_mfma_f32_32x32x16_bf16 v[40:55], v[120:123], v[16:19], v[40:55]
    ds_read_b128 v[36:39], v70 offset:1024
    s_waitcnt lgkmcnt(4)
    v_mfma_f32_32x32x16_bf16 v[40:55], v[124:127], v[20:23], v[40:55]
    ds_read_b128 v[16:19], v70 offset:2048
    s_waitcnt lgkmcnt(4)
    v_mfma_f32_32x32x16_bf16 v[40:55], v[128:131], v[24:27], v[40:55]
    ds_read_b128 v[20:23], v70 offset:3072
    s_waitcnt lgkmcnt(4)
    v_mfma_f32_32x32x16_bf16 v[40:55], v[132:135], v[28:31], v[40:55]
    ds_read_b128 v[24:27], v70 offset:4096
    s_waitcnt lgkmcnt(4)
    v_mfma_f32_32x32x16_bf16 v[40:55], v[136:139], v[32:35], v[40:55]
    ds_read_b128 v[28:31], v70 offset:5120
    s_waitcnt lgkmcnt(4)
    v_mfma_f32_32x32x16_bf16 v[40:55], v[140:143], v[36:39], v[40:55]
    ds_read_b128 v[32:35], v70 offset:6144
    s_waitcnt lgkmcnt(4)
    v_mfma_f32_32x32x16_bf16 v[40:55], v[144:147], v[16:19], v[40:55]
    ds_read_b128 v[36:39], v70 offset:7168
    s_waitcnt lgkmcnt(4)
    v_mfma_f32_32x32x16_bf16 v[40:55], v[148:151], v[20:23], v[40:55]
    ds_read_b128 v[16:19], v71 offset:0
    s_waitcnt lgkmcnt(4)
    v_mfma_f32_32x32x16_bf16 v[40:55], v[152:155], v[24:27], v[40:55]
    ds_read_b128 v[20:23], v71 offset:1024
    s_waitcnt lgkmcnt(4)
    v_mfma_f32_32x32x16_bf16 v[40:55], v[156:159], v[28:31], v[40:55]
    ds_read_b128 v[24:27], v71 offset:2048
    s_waitcnt lgkmcnt(4)
    v_mfma_f32_32x32x16_bf16 v[40:55], v[160:163], v[32:35], v[40:55]
    ds_read_b128 v[28:31], v71 offset:3072
    s_waitcnt lgkmcnt(4)
    v_mfma_f32_32x32x16_bf16 v[40:55], v[164:167], v[36:39], v[40:55]
    ds_read_b128 v[32:35], v71 offset:4096
    s_waitcnt lgkmcnt(4)
    v_mfma_f32_32x32x16_bf16 v[40:55], v[168:171], v[16:19], v[40:55]
    ds_read_b128 v[36:39], v71 offset:5120
    s_waitcnt lgkmcnt(4)
    v_mfma_f32_32x32x16_bf16 v[40:55], v[172:175], v[20:23], v[40:55]
    ds_read_b128 v[16:19], v71 offset:6144
    s_waitcnt lgkmcnt(4)
    v_mfma_f32_32x32x16_bf16 v[40:55], v[176:179], v[24:27], v[40:55]
    ds_read_b128 v[20:23], v71 offset:7168
    s_waitcnt lgkmcnt(4)
    v_mfma_f32_32x32x16_bf16 v[40:55], v[180:183], v[28:31], v[40:55]
    s_waitcnt lgkmcnt(3)
    v_mfma_f32_32x32x16_bf16 v[40:55], v[184:187], v[32:35], v[40:55]
    s_waitcnt lgkmcnt(2)
    v_mfma_f32_32x32x16_bf16 v[40:55], v[188:191], v[36:39], v[40:55]
    s_waitcnt lgkmcnt(1)
    v_mfma_f32_32x32x16_bf16 v[40:55], v[192:195], v[16:19], v[40:55]
    s_waitcnt lgkmcnt(0)
    v_mfma_f32_32x32x16_bf16 v[40:55], v[196:199], v[20:23], v[40:55]
    s_cmp_lg_u32 s2, 0
    s_cbranch_scc1 L_k_noep_35
    v_mov_b32 v3, s24
    s_mov_b32 s31, 18874368
    buffer_store_dword v3, off, s[20:23], s31 sc1
L_k_noep_35:
    s_and_b32 s38, s60, 1
    s_mul_i32 s32, s61, 28672
    s_mul_i32 s34, s60, 7168
    s_add_u32 s32, s32, s34
    s_mul_i32 s34, s35, 2048
    s_add_u32 s32, s32, s34
    s_mul_i32 s34, s38, -1024
    s_add_u32 s32, s32, s34
    s_add_u32 s32, s32, 8388608
    s_lshl_b32 s4, s38, 2
    s_add_u32 s4, s4, s35
    s_lshr_b32 s31, s35, 1
    s_and_b32 s38, s35, 1
    s_mul_i32 s33, s61, 4096
    s_mul_i32 s34, s60, 1024
    s_add_u32 s33, s33, s34
    s_mul_i32 s34, s31, 512
    s_add_u32 s33, s33, s34
    s_mul_i32 s34, s38, 8
    s_add_u32 s33, s33, s34
    s_add_u32 s33, s33, 19660800
    v_mov_b32 v64, 0
    v_mov_b32 v65, 0
    v_mov_b32 v66, 0
    v_mov_b32 v67, 0
    s_cmp_eq_u32 s4, 4
    s_cbranch_scc1 L_k_C3_36
    v_cvt_pk_bf16_f32 v56, v40, v41
    v_cvt_pk_bf16_f32 v57, v42, v43
    v_cvt_pk_bf16_f32 v58, v44, v45
    v_cvt_pk_bf16_f32 v59, v46, v47
    buffer_store_dwordx4 v[56:59], v2, s[20:23], s32 offen offset:0
    v_add_f32 v64, v64, v40
    v_fmac_f32 v65, v40, v40
    v_add_f32 v66, v66, v41
    v_fmac_f32 v67, v41, v41
    v_add_f32 v64, v64, v42
    v_fmac_f32 v65, v42, v42
    v_add_f32 v66, v66, v43
    v_fmac_f32 v67, v43, v43
    v_add_f32 v64, v64, v44
    v_fmac_f32 v65, v44, v44
    v_add_f32 v66, v66, v45
    v_fmac_f32 v67, v45, v45
    v_add_f32 v64, v64, v46
    v_fmac_f32 v65, v46, v46
    v_add_f32 v66, v66, v47
    v_fmac_f32 v67, v47, v47
L_k_C3_36:
    s_cmp_eq_u32 s4, 3
    s_cbranch_scc1 L_k_C3_37
    v_cvt_pk_bf16_f32 v60, v48, v49
    v_cvt_pk_bf16_f32 v61, v50, v51
    v_cvt_pk_bf16_f32 v62, v52, v53
    v_cvt_pk_bf16_f32 v63, v54, v55
    buffer_store_dwordx4 v[60:63], v2, s[20:23], s32 offen offset:1024
    v_add_f32 v64, v64, v48
    v_fmac_f32 v65, v48, v48
    v_add_f32 v66, v66, v49
    v_fmac_f32 v67, v49, v49
    v_add_f32 v64, v64, v50
    v_fmac_f32 v65, v50, v50
    v_add_f32 v66, v66, v51
    v_fmac_f32 v67, v51, v51
    v_add_f32 v64, v64, v52
    v_fmac_f32 v65, v52, v52
    v_add_f32 v66, v66, v53
    v_fmac_f32 v67, v53, v53
    v_add_f32 v64, v64, v54
    v_fmac_f32 v65, v54, v54
    v_add_f32 v66, v66, v55
    v_fmac_f32 v67, v55, v55
L_k_C3_37:
    v_add_f32 v64, v64, v66
    v_add_f32 v65, v65, v67
    v_mov_b32 v66, v64
    v_mov_b32 v67, v65
    s_nop 0
    v_permlane32_swap_b32 v64, v66
    v_permlane32_swap_b32 v65, v67
    s_mov_b32 exec_hi, 0
    v_add_f32 v64, v64, v66
    v_add_f32 v65, v65, v67
    buffer_store_dwordx2 v[64:65], v2, s[20:23], s33 offen
    s_mul_i32 s32, s61, 128
    s_mul_i32 s34, s60, 16
    s_add_u32 s32, s32, s34
    s_mul_i32 s34, s35, 4
    s_add_u32 s32, s32, s34
    s_add_u32 s32, s32, 18907136
    v_mov_b32 v3, s24
    s_waitcnt vmcnt(0)
    s_mov_b64 exec, 1
    s_cmp_lg_u32 s25, 0
    s_cbranch_scc1 L_k_sl_38
    buffer_store_dword v3, off, s[20:23], s32
    s_branch L_k_sj_39
L_k_sl_38:
    buffer_wbl2 sc1
    s_waitcnt vmcnt(0)
    buffer_store_dword v3, off, s[20:23], s32 sc1
L_k_sj_39:
    s_mov_b64 exec, -1
    s_barrier
    s_setprio 0
    v_lshrrev_b32 v3, 5, v1
    v_mul_u32_u24 v52, 896, v3
    v_bfe_u32 v3, v1, 4, 1
    v_mul_u32_u24 v3, 14496, v3
    v_add_u32 v52, v52, v3
    v_and_b32 v3, 3, v1
    v_lshl_add_u32 v52, v3, 3, v52
    v_bfe_u32 v3, v1, 2, 2
    v_lshl_add_u32 v53, v3, 5, v52
    v_mul_u32_u24 v3, 192, v3
    v_add_u32 v52, v52, v3
    s_mul_i32 s31, s35, 3584
    s_add_u32 s31, s31, 86496
    s_mul_i32 s32, s35, 4096
    s_add_u32 s32, s32, 149504
    v_add_u32 v52, s31, v52
    v_add_u32 v53, s31, v53
    v_lshl_add_u32 v54, v1, 2, s32
    v_mov_b32 v4, 0x3f803f80
    v_lshrrev_b32 v3, 2, v1
    v_xor_b32 v3, v3, v1
    v_and_b32 v3, 4, v3
    v_cmp_eq_u32 vcc, 0, v3
    s_nop 1
    v_cndmask_b32 v48, 0, v4, vcc
    v_cndmask_b32 v49, 0, v4, vcc
    v_cndmask_b32 v50, 0, v4, vcc
    v_cndmask_b32 v51, 0, v4, vcc
    ds_read_b32 v20, v54 offset:0
    v_mov_b32 v21, 0
    v_mov_b32 v22, 0
    v_mov_b32 v23, 0
    ds_read_b32 v24, v54 offset:256
    v_mov_b32 v25, 0
    v_mov_b32 v26, 0
    v_mov_b32 v27, 0
    ds_read_b32 v28, v54 offset:512
    v_mov_b32 v29, 0
    v_mov_b32 v30, 0
    v_mov_b32 v31, 0
    ds_read_b32 v32, v54 offset:768
    v_mov_b32 v33, 0
    v_mov_b32 v34, 0
    v_mov_b32 v35, 0
    ds_read_b32 v36, v54 offset:1024
    v_mov_b32 v37, 0
    v_mov_b32 v38, 0
    v_mov_b32 v39, 0
    ds_read_b32 v40, v54 offset:1280
    v_mov_b32 v41, 0
    v_mov_b32 v42, 0
    v_mov_b32 v43, 0
    ds_read_b32 v44, v54 offset:1536
    v_mov_b32 v45, 0
    v_mov_b32 v46, 0
    v_mov_b32 v47, 0
    s_waitcnt lgkmcnt(0)
    s_cmp_ge_u32 s30, 14
    s_cbranch_scc1 L_k_noE_40
    s_and_b32 s31, s30, 1
    s_mul_i32 s61, s29, 4
    s_mul_i32 s34, s31, 2
    s_add_u32 s61, s61, s34
    s_mul_i32 s39, s35, 7168
    s_mul_i32 s60, s35, 4096
    s_add_u32 s60, s60, 147456
    v_add_u32 v16, s60, v6
    v_add_u32 v17, s60, v7
    v_add_u32 v6, s39, v6
    v_add_u32 v7, s39, v7
    s_add_u32 m0, s60, 0
    s_add_u32 s31, s27, 100352
    buffer_load_dwordx4 v5, s[12:15], s31 offen  lds
    s_add_u32 m0, s60, 1024
    s_add_u32 s31, s27, 107520
    buffer_load_dwordx4 v5, s[12:15], s31 offen  lds
    s_add_u32 m0, s60, 2048
    s_add_u32 s31, s27, 114688
    buffer_load_dwordx4 v5, s[12:15], s31 offen  lds
    s_add_u32 m0, s60, 3072
    s_add_u32 s31, s27, 121856
    buffer_load_dwordx4 v5, s[12:15], s31 offen  lds
    s_waitcnt vmcnt(0)
    ds_read_b64_tr_b16 v[72:73], v16 offset:0
    ds_read_b64_tr_b16 v[74:75], v16 offset:1024
    ds_read_b64_tr_b16 v[76:77], v17 offset:0
    ds_read_b64_tr_b16 v[78:79], v17 offset:1024
    ds_read_b64_tr_b16 v[80:81], v16 offset:2048
    ds_read_b64_tr_b16 v[82:83], v16 offset:3072
    ds_read_b64_tr_b16 v[84:85], v17 offset:2048
    ds_read_b64_tr_b16 v[86:87], v17 offset:3072
    s_waitcnt lgkmcnt(0)
    s_add_u32 m0, s60, 0
    s_add_u32 s31, s27, 129024
    buffer_load_dwordx4 v5, s[12:15], s31 offen  lds
    s_add_u32 m0, s60, 1024
    s_add_u32 s31, s27, 136192
    buffer_load_dwordx4 v5, s[12:15], s31 offen  lds
    s_add_u32 m0, s60, 2048
    s_add_u32 s31, s27, 143360
    buffer_load_dwordx4 v5, s[12:15], s31 offen  lds
    s_add_u32 m0, s60, 3072
    s_add_u32 s31, s27, 150528
    buffer_load_dwordx4 v5, s[12:15], s31 offen  lds
    s_barrier
    s_waitcnt vmcnt(0)
    ds_read_b64_tr_b16 v[88:89], v16 offset:0
    ds_read_b64_tr_b16 v[90:91], v16 offset:1024
    ds_read_b64_tr_b16 v[92:93], v17 offset:0
    ds_read_b64_tr_b16 v[94:95], v17 offset:1024
    ds_read_b64_tr_b16 v[96:97], v16 offset:2048
    ds_read_b64_tr_b16 v[98:99], v16 offset:3072
    ds_read_b64_tr_b16 v[100:101], v17 offset:2048
    ds_read_b64_tr_b16 v[102:103], v17 offset:3072
    s_waitcnt lgkmcnt(0)
    s_add_u32 m0, s60, 0
    s_add_u32 s31, s27, 157696
    buffer_load_dwordx4 v5, s[12:15], s31 offen  lds
    s_add_u32 m0, s60, 1024
    s_add_u32 s31, s27, 164864
    buffer_load_dwordx4 v5, s[12:15], s31 offen  lds
    s_add_u32 m0, s60, 2048
    s_add_u32 s31, s27, 172032
    buffer_load_dwordx4 v5, s[12:15], s31 offen  lds
    s_add_u32 m0, s60, 3072
    s_add_u32 s31, s27, 179200
    buffer_load_dwordx4 v5, s[12:15], s31 offen  lds
    s_barrier
    s_add_u32 m0, s37, 0
    s_add_u32 s31, s36, 1146880
    buffer_load_dwordx4 v8, s[16:19], s31 offen  lds
    s_add_u32 m0, s37, 1024
    s_add_u32 s31, s36, 1146880
    buffer_load_dwordx4 v9, s[16:19], s31 offen  lds
    s_add_u32 m0, s37, 2048
    s_add_u32 s31, s36, 1146880
    buffer_load_dwordx4 v10, s[16:19], s31 offen  lds
    s_add_u32 m0, s37, 3072
    s_add_u32 s31, s36, 1146880
    buffer_load_dwordx4 v11, s[16:19], s31 offen  lds
    s_add_u32 m0, s37, 4096
    s_add_u32 s31, s36, 1146880
    buffer_load_dwordx4 v12, s[16:19], s31 offen  lds
    s_add_u32 m0, s37, 5120
    s_add_u32 s31, s36, 1146880
    buffer_load_dwordx4 v13, s[16:19], s31 offen  lds
    s_add_u32 m0, s37, 6144
    s_add_u32 s31, s36, 1146880
    buffer_load_dwordx4 v14, s[16:19], s31 offen  lds
    s_setprio 2
    ds_read_b64_tr_b16 v[128:129], v52 offset:28832
    ds_read_b64_tr_b16 v[130:131], v52 offset:30624
    ds_read_b64_tr_b16 v[132:133], v52 offset:28864
    ds_read_b64_tr_b16 v[134:135], v52 offset:30656
    ds_read_b64_tr_b16 v[136:137], v52 offset:28896
    ds_read_b64_tr_b16 v[138:139], v52 offset:30688
    ds_read_b64_tr_b16 v[140:141], v52 offset:28928
    ds_read_b64_tr_b16 v[142:143], v52 offset:30720
    ds_read_b64_tr_b16 v[144:145], v52 offset:28960
    ds_read_b64_tr_b16 v[146:147], v52 offset:30752
    ds_read_b64_tr_b16 v[148:149], v52 offset:28992
    ds_read_b64_tr_b16 v[150:151], v52 offset:30784
    ds_read_b64_tr_b16 v[152:153], v53 offset:29600
    ds_read_b64_tr_b16 v[154:155], v53 offset:31392
    s_waitcnt lgkmcnt(0)
    v_mfma_f32_16x16x32_bf16 v[20:23], v[48:51], v[128:131], v[20:23]
    v_mfma_f32_16x16x32_bf16 v[24:27], v[48:51], v[132:135], v[24:27]
    v_mfma_f32_16x16x32_bf16 v[28:31], v[48:51], v[136:139], v[28:31]
    v_mfma_f32_16x16x32_bf16 v[32:35], v[48:51], v[140:143], v[32:35]
    v_mfma_f32_16x16x32_bf16 v[36:39], v[48:51], v[144:147], v[36:39]
    v_mfma_f32_16x16x32_bf16 v[40:43], v[48:51], v[148:151], v[40:43]
    v_mfma_f32_16x16x32_bf16 v[44:47], v[48:51], v[152:155], v[44:47]
    s_setprio 0
    s_waitcnt vmcnt(7)
    ds_read_b64_tr_b16 v[104:105], v16 offset:0
    ds_read_b64_tr_b16 v[106:107], v16 offset:1024
    ds_read_b64_tr_b16 v[108:109], v17 offset:0
    ds_read_b64_tr_b16 v[110:111], v17 offset:1024
    ds_read_b64_tr_b16 v[112:113], v16 offset:2048
    ds_read_b64_tr_b16 v[114:115], v16 offset:3072
    ds_read_b64_tr_b16 v[116:117], v17 offset:2048
    ds_read_b64_tr_b16 v[118:119], v17 offset:3072
    s_waitcnt lgkmcnt(0)
    s_add_u32 m0, s60, 0
    s_add_u32 s31, s27, 186368
    buffer_load_dwordx4 v5, s[12:15], s31 offen  lds
    s_add_u32 m0, s60, 1024
    s_add_u32 s31, s27, 193536
    buffer_load_dwordx4 v5, s[12:15], s31 offen  lds
    s_barrier
    s_add_u32 m0, s37, 28832
    s_add_u32 s31, s36, 1376256
    buffer_load_dwordx4 v8, s[16:19], s31 offen  lds
    s_add_u32 m0, s37, 29856
    s_add_u32 s31, s36, 1376256
    buffer_load_dwordx4 v9, s[16:19], s31 offen  lds
    s_add_u32 m0, s37, 30880
    s_add_u32 s31, s36, 1376256
    buffer_load_dwordx4 v10, s[16:19], s31 offen  lds
    s_add_u32 m0, s37, 31904
    s_add_u32 s31, s36, 1376256
    buffer_load_dwordx4 v11, s[16:19], s31 offen  lds
    s_add_u32 m0, s37, 32928
    s_add_u32 s31, s36, 1376256
    buffer_load_dwordx4 v12, s[16:19], s31 offen  lds
    s_add_u32 m0, s37, 33952
    s_add_u32 s31, s36, 1376256
    buffer_load_dwordx4 v13, s[16:19], s31 offen  lds
    s_add_u32 m0, s37, 34976
    s_add_u32 s31, s36, 1376256
    buffer_load_dwordx4 v14, s[16:19], s31 offen  lds
    s_waitcnt vmcnt(7)
    ds_read_b64_tr_b16 v[120:121], v16 offset:0
    ds_read_b64_tr_b16 v[122:123], v16 offset:1024
    ds_read_b64_tr_b16 v[124:125], v17 offset:0
    ds_read_b64_tr_b16 v[126:127], v17 offset:1024
    s_waitcnt lgkmcnt(0)
    s_add_u32 m0, s39, 57664
    s_add_u32 s31, s27, 200704
    buffer_load_dwordx4 v5, s[12:15], s31 offen  lds
    s_add_u32 m0, s39, 58688
    s_add_u32 s31, s27, 207872
    buffer_load_dwordx4 v5, s[12:15], s31 offen  lds
    s_add_u32 m0, s39, 59712
    s_add_u32 s31, s27, 215040
    buffer_load_dwordx4 v5, s[12:15], s31 offen  lds
    s_add_u32 m0, s39, 60736
    s_add_u32 s31, s27, 222208
    buffer_load_dwordx4 v5, s[12:15], s31 offen  lds
    s_add_u32 m0, s39, 61760
    s_add_u32 s31, s27, 229376
    buffer_load_dwordx4 v5, s[12:15], s31 offen  lds
    s_add_u32 m0, s39, 62784
    s_add_u32 s31, s27, 236544
    buffer_load_dwordx4 v5, s[12:15], s31 offen  lds
    s_add_u32 m0, s39, 63808
    s_add_u32 s31, s27, 243712
    buffer_load_dwordx4 v5, s[12:15], s31 offen  lds
    s_waitcnt vmcnt(16)
    s_barrier
    s_setprio 2
    v_add_u32 v52, 4294880800, v52
    v_add_u32 v53, 4294880800, v53
    ds_read_b64_tr_b16 v[128:129], v52 offset:0
    ds_read_b64_tr_b16 v[130:131], v52 offset:1792
    ds_read_b64_tr_b16 v[132:133], v52 offset:32
    ds_read_b64_tr_b16 v[134:135], v52 offset:1824
    ds_read_b64_tr_b16 v[136:137], v52 offset:64
    ds_read_b64_tr_b16 v[138:139], v52 offset:1856
    ds_read_b64_tr_b16 v[140:141], v52 offset:96
    ds_read_b64_tr_b16 v[142:143], v52 offset:1888
    ds_read_b64_tr_b16 v[144:145], v52 offset:128
    ds_read_b64_tr_b16 v[146:147], v52 offset:1920
    ds_read_b64_tr_b16 v[148:149], v52 offset:160
    ds_read_b64_tr_b16 v[150:151], v52 offset:1952
    ds_read_b64_tr_b16 v[152:153], v53 offset:768
    ds_read_b64_tr_b16 v[154:155], v53 offset:2560
    s_waitcnt lgkmcnt(0)
    v_mfma_f32_16x16x32_bf16 v[20:23], v[48:51], v[128:131], v[20:23]
    v_mfma_f32_16x16x32_bf16 v[24:27], v[48:51], v[132:135], v[24:27]
    v_mfma_f32_16x16x32_bf16 v[28:31], v[48:51], v[136:139], v[28:31]
    v_mfma_f32_16x16x32_bf16 v[32:35], v[48:51], v[140:143], v[32:35]
    v_mfma_f32_16x16x32_bf16 v[36:39], v[48:51], v[144:147], v[36:39]
    v_mfma_f32_16x16x32_bf16 v[40:43], v[48:51], v[148:151], v[40:43]
    v_mfma_f32_16x16x32_bf16 v[44:47], v[48:51], v[152:155], v[44:47]
    s_setprio 0
    s_add_u32 m0, s39, 86496
    s_add_u32 s31, s27, 250880
    buffer_load_dwordx4 v5, s[12:15], s31 offen  lds
    s_add_u32 m0, s39, 87520
    s_add_u32 s31, s27, 258048
    buffer_load_dwordx4 v5, s[12:15], s31 offen  lds
    s_add_u32 m0, s39, 88544
    s_add_u32 s31, s27, 265216
    buffer_load_dwordx4 v5, s[12:15], s31 offen  lds
    s_add_u32 m0, s39, 89568
    s_add_u32 s31, s27, 272384
    buffer_load_dwordx4 v5, s[12:15], s31 offen  lds
    s_add_u32 m0, s39, 90592
    s_add_u32 s31, s27, 279552
    buffer_load_dwordx4 v5, s[12:15], s31 offen  lds
    s_add_u32 m0, s39, 91616
    s_add_u32 s31, s27, 286720
    buffer_load_dwordx4 v5, s[12:15], s31 offen  lds
    s_add_u32 m0, s39, 92640
    s_add_u32 s31, s27, 293888
    buffer_load_dwordx4 v5, s[12:15], s31 offen  lds
    s_waitcnt vmcnt(14)
    s_barrier
    s_setprio 2
    ds_read_b64_tr_b16 v[128:129], v52 offset:28832
    ds_read_b64_tr_b16 v[130:131], v52 offset:30624
    ds_read_b64_tr_b16 v[132:133], v52 offset:28864
    ds_read_b64_tr_b16 v[134:135], v52 offset:30656
    ds_read_b64_tr_b16 v[136:137], v52 offset:28896
    ds_read_b64_tr_b16 v[138:139], v52 offset:30688
    ds_read_b64_tr_b16 v[140:141], v52 offset:28928
    ds_read_b64_tr_b16 v[142:143], v52 offset:30720
    ds_read_b64_tr_b16 v[144:145], v52 offset:28960
    ds_read_b64_tr_b16 v[146:147], v52 offset:30752
    ds_read_b64_tr_b16 v[148:149], v52 offset:28992
    ds_read_b64_tr_b16 v[150:151], v52 offset:30784
    ds_read_b64_tr_b16 v[152:153], v53 offset:29600
    ds_read_b64_tr_b16 v[154:155], v53 offset:31392
    s_waitcnt lgkmcnt(0)
    v_mfma_f32_16x16x32_bf16 v[20:23], v[48:51], v[128:131], v[20:23]
    v_mfma_f32_16x16x32_bf16 v[24:27], v[48:51], v[132:135], v[24:27]
    v_mfma_f32_16x16x32_bf16 v[28:31], v[48:51], v[136:139], v[28:31]
    v_mfma_f32_16x16x32_bf16 v[32:35], v[48:51], v[140:143], v[32:35]
    v_mfma_f32_16x16x32_bf16 v[36:39], v[48:51], v[144:147], v[36:39]
    v_mfma_f32_16x16x32_bf16 v[40:43], v[48:51], v[148:151], v[40:43]
    v_mfma_f32_16x16x32_bf16 v[44:47], v[48:51], v[152:155], v[44:47]
    s_setprio 0
    s_lshr_b32 s31, s35, 1
    s_and_b32 s32, s35, 1
    s_mul_i32 s31, s31, 512
    s_mul_i32 s34, s32, 8
    s_add_u32 s31, s31, s34
    s_add_u32 s31, s31, 147456
    s_setprio 2
    v_add_u32 v4, s31, v2
    s_mov_b32 exec_hi, 0
    v_cvt_pk_bf16_f32 v23, v20, 0
    v_lshlrev_b32 v21, 16, v23
    v_sub_f32 v21, v20, v21
    v_cvt_pk_bf16_f32 v22, v20, v21
    ds_write_b64 v4, v[22:23] offset:0
    v_cvt_pk_bf16_f32 v27, v24, 0
    v_lshlrev_b32 v25, 16, v27
    v_sub_f32 v25, v24, v25
    v_cvt_pk_bf16_f32 v26, v24, v25
    ds_write_b64 v4, v[26:27] offset:1024
    v_cvt_pk_bf16_f32 v31, v28, 0
    v_lshlrev_b32 v29, 16, v31
    v_sub_f32 v29, v28, v29
    v_cvt_pk_bf16_f32 v30, v28, v29
    ds_write_b64 v4, v[30:31] offset:2048
    v_cvt_pk_bf16_f32 v35, v32, 0
    v_lshlrev_b32 v33, 16, v35
    v_sub_f32 v33, v32, v33
    v_cvt_pk_bf16_f32 v34, v32, v33
    ds_write_b64 v4, v[34:35] offset:3072
    v_cvt_pk_bf16_f32 v39, v36, 0
    v_lshlrev_b32 v37, 16, v39
    v_sub_f32 v37, v36, v37
    v_cvt_pk_bf16_f32 v38, v36, v37
    ds_write_b64 v4, v[38:39] offset:4096
    v_cvt_pk_bf16_f32 v43, v40, 0
    v_lshlrev_b32 v41, 16, v43
    v_sub_f32 v41, v40, v41
    v_cvt_pk_bf16_f32 v42, v40, v41
    ds_write_b64 v4, v[42:43] offset:5120
    v_cvt_pk_bf16_f32 v47, v44, 0
    v_lshlrev_b32 v45, 16, v47
    v_sub_f32 v45, v44, v45
    v_cvt_pk_bf16_f32 v46, v44, v45
    ds_write_b64 v4, v[46:47] offset:6144
    s_mov_b32 exec_hi, -1
    s_waitcnt lgkmcnt(0)
    s_add_u32 m0, s39, 115328
    s_add_u32 s31, s27, 301056
    buffer_load_dwordx4 v5, s[12:15], s31 offen  lds
    s_add_u32 m0, s39, 116352
    s_add_u32 s31, s27, 308224
    buffer_load_dwordx4 v5, s[12:15], s31 offen  lds
    s_add_u32 m0, s39, 117376
    s_add_u32 s31, s27, 315392
    buffer_load_dwordx4 v5, s[12:15], s31 offen  lds
    s_add_u32 m0, s39, 118400
    s_add_u32 s31, s27, 322560
    buffer_load_dwordx4 v5, s[12:15], s31 offen  lds
    s_add_u32 m0, s39, 119424
    s_add_u32 s31, s27, 329728
    buffer_load_dwordx4 v5, s[12:15], s31 offen  lds
    s_add_u32 m0, s39, 120448
    s_add_u32 s31, s27, 336896
    buffer_load_dwordx4 v5, s[12:15], s31 offen  lds
    s_add_u32 m0, s39, 121472
    s_add_u32 s31, s27, 344064
    buffer_load_dwordx4 v5, s[12:15], s31 offen  lds
    s_barrier
    s_add_u32 m0, s39, 0
    s_add_u32 s31, s27, 351232
    buffer_load_dwordx4 v5, s[12:15], s31 offen  lds
    s_add_u32 m0, s39, 1024
    s_add_u32 s31, s27, 358400
    buffer_load_dwordx4 v5, s[12:15], s31 offen  lds
    s_add_u32 m0, s39, 2048
    s_add_u32 s31, s27, 365568
    buffer_load_dwordx4 v5, s[12:15], s31 offen  lds
    s_add_u32 m0, s39, 3072
    s_add_u32 s31, s27, 372736
    buffer_load_dwordx4 v5, s[12:15], s31 offen  lds
    s_add_u32 m0, s39, 4096
    s_add_u32 s31, s27, 379904
    buffer_load_dwordx4 v5, s[12:15], s31 offen  lds
    s_add_u32 m0, s39, 5120
    s_add_u32 s31, s27, 387072
    buffer_load_dwordx4 v5, s[12:15], s31 offen  lds
    s_add_u32 m0, s39, 6144
    s_add_u32 s31, s27, 394240
    buffer_load_dwordx4 v5, s[12:15], s31 offen  lds
    s_lshr_b32 s31, s35, 1
    s_add_u32 s32, s61, s31
    s_xor_b32 s33, s32, 1
    s_and_b32 s31, s35, 1
    s_mul_i32 s62, s32, 114688
    s_mul_i32 s34, s35, 28672
    s_add_u32 s62, s62, s34
    s_add_u32 s62, s62, 10485760
    s_mul_i32 s63, s33, 114688
    s_mul_i32 s34, s35, 28672
    s_add_u32 s63, s63, s34
    s_add_u32 s63, s63, 10485760
    s_mul_i32 s33, s32, 28672
    s_mul_i32 s34, s3, 4096
    s_add_u32 s33, s33, s34
    s_mul_i32 s34, s31, 2048
    s_add_u32 s33, s33, s34
    s_add_u32 s33, s33, 8388608
    s_mul_i32 s60, s32, 28672
    s_mul_i32 s34, s3, 128
    s_add_u32 s60, s60, s34
    s_mul_i32 s34, s31, 64
    s_add_u32 s60, s60, s34
    buffer_load_dwordx4 v[192:195], v2, s[20:23], s33 offen offset:0 sc1
    buffer_load_dwordx4 v[196:199], v2, s[20:23], s33 offen offset:1024 sc1
    s_mul_i32 s33, s32, 4096
    s_add_u32 s33, s33, 19660800
    buffer_load_dwordx4 v[128:131], v2, s[20:23], s33 offen offset:0 sc1
    buffer_load_dwordx4 v[132:135], v2, s[20:23], s33 offen offset:1024 sc1
    buffer_load_dwordx4 v[136:139], v2, s[20:23], s33 offen offset:2048 sc1
    buffer_load_dwordx4 v[140:143], v2, s[20:23], s33 offen offset:3072 sc1
    s_barrier
    s_mul_i32 s27, s60, 1
    s_mov_b32 s12, s54
    s_mov_b32 s13, s55
    s_mov_b32 s14, 1835008
    s_mov_b32 s15, 0x20000
    v_and_b32 v4, 3, v1
    v_lshlrev_b32 v4, 2, v4
    v_bfe_u32 v3, v1, 2, 1
    v_lshl_add_u32 v4, v3, 7, v4
    s_mul_i32 s32, s61, 128
    s_mul_i32 s34, s35, 16
    s_add_u32 s32, s32, s34
    s_add_u32 s32, s32, 18919424
    s_waitcnt vmcnt(0)
    v_add_f32 v128, v128, v136
    v_add_f32 v129, v129, v137
    v_add_f32 v130, v130, v138
    v_add_f32 v131, v131, v139
    v_add_f32 v132, v132, v140
    v_add_f32 v133, v133, v141
    v_add_f32 v134, v134, v142
    v_add_f32 v135, v135, v143
    v_add_f32 v128, v128, v132
    v_add_f32 v129, v129, v133
    v_add_f32 v130, v130, v134
    v_add_f32 v131, v131, v135
    v_add_f32 v128, v128, v130
    v_add_f32 v129, v129, v131
    v_mov_b32 v3, v128
    s_nop 1
    v_permlane32_swap_b32 v128, v3
    s_nop 1
    v_add_f32 v128, v128, v3
    v_mov_b32 v3, v129
    s_nop 1
    v_permlane32_swap_b32 v129, v3
    s_nop 1
    v_add_f32 v129, v129, v3
    v_mul_f32 v128, 0xbb124925, v128
    v_mul_f32 v129, 0x3b124925, v129
    v_fma_f32 v129, -v128, v128, v129
    v_max_f32 v129, 0, v129
    v_add_f32 v129, 0x3727c5ac, v129
    v_rcp_f32 v0, v129
    v_add_u32 v5, 57664, v7
    s_mov_b32 exec_lo, 0xff
    s_mov_b32 exec_hi, 0
    s_mov_b32 s26, 0
L_k_poll_42:
    buffer_load_dword v3, v4, s[20:23], s32 offen sc1
    s_add_u32 s26, s26, 1
    s_cmp_gt_u32 s26, 0x40000
    s_waitcnt vmcnt(0)
    s_cbranch_scc1 L_k_pd_43
    v_cmp_ne_u32 vcc, s24, v3
    s_cbranch_vccnz L_k_poll_42
L_k_pd_43:
    s_cmp_eq_u32 s25, 0
    s_cbranch_scc1 L_k_pf_44
    buffer_inv sc1
    s_waitcnt vmcnt(0)
L_k_pf_44:
    s_mov_b64 exec, -1
    v_add_u32 v4, 57664, v6
    buffer_load_dwordx4 v[128:131], v2, s[20:23], s62 offen offset:0 sc1
    buffer_load_dwordx4 v[132:135], v2, s[20:23], s63 offen offset:0 sc1
    buffer_load_dwordx4 v[136:139], v2, s[20:23], s62 offen offset:1024 sc1
    buffer_load_dwordx4 v[140:143], v2, s[20:23], s63 offen offset:1024 sc1
    buffer_load_dwordx4 v[144:147], v2, s[20:23], s62 offen offset:2048 sc1
    buffer_load_dwordx4 v[148:151], v2, s[20:23], s63 offen offset:2048 sc1
    s_waitcnt vmcnt(4)
    v_mfma_f32_32x32x16_bf16 v[56:71], v[204:207], v[132:135], 0
    buffer_load_dwordx4 v[152:155], v2, s[20:23], s62 offen offset:3072 sc1
    buffer_load_dwordx4 v[156:159], v2, s[20:23], s63 offen offset:3072 sc1
    s_add_u32 s62, s62, 4096
    v_mfma_f32_32x32x16_bf16 v[24:39], v[204:207], v[128:131], 0
    s_add_u32 s63, s63, 4096
    buffer_load_dwordx4 v[160:163], v2, s[20:23], s62 offen offset:0 sc1
    buffer_load_dwordx4 v[164:167], v2, s[20:23], s63 offen offset:0 sc1
    v_mfma_f32_32x32x16_bf16 v[40:55], v[200:203], v[132:135], 0
    v_mfma_f32_32x32x16_bf16 v[8:23], v[200:203], v[128:131], 0
    s_waitcnt vmcnt(6)
    v_mfma_f32_32x32x16_bf16 v[56:71], v[212:215], v[140:143], v[56:71]
    buffer_load_dwordx4 v[168:171], v2, s[20:23], s62 offen offset:1024 sc1
    buffer_load_dwordx4 v[172:175], v2, s[20:23], s63 offen offset:1024 sc1
    buffer_load_dwordx4 v[176:179], v2, s[20:23], s62 offen offset:2048 sc1
    v_mfma_f32_32x32x16_bf16 v[24:39], v[212:215], v[136:139], v[24:39]
    buffer_load_dwordx4 v[180:183], v2, s[20:23], s63 offen offset:2048 sc1
    ds_read_b64_tr_b16 v[200:201], v4 offset:0
    ds_read_b64_tr_b16 v[202:203], v4 offset:1024
    v_mfma_f32_32x32x16_bf16 v[40:55], v[208:211], v[140:143], v[40:55]
    ds_read_b64_tr_b16 v[204:205], v5 offset:0
    ds_read_b64_tr_b16 v[206:207], v5 offset:1024
    v_mfma_f32_32x32x16_bf16 v[8:23], v[208:211], v[136:139], v[8:23]
    s_waitcnt vmcnt(8)
    v_mfma_f32_32x32x16_bf16 v[56:71], v[220:223], v[148:151], v[56:71]
    buffer_load_dwordx4 v[184:187], v2, s[20:23], s62 offen offset:3072 sc1
    buffer_load_dwordx4 v[188:191], v2, s[20:23], s63 offen offset:3072 sc1
    s_add_u32 s62, s62, 4096
    v_mfma_f32_32x32x16_bf16 v[24:39], v[220:223], v[144:147], v[24:39]
    s_add_u32 s63, s63, 4096
    ds_read_b64_tr_b16 v[208:209], v4 offset:2048
    ds_read_b64_tr_b16 v[210:211], v4 offset:3072
    v_mfma_f32_32x32x16_bf16 v[40:55], v[216:219], v[148:151], v[40:55]
    ds_read_b64_tr_b16 v[212:213], v5 offset:2048
    ds_read_b64_tr_b16 v[214:215], v5 offset:3072
    v_mfma_f32_32x32x16_bf16 v[8:23], v[216:219], v[144:147], v[8:23]
    s_waitcnt vmcnt(8)
    v_mfma_f32_32x32x16_bf16 v[56:71], v[228:231], v[156:159], v[56:71]
    buffer_load_dwordx4 v[128:131], v2, s[20:23], s62 offen offset:0 sc1
    buffer_load_dwordx4 v[132:135], v2, s[20:23], s63 offen offset:0 sc1
    ds_read_b64_tr_b16 v[216:217], v4 offset:4096
    v_mfma_f32_32x32x16_bf16 v[24:39], v[228:231], v[152:155], v[24:39]
    ds_read_b64_tr_b16 v[218:219], v4 offset:5120
    ds_read_b64_tr_b16 v[220:221], v5 offset:4096
    ds_read_b64_tr_b16 v[222:223], v5 offset:5120
    v_mfma_f32_32x32x16_bf16 v[40:55], v[224:227], v[156:159], v[40:55]
    v_mfma_f32_32x32x16_bf16 v[8:23], v[224:227], v[152:155], v[8:23]
    s_waitcnt vmcnt(8)
    v_mfma_f32_32x32x16_bf16 v[56:71], v[236:239], v[164:167], v[56:71]
    buffer_load_dwordx4 v[136:139], v2, s[20:23], s62 offen offset:1024 sc1
    buffer_load_dwordx4 v[140:143], v2, s[20:23], s63 offen offset:1024 sc1
    ds_read_b64_tr_b16 v[224:225], v4 offset:6144
    v_mfma_f32_32x32x16_bf16 v[24:39], v[236:239], v[160:163], v[24:39]
    ds_read_b64_tr_b16 v[226:227], v4 offset:28832
    ds_read_b64_tr_b16 v[228:229], v5 offset:6144
    ds_read_b64_tr_b16 v[230:231], v5 offset:28832
    v_mfma_f32_32x32x16_bf16 v[40:55], v[232:235], v[164:167], v[40:55]
    v_mfma_f32_32x32x16_bf16 v[8:23], v[232:235], v[160:163], v[8:23]
    s_waitcnt vmcnt(8)
    v_mfma_f32_32x32x16_bf16 v[56:71], v[244:247], v[172:175], v[56:71]
    buffer_load_dwordx4 v[144:147], v2, s[20:23], s62 offen offset:2048 sc1
    buffer_load_dwordx4 v[148:151], v2, s[20:23], s63 offen offset:2048 sc1
    ds_read_b64_tr_b16 v[232:233], v4 offset:29856
    v_mfma_f32_32x32x16_bf16 v[24:39], v[244:247], v[168:171], v[24:39]
    ds_read_b64_tr_b16 v[234:235], v4 offset:30880
    ds_read_b64_tr_b16 v[236:237], v5 offset:29856
    ds_read_b64_tr_b16 v[238:239], v5 offset:30880
    v_mfma_f32_32x32x16_bf16 v[40:55], v[240:243], v[172:175], v[40:55]
    v_mfma_f32_32x32x16_bf16 v[8:23], v[240:243], v[168:171], v[8:23]
    s_waitcnt vmcnt(8)
    v_mfma_f32_32x32x16_bf16 v[56:71], v[252:255], v[180:183], v[56:71]
    buffer_load_dwordx4 v[152:155], v2, s[20:23], s62 offen offset:3072 sc1
    buffer_load_dwordx4 v[156:159], v2, s[20:23], s63 offen offset:3072 sc1
    s_add_u32 s62, s62, 4096
    v_mfma_f32_32x32x16_bf16 v[24:39], v[252:255], v[176:179], v[24:39]
    s_add_u32 s63, s63, 4096
    ds_read_b64_tr_b16 v[240:241], v4 offset:31904
    ds_read_b64_tr_b16 v[242:243], v4 offset:32928
    v_mfma_f32_32x32x16_bf16 v[40:55], v[248:251], v[180:183], v[40:55]
    ds_read_b64_tr_b16 v[244:245], v5 offset:31904
    ds_read_b64_tr_b16 v[246:247], v5 offset:32928
    v_mfma_f32_32x32x16_bf16 v[8:23], v[248:251], v[176:179], v[8:23]
    s_waitcnt vmcnt(8)
    v_mfma_f32_32x32x16_bf16 v[56:71], v[76:79], v[188:191], v[56:71]
    buffer_load_dwordx4 v[160:163], v2, s[20:23], s62 offen offset:0 sc1
    buffer_load_dwordx4 v[164:167], v2, s[20:23], s63 offen offset:0 sc1
    ds_read_b64_tr_b16 v[248:249], v4 offset:33952
    v_mfma_f32_32x32x16_bf16 v[24:39], v[76:79], v[184:187], v[24:39]
    ds_read_b64_tr_b16 v[250:251], v4 offset:34976
    ds_read_b64_tr_b16 v[252:253], v5 offset:33952
    ds_read_b64_tr_b16 v[254:255], v5 offset:34976
    v_mfma_f32_32x32x16_bf16 v[40:55], v[72:75], v[188:191], v[40:55]
    v_mfma_f32_32x32x16_bf16 v[8:23], v[72:75], v[184:187], v[8:23]
    s_waitcnt vmcnt(8)
    v_mfma_f32_32x32x16_bf16 v[56:71], v[84:87], v[132:135], v[56:71]
    buffer_load_dwordx4 v[168:171], v2, s[20:23], s62 offen offset:1024 sc1
    buffer_load_dwordx4 v[172:175], v2, s[20:23], s63 offen offset:1024 sc1
    ds_read_b64_tr_b16 v[72:73], v4 offset:57664
    v_mfma_f32_32x32x16_bf16 v[24:39], v[84:87], v[128:131], v[24:39]
    ds_read_b64_tr_b16 v[74:75], v4 offset:58688
    ds_read_b64_tr_b16 v[76:77], v5 offset:57664
    ds_read_b64_tr_b16 v[78:79], v5 offset:58688
    v_mfma_f32_32x32x16_bf16 v[40:55], v[80:83], v[132:135], v[40:55]
    v_mfma_f32_32x32x16_bf16 v[8:23], v[80:83], v[128:131], v[8:23]
    s_waitcnt vmcnt(8)
    v_mfma_f32_32x32x16_bf16 v[56:71], v[92:95], v[140:143], v[56:71]
    buffer_load_dwordx4 v[176:179], v2, s[20:23], s62 offen offset:2048 sc1
    buffer_load_dwordx4 v[180:183], v2, s[20:23], s63 offen offset:2048 sc1
    ds_read_b64_tr_b16 v[80:81], v4 offset:59712
    v_mfma_f32_32x32x16_bf16 v[24:39], v[92:95], v[136:139], v[24:39]
    ds_read_b64_tr_b16 v[82:83], v4 offset:60736
    ds_read_b64_tr_b16 v[84:85], v5 offset:59712
    ds_read_b64_tr_b16 v[86:87], v5 offset:60736
    v_mfma_f32_32x32x16_bf16 v[40:55], v[88:91], v[140:143], v[40:55]
    v_mfma_f32_32x32x16_bf16 v[8:23], v[88:91], v[136:139], v[8:23]
    s_waitcnt vmcnt(8)
    v_mfma_f32_32x32x16_bf16 v[56:71], v[100:103], v[148:151], v[56:71]
    buffer_load_dwordx4 v[184:187], v2, s[20:23], s62 offen offset:3072 sc1
    buffer_load_dwordx4 v[188:191], v2, s[20:23], s63 offen offset:3072 sc1
    s_add_u32 s62, s62, 4096
    v_mfma_f32_32x32x16_bf16 v[24:39], v[100:103], v[144:147], v[24:39]
    s_add_u32 s63, s63, 4096
    ds_read_b64_tr_b16 v[88:89], v4 offset:61760
    ds_read_b64_tr_b16 v[90:91], v4 offset:62784
    v_mfma_f32_32x32x16_bf16 v[40:55], v[96:99], v[148:151], v[40:55]
    ds_read_b64_tr_b16 v[92:93], v5 offset:61760
    ds_read_b64_tr_b16 v[94:95], v5 offset:62784
    v_mfma_f32_32x32x16_bf16 v[8:23], v[96:99], v[144:147], v[8:23]
    s_waitcnt vmcnt(8)
    v_mfma_f32_32x32x16_bf16 v[56:71], v[108:111], v[156:159], v[56:71]
    buffer_load_dwordx4 v[128:131], v2, s[20:23], s62 offen offset:0 sc1
    buffer_load_dwordx4 v[132:135], v2, s[20:23], s63 offen offset:0 sc1
    ds_read_b64_tr_b16 v[96:97], v4 offset:63808
    v_mfma_f32_32x32x16_bf16 v[24:39], v[108:111], v[152:155], v[24:39]
    ds_read_b64_tr_b16 v[98:99], v6 offset:0
    ds_read_b64_tr_b16 v[100:101], v5 offset:63808
    ds_read_b64_tr_b16 v[102:103], v7 offset:0
    v_mfma_f32_32x32x16_bf16 v[40:55], v[104:107], v[156:159], v[40:55]
    v_mfma_f32_32x32x16_bf16 v[8:23], v[104:107], v[152:155], v[8:23]
    s_waitcnt vmcnt(8)
    v_mfma_f32_32x32x16_bf16 v[56:71], v[116:119], v[164:167], v[56:71]
    buffer_load_dwordx4 v[136:139], v2, s[20:23], s62 offen offset:1024 sc1
    buffer_load_dwordx4 v[140:143], v2, s[20:23], s63 offen offset:1024 sc1
    ds_read_b64_tr_b16 v[104:105], v6 offset:1024
    v_mfma_f32_32x32x16_bf16 v[24:39], v[116:119], v[160:163], v[24:39]
    ds_read_b64_tr_b16 v[106:107], v6 offset:2048
    ds_read_b64_tr_b16 v[108:109], v7 offset:1024
    ds_read_b64_tr_b16 v[110:111], v7 offset:2048
    v_mfma_f32_32x32x16_bf16 v[40:55], v[112:115], v[164:167], v[40:55]
    v_mfma_f32_32x32x16_bf16 v[8:23], v[112:115], v[160:163], v[8:23]
    s_waitcnt vmcnt(8)
    v_mfma_f32_32x32x16_bf16 v[56:71], v[124:127], v[172:175], v[56:71]
    buffer_load_dwordx4 v[144:147], v2, s[20:23], s62 offen offset:2048 sc1
    buffer_load_dwordx4 v[148:151], v2, s[20:23], s63 offen offset:2048 sc1
    ds_read_b64_tr_b16 v[112:113], v6 offset:3072
    v_mfma_f32_32x32x16_bf16 v[24:39], v[124:127], v[168:171], v[24:39]
    ds_read_b64_tr_b16 v[114:115], v6 offset:4096
    ds_read_b64_tr_b16 v[116:117], v7 offset:3072
    ds_read_b64_tr_b16 v[118:119], v7 offset:4096
    v_mfma_f32_32x32x16_bf16 v[40:55], v[120:123], v[172:175], v[40:55]
    v_mfma_f32_32x32x16_bf16 v[8:23], v[120:123], v[168:171], v[8:23]
    s_waitcnt vmcnt(8) lgkmcnt(0)
    v_mfma_f32_32x32x16_bf16 v[56:71], v[204:207], v[180:183], v[56:71]
    buffer_load_dwordx4 v[152:155], v2, s[20:23], s62 offen offset:3072 sc1
    buffer_load_dwordx4 v[156:159], v2, s[20:23], s63 offen offset:3072 sc1
    s_add_u32 s62, s62, 4096
    v_mfma_f32_32x32x16_bf16 v[24:39], v[204:207], v[176:179], v[24:39]
    s_add_u32 s63, s63, 4096
    ds_read_b64_tr_b16 v[120:121], v6 offset:5120
    ds_read_b64_tr_b16 v[122:123], v6 offset:6144
    v_mfma_f32_32x32x16_bf16 v[40:55], v[200:203], v[180:183], v[40:55]
    ds_read_b64_tr_b16 v[124:125], v7 offset:5120
    ds_read_b64_tr_b16 v[126:127], v7 offset:6144
    v_mfma_f32_32x32x16_bf16 v[8:23], v[200:203], v[176:179], v[8:23]
    s_waitcnt vmcnt(8) lgkmcnt(0)
    v_mfma_f32_32x32x16_bf16 v[56:71], v[212:215], v[188:191], v[56:71]
    buffer_load_dwordx4 v[160:163], v2, s[20:23], s62 offen offset:0 sc1
    buffer_load_dwordx4 v[164:167], v2, s[20:23], s63 offen offset:0 sc1
    v_mfma_f32_32x32x16_bf16 v[24:39], v[212:215], v[184:187], v[24:39]
    v_mfma_f32_32x32x16_bf16 v[40:55], v[208:211], v[188:191], v[40:55]
    v_mfma_f32_32x32x16_bf16 v[8:23], v[208:211], v[184:187], v[8:23]
    s_waitcnt vmcnt(8)
    v_mfma_f32_32x32x16_bf16 v[56:71], v[220:223], v[132:135], v[56:71]
    buffer_load_dwordx4 v[168:171], v2, s[20:23], s62 offen offset:1024 sc1
    buffer_load_dwordx4 v[172:175], v2, s[20:23], s63 offen offset:1024 sc1
    v_mfma_f32_32x32x16_bf16 v[24:39], v[220:223], v[128:131], v[24:39]
    v_mfma_f32_32x32x16_bf16 v[40:55], v[216:219], v[132:135], v[40:55]
    v_mfma_f32_32x32x16_bf16 v[8:23], v[216:219], v[128:131], v[8:23]
    s_waitcnt vmcnt(8)
    v_mfma_f32_32x32x16_bf16 v[56:71], v[228:231], v[140:143], v[56:71]
    buffer_load_dwordx4 v[176:179], v2, s[20:23], s62 offen offset:2048 sc1
    buffer_load_dwordx4 v[180:183], v2, s[20:23], s63 offen offset:2048 sc1
    v_mfma_f32_32x32x16_bf16 v[24:39], v[228:231], v[136:139], v[24:39]
    v_mfma_f32_32x32x16_bf16 v[40:55], v[224:227], v[140:143], v[40:55]
    v_mfma_f32_32x32x16_bf16 v[8:23], v[224:227], v[136:139], v[8:23]
    s_waitcnt vmcnt(8)
    v_mfma_f32_32x32x16_bf16 v[56:71], v[236:239], v[148:151], v[56:71]
    buffer_load_dwordx4 v[184:187], v2, s[20:23], s62 offen offset:3072 sc1
    buffer_load_dwordx4 v[188:191], v2, s[20:23], s63 offen offset:3072 sc1
    s_add_u32 s62, s62, 4096
    v_mfma_f32_32x32x16_bf16 v[24:39], v[236:239], v[144:147], v[24:39]
    s_add_u32 s63, s63, 4096
    v_mfma_f32_32x32x16_bf16 v[40:55], v[232:235], v[148:151], v[40:55]
    v_mfma_f32_32x32x16_bf16 v[8:23], v[232:235], v[144:147], v[8:23]
    s_waitcnt vmcnt(8)
    v_mfma_f32_32x32x16_bf16 v[56:71], v[244:247], v[156:159], v[56:71]
    buffer_load_dwordx4 v[128:131], v2, s[20:23], s62 offen offset:0 sc1
    buffer_load_dwordx4 v[132:135], v2, s[20:23], s63 offen offset:0 sc1
    v_mfma_f32_32x32x16_bf16 v[24:39], v[244:247], v[152:155], v[24:39]
    v_mfma_f32_32x32x16_bf16 v[40:55], v[240:243], v[156:159], v[40:55]
    v_mfma_f32_32x32x16_bf16 v[8:23], v[240:243], v[152:155], v[8:23]
    s_waitcnt vmcnt(8)
    v_mfma_f32_32x32x16_bf16 v[56:71], v[252:255], v[164:167], v[56:71]
    buffer_load_dwordx4 v[136:139], v2, s[20:23], s62 offen offset:1024 sc1
    buffer_load_dwordx4 v[140:143], v2, s[20:23], s63 offen offset:1024 sc1
    v_mfma_f32_32x32x16_bf16 v[24:39], v[252:255], v[160:163], v[24:39]
    v_mfma_f32_32x32x16_bf16 v[40:55], v[248:251], v[164:167], v[40:55]
    v_mfma_f32_32x32x16_bf16 v[8:23], v[248:251], v[160:163], v[8:23]
    s_waitcnt vmcnt(8)
    v_mfma_f32_32x32x16_bf16 v[56:71], v[76:79], v[172:175], v[56:71]
    buffer_load_dwordx4 v[144:147], v2, s[20:23], s62 offen offset:2048 sc1
    buffer_load_dwordx4 v[148:151], v2, s[20:23], s63 offen offset:2048 sc1
    v_mfma_f32_32x32x16_bf16 v[24:39], v[76:79], v[168:171], v[24:39]
    v_mfma_f32_32x32x16_bf16 v[40:55], v[72:75], v[172:175], v[40:55]
    v_mfma_f32_32x32x16_bf16 v[8:23], v[72:75], v[168:171], v[8:23]
    s_waitcnt vmcnt(8)
    v_mfma_f32_32x32x16_bf16 v[56:71], v[84:87], v[180:183], v[56:71]
    buffer_load_dwordx4 v[152:155], v2, s[20:23], s62 offen offset:3072 sc1
    buffer_load_dwordx4 v[156:159], v2, s[20:23], s63 offen offset:3072 sc1
    s_add_u32 s62, s62, 4096
    v_mfma_f32_32x32x16_bf16 v[24:39], v[84:87], v[176:179], v[24:39]
    s_add_u32 s63, s63, 4096
    v_mfma_f32_32x32x16_bf16 v[40:55], v[80:83], v[180:183], v[40:55]
    v_mfma_f32_32x32x16_bf16 v[8:23], v[80:83], v[176:179], v[8:23]
    s_waitcnt vmcnt(8)
    v_mfma_f32_32x32x16_bf16 v[56:71], v[92:95], v[188:191], v[56:71]
    v_mfma_f32_32x32x16_bf16 v[24:39], v[92:95], v[184:187], v[24:39]
    v_mfma_f32_32x32x16_bf16 v[40:55], v[88:91], v[188:191], v[40:55]
    v_mfma_f32_32x32x16_bf16 v[8:23], v[88:91], v[184:187], v[8:23]
    s_waitcnt vmcnt(6)
    v_mfma_f32_32x32x16_bf16 v[56:71], v[100:103], v[132:135], v[56:71]
    v_mfma_f32_32x32x16_bf16 v[24:39], v[100:103], v[128:131], v[24:39]
    v_mfma_f32_32x32x16_bf16 v[40:55], v[96:99], v[132:135], v[40:55]
    v_mfma_f32_32x32x16_bf16 v[8:23], v[96:99], v[128:131], v[8:23]
    s_waitcnt vmcnt(4)
    v_mfma_f32_32x32x16_bf16 v[56:71], v[108:111], v[140:143], v[56:71]
    v_mfma_f32_32x32x16_bf16 v[24:39], v[108:111], v[136:139], v[24:39]
    v_mfma_f32_32x32x16_bf16 v[40:55], v[104:107], v[140:143], v[40:55]
    v_mfma_f32_32x32x16_bf16 v[8:23], v[104:107], v[136:139], v[8:23]
    s_waitcnt vmcnt(2)
    v_mfma_f32_32x32x16_bf16 v[56:71], v[116:119], v[148:151], v[56:71]
    v_mfma_f32_32x32x16_bf16 v[24:39], v[116:119], v[144:147], v[24:39]
    v_mfma_f32_32x32x16_bf16 v[40:55], v[112:115], v[148:151], v[40:55]
    v_mfma_f32_32x32x16_bf16 v[8:23], v[112:115], v[144:147], v[8:23]
    s_waitcnt vmcnt(0)
    v_mfma_f32_32x32x16_bf16 v[56:71], v[124:127], v[156:159], v[56:71]
    v_mfma_f32_32x32x16_bf16 v[24:39], v[124:127], v[152:155], v[24:39]
    v_mfma_f32_32x32x16_bf16 v[40:55], v[120:123], v[156:159], v[40:55]
    v_mfma_f32_32x32x16_bf16 v[8:23], v[120:123], v[152:155], v[8:23]
    v_add_u32 v3, s39, v2
    v_add_u32 v3, 57664, v3
    s_xor_b32 s31, s35, 1
    s_mul_i32 s31, s31, 7168
    s_add_u32 s31, s31, 57664
    v_add_u32 v5, s31, v2
    s_xor_b32 s31, s35, 2
    s_mul_i32 s31, s31, 7168
    s_add_u32 s31, s31, 86496
    v_add_u32 v6, s31, v2
    s_xor_b32 s31, s35, 3
    s_mul_i32 s31, s31, 7168
    s_add_u32 s31, s31, 115328
    v_add_u32 v7, s31, v2
    ds_write_b128 v3, v[56:59] offset:57664
    ds_write_b128 v3, v[60:63] offset:58688
    ds_write_b128 v3, v[64:67] offset:59712
    ds_write_b128 v3, v[68:71] offset:60736
    ds_write_b128 v3, v[24:27] offset:0
    ds_write_b128 v3, v[28:31] offset:1024
    ds_write_b128 v3, v[32:35] offset:2048
    ds_write_b128 v3, v[36:39] offset:3072
    ds_write_b128 v3, v[40:43] offset:28832
    ds_write_b128 v3, v[44:47] offset:29856
    ds_write_b128 v3, v[48:51] offset:30880
    ds_write_b128 v3, v[52:55] offset:31904
    v_and_b32 v3, 31, v1
    v_mul_u32_u24 v4, 896, v3
    v_lshrrev_b32 v3, 5, v1
    v_lshl_add_u32 v4, v3, 4, v4
    v_lshlrev_b32 v144, 16, v192
    v_and_b32 v145, 0xffff0000, v192
    v_lshlrev_b32 v146, 16, v193
    v_and_b32 v147, 0xffff0000, v193
    v_lshlrev_b32 v148, 16, v194
    v_and_b32 v149, 0xffff0000, v194
    v_lshlrev_b32 v150, 16, v195
    v_and_b32 v151, 0xffff0000, v195
    v_lshlrev_b32 v152, 16, v196
    v_and_b32 v153, 0xffff0000, v196
    v_lshlrev_b32 v154, 16, v197
    v_and_b32 v155, 0xffff0000, v197
    v_lshlrev_b32 v156, 16, v198
    v_and_b32 v157, 0xffff0000, v198
    v_lshlrev_b32 v158, 16, v199
    v_and_b32 v159, 0xffff0000, v199
    s_waitcnt lgkmcnt(0)
    s_barrier
    ds_read_b128 v[72:75], v5 offset:0
    ds_read_b128 v[88:91], v6 offset:0
    ds_read_b128 v[104:107], v7 offset:0
    ds_read_b128 v[76:79], v5 offset:1024
    ds_read_b128 v[92:95], v6 offset:1024
    ds_read_b128 v[108:111], v7 offset:1024
    ds_read_b128 v[80:83], v5 offset:2048
    ds_read_b128 v[96:99], v6 offset:2048
    ds_read_b128 v[112:115], v7 offset:2048
    ds_read_b128 v[84:87], v5 offset:3072
    ds_read_b128 v[100:103], v6 offset:3072
    ds_read_b128 v[116:119], v7 offset:3072
    s_waitcnt lgkmcnt(9)
    v_add_f32 v8, v8, v72
    v_add_f32 v88, v88, v104
    v_add_f32 v9, v9, v73
    v_add_f32 v89, v89, v105
    v_add_f32 v10, v10, v74
    v_add_f32 v90, v90, v106
    v_add_f32 v11, v11, v75
    v_add_f32 v91, v91, v107
    v_add_f32 v8, v8, v88
    v_add_f32 v9, v9, v89
    v_add_f32 v10, v10, v90
    v_add_f32 v11, v11, v91
    v_fma_f32 v8, v8, v0, v144
    v_fma_f32 v9, v9, v0, v145
    v_fma_f32 v10, v10, v0, v146
    v_fma_f32 v11, v11, v0, v147
    v_cvt_pk_bf16_f32 v128, v8, v9
    v_cvt_pk_bf16_f32 v129, v10, v11
    s_waitcnt lgkmcnt(6)
    v_add_f32 v12, v12, v76
    v_add_f32 v92, v92, v108
    v_add_f32 v13, v13, v77
    v_add_f32 v93, v93, v109
    v_add_f32 v14, v14, v78
    v_add_f32 v94, v94, v110
    v_add_f32 v15, v15, v79
    v_add_f32 v95, v95, v111
    v_add_f32 v12, v12, v92
    v_add_f32 v13, v13, v93
    v_add_f32 v14, v14, v94
    v_add_f32 v15, v15, v95
    v_fma_f32 v12, v12, v0, v148
    v_fma_f32 v13, v13, v0, v149
    v_fma_f32 v14, v14, v0, v150
    v_fma_f32 v15, v15, v0, v151
    v_cvt_pk_bf16_f32 v130, v12, v13
    v_cvt_pk_bf16_f32 v131, v14, v15
    s_nop 1
    v_permlane32_swap_b32 v128, v130
    v_permlane32_swap_b32 v129, v131
    buffer_store_dwordx4 v[128:131], v4, s[12:15], s27 offen offset:0
    s_waitcnt lgkmcnt(3)
    v_add_f32 v16, v16, v80
    v_add_f32 v96, v96, v112
    v_add_f32 v17, v17, v81
    v_add_f32 v97, v97, v113
    v_add_f32 v18, v18, v82
    v_add_f32 v98, v98, v114
    v_add_f32 v19, v19, v83
    v_add_f32 v99, v99, v115
    v_add_f32 v16, v16, v96
    v_add_f32 v17, v17, v97
    v_add_f32 v18, v18, v98
    v_add_f32 v19, v19, v99
    v_fma_f32 v16, v16, v0, v152
    v_fma_f32 v17, v17, v0, v153
    v_fma_f32 v18, v18, v0, v154
    v_fma_f32 v19, v19, v0, v155
    v_cvt_pk_bf16_f32 v132, v16, v17
    v_cvt_pk_bf16_f32 v133, v18, v19
    s_waitcnt lgkmcnt(0)
    v_add_f32 v20, v20, v84
    v_add_f32 v100, v100, v116
    v_add_f32 v21, v21, v85
    v_add_f32 v101, v101, v117
    v_add_f32 v22, v22, v86
    v_add_f32 v102, v102, v118
    v_add_f32 v23, v23, v87
    v_add_f32 v103, v103, v119
    v_add_f32 v20, v20, v100
    v_add_f32 v21, v21, v101
    v_add_f32 v22, v22, v102
    v_add_f32 v23, v23, v103
    v_fma_f32 v20, v20, v0, v156
    v_fma_f32 v21, v21, v0, v157
    v_fma_f32 v22, v22, v0, v158
    v_fma_f32 v23, v23, v0, v159
    v_cvt_pk_bf16_f32 v134, v20, v21
    v_cvt_pk_bf16_f32 v135, v22, v23
    s_nop 1
    v_permlane32_swap_b32 v132, v134
    v_permlane32_swap_b32 v133, v135
    buffer_store_dwordx4 v[132:135], v4, s[12:15], s27 offen offset:32
    s_branch L_k_Eend_41
L_k_noE_40:
    s_nop 0
    s_barrier
    s_barrier
    s_add_u32 m0, s37, 0
    s_add_u32 s31, s36, 1146880
    buffer_load_dwordx4 v8, s[16:19], s31 offen  lds
    s_add_u32 m0, s37, 1024
    s_add_u32 s31, s36, 1146880
    buffer_load_dwordx4 v9, s[16:19], s31 offen  lds
    s_add_u32 m0, s37, 2048
    s_add_u32 s31, s36, 1146880
    buffer_load_dwordx4 v10, s[16:19], s31 offen  lds
    s_add_u32 m0, s37, 3072
    s_add_u32 s31, s36, 1146880
    buffer_load_dwordx4 v11, s[16:19], s31 offen  lds
    s_add_u32 m0, s37, 4096
    s_add_u32 s31, s36, 1146880
    buffer_load_dwordx4 v12, s[16:19], s31 offen  lds
    s_add_u32 m0, s37, 5120
    s_add_u32 s31, s36, 1146880
    buffer_load_dwordx4 v13, s[16:19], s31 offen  lds
    s_add_u32 m0, s37, 6144
    s_add_u32 s31, s36, 1146880
    buffer_load_dwordx4 v14, s[16:19], s31 offen  lds
    s_setprio 2
    ds_read_b64_tr_b16 v[128:129], v52 offset:28832
    ds_read_b64_tr_b16 v[130:131], v52 offset:30624
    ds_read_b64_tr_b16 v[132:133], v52 offset:28864
    ds_read_b64_tr_b16 v[134:135], v52 offset:30656
    ds_read_b64_tr_b16 v[136:137], v52 offset:28896
    ds_read_b64_tr_b16 v[138:139], v52 offset:30688
    ds_read_b64_tr_b16 v[140:141], v52 offset:28928
    ds_read_b64_tr_b16 v[142:143], v52 offset:30720
    ds_read_b64_tr_b16 v[144:145], v52 offset:28960
    ds_read_b64_tr_b16 v[146:147], v52 offset:30752
    ds_read_b64_tr_b16 v[148:149], v52 offset:28992
    ds_read_b64_tr_b16 v[150:151], v52 offset:30784
    ds_read_b64_tr_b16 v[152:153], v53 offset:29600
    ds_read_b64_tr_b16 v[154:155], v53 offset:31392
    s_waitcnt lgkmcnt(0)
    v_mfma_f32_16x16x32_bf16 v[20:23], v[48:51], v[128:131], v[20:23]
    v_mfma_f32_16x16x32_bf16 v[24:27], v[48:51], v[132:135], v[24:27]
    v_mfma_f32_16x16x32_bf16 v[28:31], v[48:51], v[136:139], v[28:31]
    v_mfma_f32_16x16x32_bf16 v[32:35], v[48:51], v[140:143], v[32:35]
    v_mfma_f32_16x16x32_bf16 v[36:39], v[48:51], v[144:147], v[36:39]
    v_mfma_f32_16x16x32_bf16 v[40:43], v[48:51], v[148:151], v[40:43]
    v_mfma_f32_16x16x32_bf16 v[44:47], v[48:51], v[152:155], v[44:47]
    s_setprio 0
    s_barrier
    s_add_u32 m0, s37, 28832
    s_add_u32 s31, s36, 1376256
    buffer_load_dwordx4 v8, s[16:19], s31 offen  lds
    s_add_u32 m0, s37, 29856
    s_add_u32 s31, s36, 1376256
    buffer_load_dwordx4 v9, s[16:19], s31 offen  lds
    s_add_u32 m0, s37, 30880
    s_add_u32 s31, s36, 1376256
    buffer_load_dwordx4 v10, s[16:19], s31 offen  lds
    s_add_u32 m0, s37, 31904
    s_add_u32 s31, s36, 1376256
    buffer_load_dwordx4 v11, s[16:19], s31 offen  lds
    s_add_u32 m0, s37, 32928
    s_add_u32 s31, s36, 1376256
    buffer_load_dwordx4 v12, s[16:19], s31 offen  lds
    s_add_u32 m0, s37, 33952
    s_add_u32 s31, s36, 1376256
    buffer_load_dwordx4 v13, s[16:19], s31 offen  lds
    s_add_u32 m0, s37, 34976
    s_add_u32 s31, s36, 1376256
    buffer_load_dwordx4 v14, s[16:19], s31 offen  lds
    s_waitcnt vmcnt(7)
    s_barrier
    s_setprio 2
    v_add_u32 v52, 4294880800, v52
    v_add_u32 v53, 4294880800, v53
    ds_read_b64_tr_b16 v[128:129], v52 offset:0
    ds_read_b64_tr_b16 v[130:131], v52 offset:1792
    ds_read_b64_tr_b16 v[132:133], v52 offset:32
    ds_read_b64_tr_b16 v[134:135], v52 offset:1824
    ds_read_b64_tr_b16 v[136:137], v52 offset:64
    ds_read_b64_tr_b16 v[138:139], v52 offset:1856
    ds_read_b64_tr_b16 v[140:141], v52 offset:96
    ds_read_b64_tr_b16 v[142:143], v52 offset:1888
    ds_read_b64_tr_b16 v[144:145], v52 offset:128
    ds_read_b64_tr_b16 v[146:147], v52 offset:1920
    ds_read_b64_tr_b16 v[148:149], v52 offset:160
    ds_read_b64_tr_b16 v[150:151], v52 offset:1952
    ds_read_b64_tr_b16 v[152:153], v53 offset:768
    ds_read_b64_tr_b16 v[154:155], v53 offset:2560
    s_waitcnt lgkmcnt(0)
    v_mfma_f32_16x16x32_bf16 v[20:23], v[48:51], v[128:131], v[20:23]
    v_mfma_f32_16x16x32_bf16 v[24:27], v[48:51], v[132:135], v[24:27]
    v_mfma_f32_16x16x32_bf16 v[28:31], v[48:51], v[136:139], v[28:31]
    v_mfma_f32_16x16x32_bf16 v[32:35], v[48:51], v[140:143], v[32:35]
    v_mfma_f32_16x16x32_bf16 v[36:39], v[48:51], v[144:147], v[36:39]
    v_mfma_f32_16x16x32_bf16 v[40:43], v[48:51], v[148:151], v[40:43]
    v_mfma_f32_16x16x32_bf16 v[44:47], v[48:51], v[152:155], v[44:47]
    s_setprio 0
    s_waitcnt vmcnt(0)
    s_barrier
    s_setprio 2
    ds_read_b64_tr_b16 v[128:129], v52 offset:28832
    ds_read_b64_tr_b16 v[130:131], v52 offset:30624
    ds_read_b64_tr_b16 v[132:133], v52 offset:28864
    ds_read_b64_tr_b16 v[134:135], v52 offset:30656
    ds_read_b64_tr_b16 v[136:137], v52 offset:28896
    ds_read_b64_tr_b16 v[138:139], v52 offset:30688
    ds_read_b64_tr_b16 v[140:141], v52 offset:28928
    ds_read_b64_tr_b16 v[142:143], v52 offset:30720
    ds_read_b64_tr_b16 v[144:145], v52 offset:28960
    ds_read_b64_tr_b16 v[146:147], v52 offset:30752
    ds_read_b64_tr_b16 v[148:149], v52 offset:28992
    ds_read_b64_tr_b16 v[150:151], v52 offset:30784
    ds_read_b64_tr_b16 v[152:153], v53 offset:29600
    ds_read_b64_tr_b16 v[154:155], v53 offset:31392
    s_waitcnt lgkmcnt(0)
    v_mfma_f32_16x16x32_bf16 v[20:23], v[48:51], v[128:131], v[20:23]
    v_mfma_f32_16x16x32_bf16 v[24:27], v[48:51], v[132:135], v[24:27]
    v_mfma_f32_16x16x32_bf16 v[28:31], v[48:51], v[136:139], v[28:31]
    v_mfma_f32_16x16x32_bf16 v[32:35], v[48:51], v[140:143], v[32:35]
    v_mfma_f32_16x16x32_bf16 v[36:39], v[48:51], v[144:147], v[36:39]
    v_mfma_f32_16x16x32_bf16 v[40:43], v[48:51], v[148:151], v[40:43]
    v_mfma_f32_16x16x32_bf16 v[44:47], v[48:51], v[152:155], v[44:47]
    s_setprio 0
    s_lshr_b32 s31, s35, 1
    s_and_b32 s32, s35, 1
    s_mul_i32 s31, s31, 512
    s_mul_i32 s34, s32, 8
    s_add_u32 s31, s31, s34
    s_add_u32 s31, s31, 147456
    s_setprio 2
    v_add_u32 v4, s31, v2
    s_mov_b32 exec_hi, 0
    v_cvt_pk_bf16_f32 v23, v20, 0
    v_lshlrev_b32 v21, 16, v23
    v_sub_f32 v21, v20, v21
    v_cvt_pk_bf16_f32 v22, v20, v21
    ds_write_b64 v4, v[22:23] offset:0
    v_cvt_pk_bf16_f32 v27, v24, 0
    v_lshlrev_b32 v25, 16, v27
    v_sub_f32 v25, v24, v25
    v_cvt_pk_bf16_f32 v26, v24, v25
    ds_write_b64 v4, v[26:27] offset:1024
    v_cvt_pk_bf16_f32 v31, v28, 0
    v_lshlrev_b32 v29, 16, v31
    v_sub_f32 v29, v28, v29
    v_cvt_pk_bf16_f32 v30, v28, v29
    ds_write_b64 v4, v[30:31] offset:2048
    v_cvt_pk_bf16_f32 v35, v32, 0
    v_lshlrev_b32 v33, 16, v35
    v_sub_f32 v33, v32, v33
    v_cvt_pk_bf16_f32 v34, v32, v33
    ds_write_b64 v4, v[34:35] offset:3072
    v_cvt_pk_bf16_f32 v39, v36, 0
    v_lshlrev_b32 v37, 16, v39
    v_sub_f32 v37, v36, v37
    v_cvt_pk_bf16_f32 v38, v36, v37
    ds_write_b64 v4, v[38:39] offset:4096
    v_cvt_pk_bf16_f32 v43, v40, 0
    v_lshlrev_b32 v41, 16, v43
    v_sub_f32 v41, v40, v41
    v_cvt_pk_bf16_f32 v42, v40, v41
    ds_write_b64 v4, v[42:43] offset:5120
    v_cvt_pk_bf16_f32 v47, v44, 0
    v_lshlrev_b32 v45, 16, v47
    v_sub_f32 v45, v44, v45
    v_cvt_pk_bf16_f32 v46, v44, v45
    ds_write_b64 v4, v[46:47] offset:6144
    s_mov_b32 exec_hi, -1
    s_waitcnt lgkmcnt(0)
    s_barrier
    s_barrier
L_k_Eend_41:
    s_endpgm
L_k_main_2:
    s_setprio 1
    s_getpc_b64 s[4:5]
L_k_pc:
    s_sub_u32 s4, s4, L_k_pc - sequential_preLN__mha_block__glu_gated_reglu__prompt_kernel
    s_subb_u32 s5, s5, 0
    s_lshr_b32 s33, s2, 3
    s_lshl_b32 s33, s33, 2
    s_add_u32 s33, s33, s35
    s_and_b32 s33, s33, 31
    s_mul_i32 s33, s33, 1536
    v_lshl_add_u32 v4, v1, 7, s33
    v_min_u32 v4, L_k_end - sequential_preLN__mha_block__glu_gated_reglu__prompt_kernel - 4, v4
    s_mov_b64 exec, 4095
    global_load_dword v255, v4, s[4:5]
    s_mov_b64 exec, -1
    v_and_b32 v3, 31, v1
    s_lshl_b32 s31, s35, 5
    v_add_u32 v4, s31, v3
    v_lshlrev_b32 v4, 7, v4
    v_bfe_u32 v3, v1, 1, 3
    v_lshrrev_b32 v8, 5, v1
    v_xor_b32 v3, v3, v8
    v_xor_b32 v8, 0, v3
    v_lshl_add_u32 v8, v8, 4, v4
    v_xor_b32 v9, 2, v3
    v_lshl_add_u32 v9, v9, 4, v4
    v_xor_b32 v10, 4, v3
    v_lshl_add_u32 v10, v10, 4, v4
    v_xor_b32 v11, 6, v3
    v_lshl_add_u32 v11, v11, 4, v4
    v_bfe_u32 v5, v1, 2, 2
    v_lshrrev_b32 v12, 5, v1
    v_lshl_add_u32 v5, v12, 3, v5
    v_mul_u32_u24 v12, 64, v5
    v_bfe_u32 v5, v1, 4, 1
    v_mul_u32_u24 v5, 32, v5
    v_add_u32 v12, v12, v5
    v_and_b32 v5, 3, v1
    v_lshl_add_u32 v12, v5, 3, v12
    v_add_u32 v13, 49152, v12
    v_mov_b32 v7, 0x3f803f80
    v_lshrrev_b32 v5, 2, v1
    v_xor_b32 v5, v5, v1
    v_and_b32 v5, 4, v5
    v_cmp_eq_u32 vcc, 0, v5
    v_mov_b32 v36, 0
    v_mov_b32 v37, 0
    v_mov_b32 v38, 0
    v_mov_b32 v39, 0
    v_cndmask_b32 v16, 0, v7, vcc
    v_cndmask_b32 v17, 0, v7, vcc
    v_cndmask_b32 v18, 0, v7, vcc
    v_cndmask_b32 v19, 0, v7, vcc
    s_waitcnt lgkmcnt(0)
    s_add_u32 s4, s58, 18874368
    s_addc_u32 s5, s59, 0
    s_load_dword s24, s[4:5], 0
    s_mov_b32 s20, s58
    s_mov_b32 s21, s59
    s_mov_b32 s22, 20971520
    s_mov_b32 s23, 0x20000
    s_mov_b32 s8, s40
    s_mov_b32 s9, s41
    s_mov_b32 s10, 1835008
    s_mov_b32 s11, 0x20000
    s_mov_b32 s12, s42
    s_mov_b32 s13, s43
    s_mov_b32 s14, 1204224
    s_mov_b32 s15, 0x20000
    s_lshl_b32 s33, s2, 2
    s_add_u32 s33, s33, s35
    v_lshrrev_b32 v3, 1, v1
    v_and_b32 v4, 1, v1
    v_mul_u32_u24 v4, 896, v4
    v_lshl_add_u32 v4, v3, 7, v4
    s_mul_i32 s32, s33, 1792
    s_add_u32 s32, s32, 128
    s_mov_b64 exec, 4095
    buffer_load_dword v255, v4, s[8:11], s32 offen
    v_lshlrev_b32 v4, 17, v1
    s_mul_i32 s32, s33, 128
    s_add_u32 s32, s32, 172032
    buffer_load_dword v255, v4, s[12:15], s32 offen
    s_mov_b64 exec, -1
    s_mov_b64 exec, 1
    s_mul_i32 s32, s29, 262144
    s_mul_i32 s34, s30, 16384
    s_add_u32 s32, s32, s34
    s_mul_i32 s34, s35, 4096
    s_add_u32 s32, s32, s34
    s_add_u32 s32, s32, 2097152
    buffer_load_dword v255, off, s[20:23], s32 sc1
    s_mul_i32 s32, s30, 131072
    s_mul_i32 s34, s35, 32768
    s_add_u32 s32, s32, s34
    s_mul_i32 s34, s29, 2048
    s_add_u32 s32, s32, s34
    s_add_u32 s32, s32, 6291456
    buffer_load_dword v255, off, s[20:23], s32 sc1
    s_mul_i32 s32, s29, 458752
    s_mul_i32 s34, s35, 114688
    s_add_u32 s32, s32, s34
    s_mul_i32 s34, s30, 7168
    s_add_u32 s32, s32, s34
    s_add_u32 s32, s32, 10486784
    buffer_load_dword v255, off, s[20:23], s32 sc1
    s_mov_b64 exec, -1
    s_waitcnt lgkmcnt(0)
    s_mul_i32 s24, s24, 0x9E3779B1
    s_add_u32 s24, s24, 0x7F4A7C15
    s_mul_i32 s32, s29, 128
    s_mul_i32 s34, s30, 4
    s_add_u32 s32, s32, s34
    s_add_u32 s32, s32, 18878464
    s_cmp_lg_u32 s35, 0
    s_cbranch_scc1 L_k_hel_45
    s_getreg_b32 s31, hwreg(HW_REG_XCC_ID, 0, 4)
    s_xor_b32 s31, s31, s24
    v_mov_b32 v5, s31
    s_mov_b64 exec, 1
    buffer_store_dword v5, off, s[20:23], s32 sc1
    s_mov_b64 exec, -1
L_k_hel_45:
    s_barrier
    ds_read_b128 v[140:143], v8
    ds_read_b64_tr_b16 v[44:45], v12 offset:16384
    ds_read_b64_tr_b16 v[46:47], v12 offset:16640
    ds_read_b64_tr_b16 v[48:49], v12 offset:20480
    ds_read_b64_tr_b16 v[50:51], v12 offset:20736
    ds_read_b128 v[144:147], v9
    ds_read_b64_tr_b16 v[52:53], v12 offset:17408
    ds_read_b64_tr_b16 v[54:55], v12 offset:17664
    ds_read_b64_tr_b16 v[56:57], v12 offset:21504
    ds_read_b64_tr_b16 v[58:59], v12 offset:21760
    s_waitcnt lgkmcnt(5)
    v_mfma_f32_32x32x16_bf16 v[76:91], v[44:47], v[140:143], 0
    ds_read_b128 v[148:151], v10
    ds_read_b64_tr_b16 v[60:61], v12 offset:18432
    v_and_b32 v40, 0xffff0000, v140
    v_lshlrev_b32 v41, 16, v140
    v_fmac_f32 v36, v40, v40
    v_fmac_f32 v37, v41, v41
    v_and_b32 v42, 0xffff0000, v141
    v_lshlrev_b32 v43, 16, v141
    v_mfma_f32_32x32x16_bf16 v[92:107], v[140:143], v[48:51], 0
    ds_read_b64_tr_b16 v[62:63], v12 offset:18688
    ds_read_b64_tr_b16 v[64:65], v12 offset:22528
    v_fmac_f32 v38, v42, v42
    v_fmac_f32 v39, v43, v43
    v_and_b32 v40, 0xffff0000, v142
    v_lshlrev_b32 v41, 16, v142
    v_fmac_f32 v36, v40, v40
    v_fmac_f32 v37, v41, v41
    v_mfma_f32_16x16x32_bf16 v[20:23], v[16:19], v[140:143], 0
    ds_read_b64_tr_b16 v[66:67], v12 offset:22784
    v_and_b32 v42, 0xffff0000, v143
    v_lshlrev_b32 v43, 16, v143
    v_fmac_f32 v38, v42, v42
    v_fmac_f32 v39, v43, v43
    s_waitcnt lgkmcnt(5)
    v_mfma_f32_32x32x16_bf16 v[76:91], v[52:55], v[144:147], v[76:91]
    ds_read_b128 v[152:155], v11
    ds_read_b64_tr_b16 v[68:69], v12 offset:19456
    v_and_b32 v40, 0xffff0000, v144
    v_lshlrev_b32 v41, 16, v144
    v_fmac_f32 v36, v40, v40
    v_fmac_f32 v37, v41, v41
    v_and_b32 v42, 0xffff0000, v145
    v_lshlrev_b32 v43, 16, v145
    v_mfma_f32_32x32x16_bf16 v[92:107], v[144:147], v[56:59], v[92:107]
    ds_read_b64_tr_b16 v[70:71], v12 offset:19712
    ds_read_b64_tr_b16 v[72:73], v12 offset:23552
    v_fmac_f32 v38, v42, v42
    v_fmac_f32 v39, v43, v43
    v_and_b32 v40, 0xffff0000, v146
    v_lshlrev_b32 v41, 16, v146
    v_fmac_f32 v36, v40, v40
    v_fmac_f32 v37, v41, v41
    v_mfma_f32_16x16x32_bf16 v[20:23], v[16:19], v[144:147], v[20:23]
    ds_read_b64_tr_b16 v[74:75], v12 offset:23808
    v_and_b32 v42, 0xffff0000, v147
    v_lshlrev_b32 v43, 16, v147
    v_fmac_f32 v38, v42, v42
    v_fmac_f32 v39, v43, v43
    s_waitcnt lgkmcnt(0)
    s_barrier
    v_add_u32 v8, 24576, v8
    v_add_u32 v9, 24576, v9
    v_add_u32 v10, 24576, v10
    v_add_u32 v11, 24576, v11
    v_add_u32 v12, 24576, v12
    v_mfma_f32_32x32x16_bf16 v[76:91], v[60:63], v[148:151], v[76:91]
    ds_read_b128 v[156:159], v8
    ds_read_b64_tr_b16 v[44:45], v12 offset:16384
    v_and_b32 v40, 0xffff0000, v148
    v_lshlrev_b32 v41, 16, v148
    v_fmac_f32 v36, v40, v40
    v_fmac_f32 v37, v41, v41
    v_and_b32 v42, 0xffff0000, v149
    v_lshlrev_b32 v43, 16, v149
    v_mfma_f32_32x32x16_bf16 v[92:107], v[148:151], v[64:67], v[92:107]
    ds_read_b64_tr_b16 v[46:47], v12 offset:16640
    ds_read_b64_tr_b16 v[48:49], v12 offset:20480
    v_fmac_f32 v38, v42, v42
    v_fmac_f32 v39, v43, v43
    v_and_b32 v40, 0xffff0000, v150
    v_lshlrev_b32 v41, 16, v150
    v_fmac_f32 v36, v40, v40
    v_fmac_f32 v37, v41, v41
    v_mfma_f32_16x16x32_bf16 v[20:23], v[16:19], v[148:151], v[20:23]
    ds_read_b64_tr_b16 v[50:51], v12 offset:20736
    v_and_b32 v42, 0xffff0000, v151
    v_lshlrev_b32 v43, 16, v151
    v_fmac_f32 v38, v42, v42
    v_fmac_f32 v39, v43, v43
    v_mfma_f32_32x32x16_bf16 v[76:91], v[68:71], v[152:155], v[76:91]
    ds_read_b128 v[160:163], v9
    ds_read_b64_tr_b16 v[52:53], v12 offset:17408
    v_and_b32 v40, 0xffff0000, v152
    v_lshlrev_b32 v41, 16, v152
    v_fmac_f32 v36, v40, v40
    v_fmac_f32 v37, v41, v41
    v_and_b32 v42, 0xffff0000, v153
    v_lshlrev_b32 v43, 16, v153
    v_mfma_f32_32x32x16_bf16 v[92:107], v[152:155], v[72:75], v[92:107]
    ds_read_b64_tr_b16 v[54:55], v12 offset:17664
    ds_read_b64_tr_b16 v[56:57], v12 offset:21504
    v_fmac_f32 v38, v42, v42
    v_fmac_f32 v39, v43, v43
    v_and_b32 v40, 0xffff0000, v154
    v_lshlrev_b32 v41, 16, v154
    v_fmac_f32 v36, v40, v40
    v_fmac_f32 v37, v41, v41
    v_mfma_f32_16x16x32_bf16 v[20:23], v[16:19], v[152:155], v[20:23]
    ds_read_b64_tr_b16 v[58:59], v12 offset:21760
    v_and_b32 v42, 0xffff0000, v155
    v_lshlrev_b32 v43, 16, v155
    v_fmac_f32 v38, v42, v42
    v_fmac_f32 v39, v43, v43
    s_waitcnt lgkmcnt(5)
    v_mfma_f32_32x32x16_bf16 v[76:91], v[44:47], v[156:159], v[76:91]
    ds_read_b128 v[164:167], v10
    ds_read_b64_tr_b16 v[60:61], v12 offset:18432
    v_and_b32 v40, 0xffff0000, v156
    v_lshlrev_b32 v41, 16, v156
    v_fmac_f32 v36, v40, v40
    v_fmac_f32 v37, v41, v41
    v_and_b32 v42, 0xffff0000, v157
    v_lshlrev_b32 v43, 16, v157
    v_mfma_f32_32x32x16_bf16 v[92:107], v[156:159], v[48:51], v[92:107]
    ds_read_b64_tr_b16 v[62:63], v12 offset:18688
    ds_read_b64_tr_b16 v[64:65], v12 offset:22528
    v_fmac_f32 v38, v42, v42
    v_fmac_f32 v39, v43, v43
    v_and_b32 v40, 0xffff0000, v158
    v_lshlrev_b32 v41, 16, v158
    v_fmac_f32 v36, v40, v40
    v_fmac_f32 v37, v41, v41
    v_mfma_f32_16x16x32_bf16 v[20:23], v[16:19], v[156:159], v[20:23]
    ds_read_b64_tr_b16 v[66:67], v12 offset:22784
    v_and_b32 v42, 0xffff0000, v159
    v_lshlrev_b32 v43, 16, v159
    v_fmac_f32 v38, v42, v42
    v_fmac_f32 v39, v43, v43
    s_waitcnt lgkmcnt(5)
    v_mfma_f32_32x32x16_bf16 v[76:91], v[52:55], v[160:163], v[76:91]
    ds_read_b128 v[168:171], v11
    ds_read_b64_tr_b16 v[68:69], v12 offset:19456
    v_and_b32 v40, 0xffff0000, v160
    v_lshlrev_b32 v41, 16, v160
    v_fmac_f32 v36, v40, v40
    v_fmac_f32 v37, v41, v41
    v_and_b32 v42, 0xffff0000, v161
    v_lshlrev_b32 v43, 16, v161
    v_mfma_f32_32x32x16_bf16 v[92:107], v[160:163], v[56:59], v[92:107]
    ds_read_b64_tr_b16 v[70:71], v12 offset:19712
    ds_read_b64_tr_b16 v[72:73], v12 offset:23552
    v_fmac_f32 v38, v42, v42
    v_fmac_f32 v39, v43, v43
    v_and_b32 v40, 0xffff0000, v162
    v_lshlrev_b32 v41, 16, v162
    v_fmac_f32 v36, v40, v40
    v_fmac_f32 v37, v41, v41
    v_mfma_f32_16x16x32_bf16 v[20:23], v[16:19], v[160:163], v[20:23]
    ds_read_b64_tr_b16 v[74:75], v12 offset:23808
    v_and_b32 v42, 0xffff0000, v163
    v_lshlrev_b32 v43, 16, v163
    v_fmac_f32 v38, v42, v42
    v_fmac_f32 v39, v43, v43
    s_waitcnt lgkmcnt(0)
    s_barrier
    v_add_u32 v8, 24576, v8
    v_add_u32 v9, 24576, v9
    v_add_u32 v10, 24576, v10
    v_add_u32 v11, 24576, v11
    v_add_u32 v12, 24576, v12
    v_mfma_f32_32x32x16_bf16 v[76:91], v[60:63], v[164:167], v[76:91]
    ds_read_b128 v[172:175], v8
    ds_read_b64_tr_b16 v[44:45], v12 offset:16384
    v_and_b32 v40, 0xffff0000, v164
    v_lshlrev_b32 v41, 16, v164
    v_fmac_f32 v36, v40, v40
    v_fmac_f32 v37, v41, v41
    v_and_b32 v42, 0xffff0000, v165
    v_lshlrev_b32 v43, 16, v165
    v_mfma_f32_32x32x16_bf16 v[92:107], v[164:167], v[64:67], v[92:107]
    ds_read_b64_tr_b16 v[46:47], v12 offset:16640
    ds_read_b64_tr_b16 v[48:49], v12 offset:20480
    v_fmac_f32 v38, v42, v42
    v_fmac_f32 v39, v43, v43
    v_and_b32 v40, 0xffff0000, v166
    v_lshlrev_b32 v41, 16, v166
    v_fmac_f32 v36, v40, v40
    v_fmac_f32 v37, v41, v41
    v_mfma_f32_16x16x32_bf16 v[20:23], v[16:19], v[164:167], v[20:23]
    ds_read_b64_tr_b16 v[50:51], v12 offset:20736
    v_and_b32 v42, 0xffff0000, v167
    v_lshlrev_b32 v43, 16, v167
    v_fmac_f32 v38, v42, v42
    v_fmac_f32 v39, v43, v43
    v_mfma_f32_32x32x16_bf16 v[76:91], v[68:71], v[168:171], v[76:91]
    ds_read_b128 v[176:179], v9
    ds_read_b64_tr_b16 v[52:53], v12 offset:17408
    v_and_b32 v40, 0xffff0000, v168
    v_lshlrev_b32 v41, 16, v168
    v_fmac_f32 v36, v40, v40
    v_fmac_f32 v37, v41, v41
    v_and_b32 v42, 0xffff0000, v169
    v_lshlrev_b32 v43, 16, v169
    v_mfma_f32_32x32x16_bf16 v[92:107], v[168:171], v[72:75], v[92:107]
    ds_read_b64_tr_b16 v[54:55], v12 offset:17664
    ds_read_b64_tr_b16 v[56:57], v12 offset:21504
    v_fmac_f32 v38, v42, v42
    v_fmac_f32 v39, v43, v43
    v_and_b32 v40, 0xffff0000, v170
    v_lshlrev_b32 v41, 16, v170
    v_fmac_f32 v36, v40, v40
    v_fmac_f32 v37, v41, v41
    v_mfma_f32_16x16x32_bf16 v[20:23], v[16:19], v[168:171], v[20:23]
    ds_read_b64_tr_b16 v[58:59], v12 offset:21760
    v_and_b32 v42, 0xffff0000, v171
    v_lshlrev_b32 v43, 16, v171
    v_fmac_f32 v38, v42, v42
    v_fmac_f32 v39, v43, v43
    s_waitcnt lgkmcnt(5)
    v_mfma_f32_32x32x16_bf16 v[76:91], v[44:47], v[172:175], v[76:91]
    ds_read_b128 v[180:183], v10
    ds_read_b64_tr_b16 v[60:61], v12 offset:18432
    v_and_b32 v40, 0xffff0000, v172
    v_lshlrev_b32 v41, 16, v172
    v_fmac_f32 v36, v40, v40
    v_fmac_f32 v37, v41, v41
    v_and_b32 v42, 0xffff0000, v173
    v_lshlrev_b32 v43, 16, v173
    v_mfma_f32_32x32x16_bf16 v[92:107], v[172:175], v[48:51], v[92:107]
    ds_read_b64_tr_b16 v[62:63], v12 offset:18688
    ds_read_b64_tr_b16 v[64:65], v12 offset:22528
    v_fmac_f32 v38, v42, v42
    v_fmac_f32 v39, v43, v43
    v_and_b32 v40, 0xffff0000, v174
    v_lshlrev_b32 v41, 16, v174
    v_fmac_f32 v36, v40, v40
    v_fmac_f32 v37, v41, v41
    v_mfma_f32_16x16x32_bf16 v[20:23], v[16:19], v[172:175], v[20:23]
    ds_read_b64_tr_b16 v[66:67], v12 offset:22784
    v_and_b32 v42, 0xffff0000, v175
    v_lshlrev_b32 v43, 16, v175
    v_fmac_f32 v38, v42, v42
    v_fmac_f32 v39, v43, v43
    s_waitcnt lgkmcnt(5)
    v_mfma_f32_32x32x16_bf16 v[76:91], v[52:55], v[176:179], v[76:91]
    ds_read_b128 v[184:187], v11
    ds_read_b64_tr_b16 v[68:69], v12 offset:19456
    v_and_b32 v40, 0xffff0000, v176
    v_lshlrev_b32 v41, 16, v176
    v_fmac_f32 v36, v40, v40
    v_fmac_f32 v37, v41, v41
    v_and_b32 v42, 0xffff0000, v177
    v_lshlrev_b32 v43, 16, v177
    v_mfma_f32_32x32x16_bf16 v[92:107], v[176:179], v[56:59], v[92:107]
    ds_read_b64_tr_b16 v[70:71], v12 offset:19712
    ds_read_b64_tr_b16 v[72:73], v12 offset:23552
    v_fmac_f32 v38, v42, v42
    v_fmac_f32 v39, v43, v43
    v_and_b32 v40, 0xffff0000, v178
    v_lshlrev_b32 v41, 16, v178
    v_fmac_f32 v36, v40, v40
    v_fmac_f32 v37, v41, v41
    v_mfma_f32_16x16x32_bf16 v[20:23], v[16:19], v[176:179], v[20:23]
    ds_read_b64_tr_b16 v[74:75], v12 offset:23808
    v_and_b32 v42, 0xffff0000, v179
    v_lshlrev_b32 v43, 16, v179
    v_fmac_f32 v38, v42, v42
    v_fmac_f32 v39, v43, v43
    s_waitcnt lgkmcnt(0)
    s_barrier
    v_add_u32 v8, 24576, v8
    v_add_u32 v9, 24576, v9
    v_add_u32 v10, 24576, v10
    v_add_u32 v11, 24576, v11
    v_add_u32 v12, 24576, v12
    v_mfma_f32_32x32x16_bf16 v[76:91], v[60:63], v[180:183], v[76:91]
    ds_read_b128 v[188:191], v8
    ds_read_b64_tr_b16 v[44:45], v12 offset:16384
    v_and_b32 v40, 0xffff0000, v180
    v_lshlrev_b32 v41, 16, v180
    v_fmac_f32 v36, v40, v40
    v_fmac_f32 v37, v41, v41
    v_and_b32 v42, 0xffff0000, v181
    v_lshlrev_b32 v43, 16, v181
    v_mfma_f32_32x32x16_bf16 v[92:107], v[180:183], v[64:67], v[92:107]
    ds_read_b64_tr_b16 v[46:47], v12 offset:16640
    ds_read_b64_tr_b16 v[48:49], v12 offset:20480
    v_fmac_f32 v38, v42, v42
    v_fmac_f32 v39, v43, v43
    v_and_b32 v40, 0xffff0000, v182
    v_lshlrev_b32 v41, 16, v182
    v_fmac_f32 v36, v40, v40
    v_fmac_f32 v37, v41, v41
    v_mfma_f32_16x16x32_bf16 v[20:23], v[16:19], v[180:183], v[20:23]
    ds_read_b64_tr_b16 v[50:51], v12 offset:20736
    v_and_b32 v42, 0xffff0000, v183
    v_lshlrev_b32 v43, 16, v183
    v_fmac_f32 v38, v42, v42
    v_fmac_f32 v39, v43, v43
    v_mfma_f32_32x32x16_bf16 v[76:91], v[68:71], v[184:187], v[76:91]
    ds_read_b128 v[192:195], v9
    ds_read_b64_tr_b16 v[52:53], v12 offset:17408
    v_and_b32 v40, 0xffff0000, v184
    v_lshlrev_b32 v41, 16, v184
    v_fmac_f32 v36, v40, v40
    v_fmac_f32 v37, v41, v41
    v_and_b32 v42, 0xffff0000, v185
    v_lshlrev_b32 v43, 16, v185
    v_mfma_f32_32x32x16_bf16 v[92:107], v[184:187], v[72:75], v[92:107]
    ds_read_b64_tr_b16 v[54:55], v12 offset:17664
    ds_read_b64_tr_b16 v[56:57], v12 offset:21504
    v_fmac_f32 v38, v42, v42
    v_fmac_f32 v39, v43, v43
    v_and_b32 v40, 0xffff0000, v186
    v_lshlrev_b32 v41, 16, v186
    v_fmac_f32 v36, v40, v40
    v_fmac_f32 v37, v41, v41
    v_mfma_f32_16x16x32_bf16 v[20:23], v[16:19], v[184:187], v[20:23]
    ds_read_b64_tr_b16 v[58:59], v12 offset:21760
    v_and_b32 v42, 0xffff0000, v187
    v_lshlrev_b32 v43, 16, v187
    v_fmac_f32 v38, v42, v42
    v_fmac_f32 v39, v43, v43
    s_waitcnt lgkmcnt(5)
    v_mfma_f32_32x32x16_bf16 v[76:91], v[44:47], v[188:191], v[76:91]
    ds_read_b128 v[196:199], v10
    ds_read_b64_tr_b16 v[60:61], v12 offset:18432
    v_and_b32 v40, 0xffff0000, v188
    v_lshlrev_b32 v41, 16, v188
    v_fmac_f32 v36, v40, v40
    v_fmac_f32 v37, v41, v41
    v_and_b32 v42, 0xffff0000, v189
    v_lshlrev_b32 v43, 16, v189
    v_mfma_f32_32x32x16_bf16 v[92:107], v[188:191], v[48:51], v[92:107]
    ds_read_b64_tr_b16 v[62:63], v12 offset:18688
    ds_read_b64_tr_b16 v[64:65], v12 offset:22528
    v_fmac_f32 v38, v42, v42
    v_fmac_f32 v39, v43, v43
    v_and_b32 v40, 0xffff0000, v190
    v_lshlrev_b32 v41, 16, v190
    v_fmac_f32 v36, v40, v40
    v_fmac_f32 v37, v41, v41
    v_mfma_f32_16x16x32_bf16 v[20:23], v[16:19], v[188:191], v[20:23]
    ds_read_b64_tr_b16 v[66:67], v12 offset:22784
    v_and_b32 v42, 0xffff0000, v191
    v_lshlrev_b32 v43, 16, v191
    v_fmac_f32 v38, v42, v42
    v_fmac_f32 v39, v43, v43
    s_waitcnt lgkmcnt(5)
    v_mfma_f32_32x32x16_bf16 v[76:91], v[52:55], v[192:195], v[76:91]
    ds_read_b128 v[200:203], v11
    ds_read_b64_tr_b16 v[68:69], v12 offset:19456
    v_and_b32 v40, 0xffff0000, v192
    v_lshlrev_b32 v41, 16, v192
    v_fmac_f32 v36, v40, v40
    v_fmac_f32 v37, v41, v41
    v_and_b32 v42, 0xffff0000, v193
    v_lshlrev_b32 v43, 16, v193
    v_mfma_f32_32x32x16_bf16 v[92:107], v[192:195], v[56:59], v[92:107]
    ds_read_b64_tr_b16 v[70:71], v12 offset:19712
    ds_read_b64_tr_b16 v[72:73], v12 offset:23552
    v_fmac_f32 v38, v42, v42
    v_fmac_f32 v39, v43, v43
    v_and_b32 v40, 0xffff0000, v194
    v_lshlrev_b32 v41, 16, v194
    v_fmac_f32 v36, v40, v40
    v_fmac_f32 v37, v41, v41
    v_mfma_f32_16x16x32_bf16 v[20:23], v[16:19], v[192:195], v[20:23]
    ds_read_b64_tr_b16 v[74:75], v12 offset:23808
    v_and_b32 v42, 0xffff0000, v195
    v_lshlrev_b32 v43, 16, v195
    v_fmac_f32 v38, v42, v42
    v_fmac_f32 v39, v43, v43
    s_waitcnt lgkmcnt(0)
    s_barrier
    v_add_u32 v8, 24576, v8
    v_add_u32 v9, 24576, v9
    v_add_u32 v10, 24576, v10
    v_add_u32 v11, 24576, v11
    v_add_u32 v12, 24576, v12
    v_mfma_f32_32x32x16_bf16 v[76:91], v[60:63], v[196:199], v[76:91]
    ds_read_b128 v[204:207], v8
    ds_read_b64_tr_b16 v[44:45], v12 offset:16384
    v_and_b32 v40, 0xffff0000, v196
    v_lshlrev_b32 v41, 16, v196
    v_fmac_f32 v36, v40, v40
    v_fmac_f32 v37, v41, v41
    v_and_b32 v42, 0xffff0000, v197
    v_lshlrev_b32 v43, 16, v197
    v_mfma_f32_32x32x16_bf16 v[92:107], v[196:199], v[64:67], v[92:107]
    ds_read_b64_tr_b16 v[46:47], v12 offset:16640
    ds_read_b64_tr_b16 v[48:49], v12 offset:20480
    v_fmac_f32 v38, v42, v42
    v_fmac_f32 v39, v43, v43
    v_and_b32 v40, 0xffff0000, v198
    v_lshlrev_b32 v41, 16, v198
    v_fmac_f32 v36, v40, v40
    v_fmac_f32 v37, v41, v41
    v_mfma_f32_16x16x32_bf16 v[20:23], v[16:19], v[196:199], v[20:23]
    ds_read_b64_tr_b16 v[50:51], v12 offset:20736
    v_and_b32 v42, 0xffff0000, v199
    v_lshlrev_b32 v43, 16, v199
    v_fmac_f32 v38, v42, v42
    v_fmac_f32 v39, v43, v43
    v_mfma_f32_32x32x16_bf16 v[76:91], v[68:71], v[200:203], v[76:91]
    ds_read_b128 v[208:211], v9
    ds_read_b64_tr_b16 v[52:53], v12 offset:17408
    v_and_b32 v40, 0xffff0000, v200
    v_lshlrev_b32 v41, 16, v200
    v_fmac_f32 v36, v40, v40
    v_fmac_f32 v37, v41, v41
    v_and_b32 v42, 0xffff0000, v201
    v_lshlrev_b32 v43, 16, v201
    v_mfma_f32_32x32x16_bf16 v[92:107], v[200:203], v[72:75], v[92:107]
    ds_read_b64_tr_b16 v[54:55], v12 offset:17664
    ds_read_b64_tr_b16 v[56:57], v12 offset:21504
    v_fmac_f32 v38, v42, v42
    v_fmac_f32 v39, v43, v43
    v_and_b32 v40, 0xffff0000, v202
    v_lshlrev_b32 v41, 16, v202
    v_fmac_f32 v36, v40, v40
    v_fmac_f32 v37, v41, v41
    v_mfma_f32_16x16x32_bf16 v[20:23], v[16:19], v[200:203], v[20:23]
    ds_read_b64_tr_b16 v[58:59], v12 offset:21760
    v_and_b32 v42, 0xffff0000, v203
    v_lshlrev_b32 v43, 16, v203
    v_fmac_f32 v38, v42, v42
    v_fmac_f32 v39, v43, v43
    s_waitcnt lgkmcnt(5)
    v_mfma_f32_32x32x16_bf16 v[76:91], v[44:47], v[204:207], v[76:91]
    ds_read_b128 v[212:215], v10
    ds_read_b64_tr_b16 v[60:61], v12 offset:18432
    v_and_b32 v40, 0xffff0000, v204
    v_lshlrev_b32 v41, 16, v204
    v_fmac_f32 v36, v40, v40
    v_fmac_f32 v37, v41, v41
    v_and_b32 v42, 0xffff0000, v205
    v_lshlrev_b32 v43, 16, v205
    v_mfma_f32_32x32x16_bf16 v[92:107], v[204:207], v[48:51], v[92:107]
    ds_read_b64_tr_b16 v[62:63], v12 offset:18688
    ds_read_b64_tr_b16 v[64:65], v12 offset:22528
    v_fmac_f32 v38, v42, v42
    v_fmac_f32 v39, v43, v43
    v_and_b32 v40, 0xffff0000, v206
    v_lshlrev_b32 v41, 16, v206
    v_fmac_f32 v36, v40, v40
    v_fmac_f32 v37, v41, v41
    v_mfma_f32_16x16x32_bf16 v[20:23], v[16:19], v[204:207], v[20:23]
    ds_read_b64_tr_b16 v[66:67], v12 offset:22784
    v_and_b32 v42, 0xffff0000, v207
    v_lshlrev_b32 v43, 16, v207
    v_fmac_f32 v38, v42, v42
    v_fmac_f32 v39, v43, v43
    s_waitcnt lgkmcnt(5)
    v_mfma_f32_32x32x16_bf16 v[76:91], v[52:55], v[208:211], v[76:91]
    ds_read_b128 v[216:219], v11
    ds_read_b64_tr_b16 v[68:69], v12 offset:19456
    v_and_b32 v40, 0xffff0000, v208
    v_lshlrev_b32 v41, 16, v208
    v_fmac_f32 v36, v40, v40
    v_fmac_f32 v37, v41, v41
    v_and_b32 v42, 0xffff0000, v209
    v_lshlrev_b32 v43, 16, v209
    v_mfma_f32_32x32x16_bf16 v[92:107], v[208:211], v[56:59], v[92:107]
    ds_read_b64_tr_b16 v[70:71], v12 offset:19712
    ds_read_b64_tr_b16 v[72:73], v12 offset:23552
    v_fmac_f32 v38, v42, v42
    v_fmac_f32 v39, v43, v43
    v_and_b32 v40, 0xffff0000, v210
    v_lshlrev_b32 v41, 16, v210
    v_fmac_f32 v36, v40, v40
    v_fmac_f32 v37, v41, v41
    v_mfma_f32_16x16x32_bf16 v[20:23], v[16:19], v[208:211], v[20:23]
    ds_read_b64_tr_b16 v[74:75], v12 offset:23808
    v_and_b32 v42, 0xffff0000, v211
    v_lshlrev_b32 v43, 16, v211
    v_fmac_f32 v38, v42, v42
    v_fmac_f32 v39, v43, v43
    s_waitcnt lgkmcnt(0)
    s_barrier
    v_add_u32 v8, 4294868992, v8
    v_add_u32 v9, 4294868992, v9
    v_add_u32 v10, 4294868992, v10
    v_add_u32 v11, 4294868992, v11
    v_add_u32 v12, 4294868992, v12
    v_mfma_f32_32x32x16_bf16 v[76:91], v[60:63], v[212:215], v[76:91]
    ds_read_b128 v[220:223], v8
    ds_read_b64_tr_b16 v[44:45], v12 offset:16384
    v_and_b32 v40, 0xffff0000, v212
    v_lshlrev_b32 v41, 16, v212
    v_fmac_f32 v36, v40, v40
    v_fmac_f32 v37, v41, v41
    v_and_b32 v42, 0xffff0000, v213
    v_lshlrev_b32 v43, 16, v213
    v_mfma_f32_32x32x16_bf16 v[92:107], v[212:215], v[64:67], v[92:107]
    ds_read_b64_tr_b16 v[46:47], v12 offset:16640
    ds_read_b64_tr_b16 v[48:49], v12 offset:20480
    v_fmac_f32 v38, v42, v42
    v_fmac_f32 v39, v43, v43
    v_and_b32 v40, 0xffff0000, v214
    v_lshlrev_b32 v41, 16, v214
    v_fmac_f32 v36, v40, v40
    v_fmac_f32 v37, v41, v41
    v_mfma_f32_16x16x32_bf16 v[20:23], v[16:19], v[212:215], v[20:23]
    ds_read_b64_tr_b16 v[50:51], v12 offset:20736
    v_and_b32 v42, 0xffff0000, v215
    v_lshlrev_b32 v43, 16, v215
    v_fmac_f32 v38, v42, v42
    v_fmac_f32 v39, v43, v43
    v_mfma_f32_32x32x16_bf16 v[76:91], v[68:71], v[216:219], v[76:91]
    ds_read_b128 v[224:227], v9
    ds_read_b64_tr_b16 v[52:53], v12 offset:17408
    v_and_b32 v40, 0xffff0000, v216
    v_lshlrev_b32 v41, 16, v216
    v_fmac_f32 v36, v40, v40
    v_fmac_f32 v37, v41, v41
    v_and_b32 v42, 0xffff0000, v217
    v_lshlrev_b32 v43, 16, v217
    v_mfma_f32_32x32x16_bf16 v[92:107], v[216:219], v[72:75], v[92:107]
    ds_read_b64_tr_b16 v[54:55], v12 offset:17664
    ds_read_b64_tr_b16 v[56:57], v12 offset:21504
    v_fmac_f32 v38, v42, v42
    v_fmac_f32 v39, v43, v43
    v_and_b32 v40, 0xffff0000, v218
    v_lshlrev_b32 v41, 16, v218
    v_fmac_f32 v36, v40, v40
    v_fmac_f32 v37, v41, v41
    v_mfma_f32_16x16x32_bf16 v[20:23], v[16:19], v[216:219], v[20:23]
    ds_read_b64_tr_b16 v[58:59], v12 offset:21760
    v_and_b32 v42, 0xffff0000, v219
    v_lshlrev_b32 v43, 16, v219
    v_fmac_f32 v38, v42, v42
    v_fmac_f32 v39, v43, v43
    s_waitcnt lgkmcnt(5)
    v_mfma_f32_32x32x16_bf16 v[76:91], v[44:47], v[220:223], v[76:91]
    ds_read_b128 v[228:231], v10
    ds_read_b64_tr_b16 v[60:61], v12 offset:18432
    v_and_b32 v40, 0xffff0000, v220
    v_lshlrev_b32 v41, 16, v220
    v_fmac_f32 v36, v40, v40
    v_fmac_f32 v37, v41, v41
    v_and_b32 v42, 0xffff0000, v221
    v_lshlrev_b32 v43, 16, v221
    v_mfma_f32_32x32x16_bf16 v[92:107], v[220:223], v[48:51], v[92:107]
    ds_read_b64_tr_b16 v[62:63], v12 offset:18688
    ds_read_b64_tr_b16 v[64:65], v12 offset:22528
    v_fmac_f32 v38, v42, v42
    v_fmac_f32 v39, v43, v43
    v_and_b32 v40, 0xffff0000, v222
    v_lshlrev_b32 v41, 16, v222
    v_fmac_f32 v36, v40, v40
    v_fmac_f32 v37, v41, v41
    v_mfma_f32_16x16x32_bf16 v[20:23], v[16:19], v[220:223], v[20:23]
    ds_read_b64_tr_b16 v[66:67], v12 offset:22784
    v_and_b32 v42, 0xffff0000, v223
    v_lshlrev_b32 v43, 16, v223
    v_fmac_f32 v38, v42, v42
    v_fmac_f32 v39, v43, v43
    s_waitcnt lgkmcnt(5)
    v_mfma_f32_32x32x16_bf16 v[76:91], v[52:55], v[224:227], v[76:91]
    ds_read_b128 v[232:235], v11
    ds_read_b64_tr_b16 v[68:69], v12 offset:19456
    v_and_b32 v40, 0xffff0000, v224
    v_lshlrev_b32 v41, 16, v224
    v_fmac_f32 v36, v40, v40
    v_fmac_f32 v37, v41, v41
    v_and_b32 v42, 0xffff0000, v225
    v_lshlrev_b32 v43, 16, v225
    v_mfma_f32_32x32x16_bf16 v[92:107], v[224:227], v[56:59], v[92:107]
    ds_read_b64_tr_b16 v[70:71], v12 offset:19712
    ds_read_b64_tr_b16 v[72:73], v12 offset:23552
    v_fmac_f32 v38, v42, v42
    v_fmac_f32 v39, v43, v43
    v_and_b32 v40, 0xffff0000, v226
    v_lshlrev_b32 v41, 16, v226
    v_fmac_f32 v36, v40, v40
    v_fmac_f32 v37, v41, v41
    v_mfma_f32_16x16x32_bf16 v[20:23], v[16:19], v[224:227], v[20:23]
    ds_read_b64_tr_b16 v[74:75], v12 offset:23808
    v_and_b32 v42, 0xffff0000, v227
    v_lshlrev_b32 v43, 16, v227
    v_fmac_f32 v38, v42, v42
    v_fmac_f32 v39, v43, v43
    s_waitcnt lgkmcnt(0)
    s_barrier
    v_add_u32 v8, 24576, v8
    v_add_u32 v9, 24576, v9
    v_add_u32 v10, 24576, v10
    v_add_u32 v11, 24576, v11
    v_add_u32 v12, 24576, v12
    v_mfma_f32_32x32x16_bf16 v[76:91], v[60:63], v[228:231], v[76:91]
    ds_read_b128 v[236:239], v8
    ds_read_b64_tr_b16 v[44:45], v12 offset:16384
    v_and_b32 v40, 0xffff0000, v228
    v_lshlrev_b32 v41, 16, v228
    v_fmac_f32 v36, v40, v40
    v_fmac_f32 v37, v41, v41
    v_and_b32 v42, 0xffff0000, v229
    v_lshlrev_b32 v43, 16, v229
    v_mfma_f32_32x32x16_bf16 v[92:107], v[228:231], v[64:67], v[92:107]
    ds_read_b64_tr_b16 v[46:47], v12 offset:16640
    ds_read_b64_tr_b16 v[48:49], v12 offset:20480
    v_fmac_f32 v38, v42, v42
    v_fmac_f32 v39, v43, v43
    v_and_b32 v40, 0xffff0000, v230
    v_lshlrev_b32 v41, 16, v230
    v_fmac_f32 v36, v40, v40
    v_fmac_f32 v37, v41, v41
    v_mfma_f32_16x16x32_bf16 v[20:23], v[16:19], v[228:231], v[20:23]
    ds_read_b64_tr_b16 v[50:51], v12 offset:20736
    v_and_b32 v42, 0xffff0000, v231
    v_lshlrev_b32 v43, 16, v231
    v_fmac_f32 v38, v42, v42
    v_fmac_f32 v39, v43, v43
    v_mfma_f32_32x32x16_bf16 v[76:91], v[68:71], v[232:235], v[76:91]
    ds_read_b128 v[240:243], v9
    ds_read_b64_tr_b16 v[52:53], v12 offset:17408
    v_and_b32 v40, 0xffff0000, v232
    v_lshlrev_b32 v41, 16, v232
    v_fmac_f32 v36, v40, v40
    v_fmac_f32 v37, v41, v41
    v_and_b32 v42, 0xffff0000, v233
    v_lshlrev_b32 v43, 16, v233
    v_mfma_f32_32x32x16_bf16 v[92:107], v[232:235], v[72:75], v[92:107]
    ds_read_b64_tr_b16 v[54:55], v12 offset:17664
    ds_read_b64_tr_b16 v[56:57], v12 offset:21504
    v_fmac_f32 v38, v42, v42
    v_fmac_f32 v39, v43, v43
    v_and_b32 v40, 0xffff0000, v234
    v_lshlrev_b32 v41, 16, v234
    v_fmac_f32 v36, v40, v40
    v_fmac_f32 v37, v41, v41
    v_mfma_f32_16x16x32_bf16 v[20:23], v[16:19], v[232:235], v[20:23]
    ds_read_b64_tr_b16 v[58:59], v12 offset:21760
    v_and_b32 v42, 0xffff0000, v235
    v_lshlrev_b32 v43, 16, v235
    v_fmac_f32 v38, v42, v42
    v_fmac_f32 v39, v43, v43
    s_waitcnt lgkmcnt(5)
    v_mfma_f32_32x32x16_bf16 v[76:91], v[44:47], v[236:239], v[76:91]
    ds_read_b128 v[244:247], v10
    ds_read_b64_tr_b16 v[60:61], v12 offset:18432
    v_and_b32 v40, 0xffff0000, v236
    v_lshlrev_b32 v41, 16, v236
    v_fmac_f32 v36, v40, v40
    v_fmac_f32 v37, v41, v41
    v_and_b32 v42, 0xffff0000, v237
    v_lshlrev_b32 v43, 16, v237
    v_mfma_f32_32x32x16_bf16 v[92:107], v[236:239], v[48:51], v[92:107]
    ds_read_b64_tr_b16 v[62:63], v12 offset:18688
    ds_read_b64_tr_b16 v[64:65], v12 offset:22528
    v_fmac_f32 v38, v42, v42
    v_fmac_f32 v39, v43, v43
    v_and_b32 v40, 0xffff0000, v238
    v_lshlrev_b32 v41, 16, v238
    v_fmac_f32 v36, v40, v40
    v_fmac_f32 v37, v41, v41
    v_mfma_f32_16x16x32_bf16 v[20:23], v[16:19], v[236:239], v[20:23]
    ds_read_b64_tr_b16 v[66:67], v12 offset:22784
    v_and_b32 v42, 0xffff0000, v239
    v_lshlrev_b32 v43, 16, v239
    v_fmac_f32 v38, v42, v42
    v_fmac_f32 v39, v43, v43
    s_waitcnt lgkmcnt(5)
    v_mfma_f32_32x32x16_bf16 v[76:91], v[52:55], v[240:243], v[76:91]
    ds_read_b128 v[248:251], v11
    ds_read_b64_tr_b16 v[68:69], v12 offset:19456
    v_and_b32 v40, 0xffff0000, v240
    v_lshlrev_b32 v41, 16, v240
    v_fmac_f32 v36, v40, v40
    v_fmac_f32 v37, v41, v41
    v_and_b32 v42, 0xffff0000, v241
    v_lshlrev_b32 v43, 16, v241
    v_mfma_f32_32x32x16_bf16 v[92:107], v[240:243], v[56:59], v[92:107]
    ds_read_b64_tr_b16 v[70:71], v12 offset:19712
    ds_read_b64_tr_b16 v[72:73], v12 offset:23552
    v_fmac_f32 v38, v42, v42
    v_fmac_f32 v39, v43, v43
    v_and_b32 v40, 0xffff0000, v242
    v_lshlrev_b32 v41, 16, v242
    v_fmac_f32 v36, v40, v40
    v_fmac_f32 v37, v41, v41
    v_mfma_f32_16x16x32_bf16 v[20:23], v[16:19], v[240:243], v[20:23]
    ds_read_b64_tr_b16 v[74:75], v12 offset:23808
    v_and_b32 v42, 0xffff0000, v243
    v_lshlrev_b32 v43, 16, v243
    v_fmac_f32 v38, v42, v42
    v_fmac_f32 v39, v43, v43
    s_waitcnt lgkmcnt(5)
    v_add_u32 v8, 152064, v2
    v_mfma_f32_32x32x16_bf16 v[76:91], v[60:63], v[244:247], v[76:91]
    v_and_b32 v40, 0xffff0000, v244
    v_lshlrev_b32 v41, 16, v244
    v_fmac_f32 v36, v40, v40
    v_fmac_f32 v37, v41, v41
    v_and_b32 v42, 0xffff0000, v245
    v_lshlrev_b32 v43, 16, v245
    v_mfma_f32_32x32x16_bf16 v[92:107], v[244:247], v[64:67], v[92:107]
    v_fmac_f32 v38, v42, v42
    v_fmac_f32 v39, v43, v43
    v_and_b32 v40, 0xffff0000, v246
    v_lshlrev_b32 v41, 16, v246
    v_fmac_f32 v36, v40, v40
    v_fmac_f32 v37, v41, v41
    v_mfma_f32_16x16x32_bf16 v[20:23], v[16:19], v[244:247], v[20:23]
    v_and_b32 v42, 0xffff0000, v247
    v_lshlrev_b32 v43, 16, v247
    v_fmac_f32 v38, v42, v42
    v_fmac_f32 v39, v43, v43
    s_waitcnt lgkmcnt(0)
    v_mfma_f32_32x32x16_bf16 v[76:91], v[68:71], v[248:251], v[76:91]
    s_barrier
    ds_read_b128 v[24:27], v8
    v_and_b32 v40, 0xffff0000, v248
    v_lshlrev_b32 v41, 16, v248
    v_fmac_f32 v36, v40, v40
    v_fmac_f32 v37, v41, v41
    v_and_b32 v42, 0xffff0000, v249
    v_lshlrev_b32 v43, 16, v249
    v_mfma_f32_32x32x16_bf16 v[92:107], v[248:251], v[72:75], v[92:107]
    ds_read_b128 v[28:31], v8 offset:1024
    v_fmac_f32 v38, v42, v42
    v_fmac_f32 v39, v43, v43
    v_and_b32 v40, 0xffff0000, v250
    v_lshlrev_b32 v41, 16, v250
    v_fmac_f32 v36, v40, v40
    v_fmac_f32 v37, v41, v41
    v_mfma_f32_16x16x32_bf16 v[20:23], v[16:19], v[248:251], v[20:23]
    v_and_b32 v42, 0xffff0000, v251
    v_lshlrev_b32 v43, 16, v251
    v_fmac_f32 v38, v42, v42
    v_fmac_f32 v39, v43, v43
    v_add_f32 v36, v36, v37
    v_add_f32 v38, v38, v39
    v_add_f32 v6, v36, v38
    v_mov_b32 v3, v6
    s_nop 1
    v_permlane32_swap_b32 v6, v3
    s_nop 1
    v_add_f32 v6, v6, v3
    s_mul_i32 s31, s35, 128
    s_add_u32 s31, s31, 154368
    v_mov_b32 v5, v20
    v_and_b32 v4, 31, v1
    v_cmp_eq_u32 s[62:63], 28, v4
    v_cmp_lt_u32 s[64:65], 27, v4
    v_lshl_add_u32 v4, v4, 2, s31
    s_waitcnt lgkmcnt(0)
    v_add_f32 v24, v24, v25
    v_add_f32 v26, v26, v27
    v_add_f32 v24, v24, v26
    v_add_f32 v28, v28, v29
    v_add_f32 v30, v30, v31
    v_add_f32 v28, v28, v30
    v_mul_f32 v5, 0xbb124925, v5
    v_mul_f32 v6, 0x3b124925, v6
    v_fma_f32 v6, -v5, v5, v6
    v_max_f32 v6, 0, v6
    v_add_f32 v6, 0x3727c5ac, v6
    v_rsq_f32 v6, v6
    v_mul_f32 v5, 0.5, v5
    v_lshrrev_b32 v12, 5, v1
    ds_write_b32 v4, v6
    v_mfma_f32_32x32x2_f32 v[76:91], v24, v5, v[76:91]
    v_mfma_f32_32x32x2_f32 v[92:107], v5, v28, v[92:107]
    v_lshl_add_u32 v12, v12, 4, s31
    v_cmp_lt_u32 vcc, 31, v1
    v_mov_b32 v3, 0x3f80
    v_cndmask_b32 v8, 0, v7, s[62:63]
    s_waitcnt lgkmcnt(0)
    ds_read_b128 v[44:47], v12 offset:0
    ds_read_b128 v[48:51], v12 offset:32
    ds_read_b128 v[52:55], v12 offset:64
    ds_read_b128 v[56:59], v12 offset:96
    s_mul_i32 s32, s29, 262144
    s_mul_i32 s34, s30, 16384
    s_add_u32 s32, s32, s34
    s_mul_i32 s34, s35, 4096
    s_add_u32 s32, s32, s34
    s_add_u32 s32, s32, 2097152
    s_nop 1
    v_mul_f32 v76, v76, v6
    v_mul_f32 v77, v77, v6
    v_mul_f32 v78, v78, v6
    v_mul_f32 v79, v79, v6
    v_mul_f32 v80, v80, v6
    v_mul_f32 v81, v81, v6
    v_mul_f32 v82, v82, v6
    v_mul_f32 v83, v83, v6
    v_cvt_pk_bf16_f32 v124, v76, v77
    v_cvt_pk_bf16_f32 v125, v78, v79
    v_cvt_pk_bf16_f32 v126, v80, v81
    v_cvt_pk_bf16_f32 v127, v82, v83
    buffer_store_dwordx4 v[124:127], v2, s[20:23], s32 offen offset:0 sc1
    v_mul_f32 v84, v84, v6
    v_mul_f32 v85, v85, v6
    v_mul_f32 v86, v86, v6
    v_mul_f32 v87, v87, v6
    v_mul_f32 v88, v88, v6
    v_mul_f32 v89, v89, v6
    v_mul_f32 v90, v90, v6
    v_mul_f32 v91, v91, v6
    v_cvt_pk_bf16_f32 v128, v84, v85
    v_cvt_pk_bf16_f32 v129, v86, v87
    v_cvt_pk_bf16_f32 v130, v88, v89
    v_cvt_pk_bf16_f32 v131, v90, v91
    v_cndmask_b32 v130, v130, v7, vcc
    v_cndmask_b32 v131, v131, v3, vcc
    buffer_store_dwordx4 v[128:131], v2, s[20:23], s32 offen offset:1024 sc1
    s_waitcnt lgkmcnt(0)
    v_mul_f32 v92, v92, v44
    v_mul_f32 v93, v93, v45
    v_mul_f32 v94, v94, v46
    v_mul_f32 v95, v95, v47
    v_mul_f32 v96, v96, v48
    v_mul_f32 v97, v97, v49
    v_mul_f32 v98, v98, v50
    v_mul_f32 v99, v99, v51
    v_cvt_pk_bf16_f32 v132, v92, v93
    v_cvt_pk_bf16_f32 v133, v94, v95
    v_cvt_pk_bf16_f32 v134, v96, v97
    v_cvt_pk_bf16_f32 v135, v98, v99
    v_cndmask_b32 v132, v132, v8, s[64:65]
    v_cndmask_b32 v133, v133, v8, s[64:65]
    v_cndmask_b32 v134, v134, v8, s[64:65]
    v_cndmask_b32 v135, v135, v8, s[64:65]
    buffer_store_dwordx4 v[132:135], v2, s[20:23], s32 offen offset:2048 sc1
    v_mul_f32 v100, v100, v52
    v_mul_f32 v101, v101, v53
    v_mul_f32 v102, v102, v54
    v_mul_f32 v103, v103, v55
    v_mul_f32 v104, v104, v56
    v_mul_f32 v105, v105, v57
    v_mul_f32 v106, v106, v58
    v_mul_f32 v107, v107, v59
    v_cvt_pk_bf16_f32 v136, v100, v101
    v_cvt_pk_bf16_f32 v137, v102, v103
    v_cvt_pk_bf16_f32 v138, v104, v105
    v_cvt_pk_bf16_f32 v139, v106, v107
    v_cndmask_b32 v136, v136, v8, s[64:65]
    v_cndmask_b32 v137, v137, v8, s[64:65]
    v_cndmask_b32 v138, v138, v8, s[64:65]
    v_cndmask_b32 v139, v139, v8, s[64:65]
    buffer_store_dwordx4 v[136:139], v2, s[20:23], s32 offen offset:3072 sc1
    v_lshlrev_b32 v4, 7, v1
    s_lshr_b32 s31, s35, 1
    s_lshr_b32 s33, s2, 3
    s_mov_b64 exec, 0x1ffffff
    s_mov_b32 s12, s44
    s_mov_b32 s13, s45
    s_mov_b32 s14, 401408
    s_mov_b32 s15, 0x20000
    s_mul_i32 s32, s33, 12800
    s_mul_i32 s34, s35, 3200
    s_add_u32 s32, s32, s34
    buffer_load_dword v255, v4, s[12:15], s32 offen
    s_bitcmp1_b32 s35, 0
    s_cselect_b32 s12, s50, s48
    s_cselect_b32 s13, s51, s49
    s_mov_b32 s14, 1605632
    s_mul_i32 s32, s2, 6400
    s_mul_i32 s34, s31, 3200
    s_add_u32 s32, s32, s34
    buffer_load_dword v255, v4, s[12:15], s32 offen
    s_mov_b64 exec, 0x1fff
    s_mov_b32 s12, s52
    s_mov_b32 s13, s53
    s_mov_b32 s14, 1605632
    s_mov_b32 s15, 0x20000
    s_mul_i32 s32, s2, 6656
    s_mul_i32 s34, s35, 1664
    s_add_u32 s32, s32, s34
    buffer_load_dword v255, v4, s[12:15], s32 offen
    s_mov_b64 exec, -1
    v_mov_b32 v3, 154880
    s_barrier
    ds_read_b32 v4, v3
    ds_read_b64_tr_b16 v[44:45], v13 offset:0
    ds_read_b64_tr_b16 v[46:47], v13 offset:256
    ds_read_b64_tr_b16 v[48:49], v13 offset:1024
    ds_read_b64_tr_b16 v[50:51], v13 offset:1280
    ds_read_b64_tr_b16 v[52:53], v13 offset:2048
    ds_read_b64_tr_b16 v[54:55], v13 offset:2304
    ds_read_b64_tr_b16 v[56:57], v13 offset:3072
    ds_read_b64_tr_b16 v[58:59], v13 offset:3328
    ds_read_b64_tr_b16 v[60:61], v13 offset:4096
    ds_read_b64_tr_b16 v[62:63], v13 offset:4352
    ds_read_b64_tr_b16 v[64:65], v13 offset:5120
    ds_read_b64_tr_b16 v[66:67], v13 offset:5376
    s_mul_i32 s32, s29, 256
    s_mul_i32 s34, s30, 4
    s_add_u32 s32, s32, s34
    s_mul_i32 s34, s35, 64
    s_add_u32 s32, s32, s34
    s_add_u32 s32, s32, 18882560
    s_waitcnt lgkmcnt(12)
    v_readfirstlane_b32 s25, v4
    s_waitcnt lgkmcnt(10)
    v_mfma_f32_32x32x16_bf16 v[108:123], v[44:47], v[140:143], 0
    ds_read_b64_tr_b16 v[68:69], v13 offset:6144
    ds_read_b64_tr_b16 v[70:71], v13 offset:6400
    s_waitcnt lgkmcnt(10)
    v_mfma_f32_32x32x16_bf16 v[108:123], v[48:51], v[144:147], v[108:123]
    ds_read_b64_tr_b16 v[72:73], v13 offset:7168
    ds_read_b64_tr_b16 v[74:75], v13 offset:7424
    s_waitcnt lgkmcnt(10)
    v_mfma_f32_32x32x16_bf16 v[108:123], v[52:55], v[148:151], v[108:123]
    ds_read_b64_tr_b16 v[44:45], v13 offset:8192
    ds_read_b64_tr_b16 v[46:47], v13 offset:8448
    s_waitcnt lgkmcnt(10)
    v_mfma_f32_32x32x16_bf16 v[108:123], v[56:59], v[152:155], v[108:123]
    ds_read_b64_tr_b16 v[48:49], v13 offset:9216
    ds_read_b64_tr_b16 v[50:51], v13 offset:9472
    s_waitcnt lgkmcnt(10)
    v_mfma_f32_32x32x16_bf16 v[108:123], v[60:63], v[156:159], v[108:123]
    ds_read_b64_tr_b16 v[52:53], v13 offset:10240
    ds_read_b64_tr_b16 v[54:55], v13 offset:10496
    s_waitcnt lgkmcnt(10)
    v_mfma_f32_32x32x16_bf16 v[108:123], v[64:67], v[160:163], v[108:123]
    ds_read_b64_tr_b16 v[56:57], v13 offset:11264
    ds_read_b64_tr_b16 v[58:59], v13 offset:11520
    s_waitcnt lgkmcnt(10)
    v_mfma_f32_32x32x16_bf16 v[108:123], v[68:71], v[164:167], v[108:123]
    ds_read_b64_tr_b16 v[60:61], v13 offset:12288
    ds_read_b64_tr_b16 v[62:63], v13 offset:12544
    s_waitcnt lgkmcnt(10)
    v_mfma_f32_32x32x16_bf16 v[108:123], v[72:75], v[168:171], v[108:123]
    ds_read_b64_tr_b16 v[64:65], v13 offset:13312
    ds_read_b64_tr_b16 v[66:67], v13 offset:13568
    s_waitcnt lgkmcnt(10)
    v_mfma_f32_32x32x16_bf16 v[108:123], v[44:47], v[172:175], v[108:123]
    ds_read_b64_tr_b16 v[68:69], v13 offset:14336
    ds_read_b64_tr_b16 v[70:71], v13 offset:14592
    s_waitcnt lgkmcnt(10)
    v_mfma_f32_32x32x16_bf16 v[108:123], v[48:51], v[176:179], v[108:123]
    ds_read_b64_tr_b16 v[72:73], v13 offset:15360
    ds_read_b64_tr_b16 v[74:75], v13 offset:15616
    s_waitcnt lgkmcnt(10)
    v_mfma_f32_32x32x16_bf16 v[108:123], v[52:55], v[180:183], v[108:123]
    ds_read_b64_tr_b16 v[44:45], v13 offset:16384
    ds_read_b64_tr_b16 v[46:47], v13 offset:16640
    s_waitcnt lgkmcnt(10)
    v_mfma_f32_32x32x16_bf16 v[108:123], v[56:59], v[184:187], v[108:123]
    ds_read_b64_tr_b16 v[48:49], v13 offset:17408
    ds_read_b64_tr_b16 v[50:51], v13 offset:17664
    s_waitcnt lgkmcnt(10)
    v_mfma_f32_32x32x16_bf16 v[108:123], v[60:63], v[188:191], v[108:123]
    ds_read_b64_tr_b16 v[52:53], v13 offset:18432
    ds_read_b64_tr_b16 v[54:55], v13 offset:18688
    v_mov_b32 v80, 0
    v_mov_b32 v81, 0
    v_mov_b32 v82, 0
    v_mov_b32 v83, 0
    s_waitcnt lgkmcnt(10)
    v_mfma_f32_32x32x16_bf16 v[108:123], v[64:67], v[192:195], v[108:123]
    ds_read_b64_tr_b16 v[56:57], v13 offset:19456
    ds_read_b64_tr_b16 v[58:59], v13 offset:19712
    v_mov_b32 v84, 0
    v_mov_b32 v85, 0
    v_mov_b32 v86, 0
    v_mov_b32 v87, 0
    v_mov_b32 v3, s24
    s_waitcnt vmcnt(3)
    s_mov_b64 exec, 1
    s_cmp_lg_u32 s25, 0
    s_cbranch_scc1 L_k_sl_46
    buffer_store_dword v3, off, s[20:23], s32
    s_branch L_k_sj_47
L_k_sl_46:

    s_waitcnt vmcnt(0)
    buffer_store_dword v3, off, s[20:23], s32 sc1
L_k_sj_47:
    s_mov_b64 exec, -1
    s_waitcnt lgkmcnt(10)
    v_mfma_f32_32x32x16_bf16 v[108:123], v[68:71], v[196:199], v[108:123]
    ds_read_b64_tr_b16 v[60:61], v13 offset:20480
    ds_read_b64_tr_b16 v[62:63], v13 offset:20736
    v_mov_b32 v96, 0
    v_mov_b32 v97, 0
    v_mov_b32 v98, 0
    v_mov_b32 v99, 0
    s_waitcnt lgkmcnt(10)
    v_mfma_f32_32x32x16_bf16 v[108:123], v[72:75], v[200:203], v[108:123]
    ds_read_b64_tr_b16 v[64:65], v13 offset:21504
    ds_read_b64_tr_b16 v[66:67], v13 offset:21760
    v_mov_b32 v100, 0
    v_mov_b32 v101, 0
    v_mov_b32 v102, 0
    v_mov_b32 v103, 0
    s_waitcnt lgkmcnt(10)
    v_mfma_f32_32x32x16_bf16 v[108:123], v[44:47], v[204:207], v[108:123]
    ds_read_b64_tr_b16 v[68:69], v13 offset:22528
    ds_read_b64_tr_b16 v[70:71], v13 offset:22784
    v_mov_b32 v140, 0
    v_mov_b32 v141, 0
    v_mov_b32 v142, 0
    v_mov_b32 v143, 0
    s_waitcnt lgkmcnt(10)
    v_mfma_f32_32x32x16_bf16 v[108:123], v[48:51], v[208:211], v[108:123]
    ds_read_b64_tr_b16 v[72:73], v13 offset:23552
    ds_read_b64_tr_b16 v[74:75], v13 offset:23808
    v_mov_b32 v144, 0
    v_mov_b32 v145, 0
    v_mov_b32 v146, 0
    v_mov_b32 v147, 0
    s_waitcnt lgkmcnt(10)
    v_mfma_f32_32x32x16_bf16 v[108:123], v[52:55], v[212:215], v[108:123]
    ds_read_b64_tr_b16 v[44:45], v13 offset:24576
    ds_read_b64_tr_b16 v[46:47], v13 offset:24832
    v_mov_b32 v148, 0
    v_mov_b32 v149, 0
    v_mov_b32 v150, 0
    v_mov_b32 v151, 0
    s_waitcnt lgkmcnt(10)
    v_mfma_f32_32x32x16_bf16 v[108:123], v[56:59], v[216:219], v[108:123]
    ds_read_b64_tr_b16 v[48:49], v13 offset:25600
    ds_read_b64_tr_b16 v[50:51], v13 offset:25856
    v_mov_b32 v152, 0
    v_mov_b32 v153, 0
    v_mov_b32 v154, 0
    v_mov_b32 v155, 0
    s_waitcnt lgkmcnt(10)
    v_mfma_f32_32x32x16_bf16 v[108:123], v[60:63], v[220:223], v[108:123]
    ds_read_b64_tr_b16 v[52:53], v13 offset:26624
    ds_read_b64_tr_b16 v[54:55], v13 offset:26880
    v_mov_b32 v156, 0
    v_mov_b32 v157, 0
    v_mov_b32 v158, 0
    v_mov_b32 v159, 0
    s_waitcnt lgkmcnt(10)
    v_mfma_f32_32x32x16_bf16 v[108:123], v[64:67], v[224:227], v[108:123]
    ds_read_b64_tr_b16 v[56:57], v13 offset:27648
    ds_read_b64_tr_b16 v[58:59], v13 offset:27904
    v_mov_b32 v160, 0
    v_mov_b32 v161, 0
    v_mov_b32 v162, 0
    v_mov_b32 v163, 0
    s_waitcnt lgkmcnt(10)
    v_mfma_f32_32x32x16_bf16 v[108:123], v[68:71], v[228:231], v[108:123]
    v_mov_b32 v164, 0
    v_mov_b32 v165, 0
    v_mov_b32 v166, 0
    v_mov_b32 v167, 0
    v_add_u32 v12, 78848, v2
    s_barrier
    ds_read_b128 v[32:35], v12
    s_waitcnt lgkmcnt(8)
    v_mfma_f32_32x32x16_bf16 v[108:123], v[72:75], v[232:235], v[108:123]
    v_mov_b32 v168, 0
    v_mov_b32 v169, 0
    v_mov_b32 v170, 0
    v_mov_b32 v171, 0
    s_waitcnt lgkmcnt(6)
    v_mfma_f32_32x32x16_bf16 v[108:123], v[44:47], v[236:239], v[108:123]
    v_mov_b32 v172, 0
    v_mov_b32 v173, 0
    v_mov_b32 v174, 0
    v_mov_b32 v175, 0
    s_waitcnt lgkmcnt(4)
    v_mfma_f32_32x32x16_bf16 v[108:123], v[48:51], v[240:243], v[108:123]
    v_mov_b32 v176, 0
    v_mov_b32 v177, 0
    v_mov_b32 v178, 0
    v_mov_b32 v179, 0
    s_waitcnt lgkmcnt(2)
    v_mfma_f32_32x32x16_bf16 v[108:123], v[52:55], v[244:247], v[108:123]
    v_mov_b32 v180, 0
    v_mov_b32 v181, 0
    v_mov_b32 v182, 0
    v_mov_b32 v183, 0
    s_waitcnt lgkmcnt(0)
    v_mfma_f32_32x32x16_bf16 v[108:123], v[56:59], v[248:251], v[108:123]
    v_mov_b32 v184, 0
    v_mov_b32 v185, 0
    v_mul_f32 v6, 0x3e8b97f6, v6
    s_lshl_b32 s31, s35, 11
    s_add_u32 s31, s31, 155648
    v_add_u32 v4, s31, v2
    v_cmp_lt_u32 vcc, 31, v1
    v_add_f32 v32, v32, v33
    v_add_f32 v34, v34, v35
    v_add_f32 v32, v32, v34
    s_nop 1
    v_mfma_f32_32x32x2_f32 v[108:123], v32, v5, v[108:123]
    v_mov_b32 v186, 0
    v_mov_b32 v187, 0
    v_mov_b32 v188, 0
    v_mov_b32 v189, 0
    v_mov_b32 v190, 0
    v_mov_b32 v191, 0
    v_mov_b32 v192, 0
    v_mov_b32 v193, 0
    v_mov_b32 v194, 0
    v_mov_b32 v195, 0
    v_mov_b32 v196, 0
    v_mov_b32 v197, 0
    v_mov_b32 v198, 0
    v_mov_b32 v199, 0
    v_mov_b32 v200, 0
    v_mov_b32 v201, 0
    v_mov_b32 v202, 0
    v_mov_b32 v203, 0
    v_mul_f32 v108, v108, v6
    v_mul_f32 v109, v109, v6
    v_mul_f32 v110, v110, v6
    v_mul_f32 v111, v111, v6
    v_mul_f32 v112, v112, v6
    v_mul_f32 v113, v113, v6
    v_mul_f32 v114, v114, v6
    v_mul_f32 v115, v115, v6
    v_mul_f32 v116, v116, v6
    v_mul_f32 v117, v117, v6
    v_mul_f32 v118, v118, v6
    v_mul_f32 v119, v119, v6
    v_mul_f32 v120, v120, v6
    v_mul_f32 v121, v121, v6
    v_mul_f32 v122, v122, v6
    v_mul_f32 v123, v123, v6
    v_cvt_pk_bf16_f32 v44, v108, v109
    v_cvt_pk_bf16_f32 v45, v110, v111
    v_cvt_pk_bf16_f32 v46, v112, v113
    v_cvt_pk_bf16_f32 v47, v114, v115
    v_cvt_pk_bf16_f32 v48, v116, v117
    v_cvt_pk_bf16_f32 v49, v118, v119
    v_cvt_pk_bf16_f32 v50, v120, v121
    v_cvt_pk_bf16_f32 v51, v122, v123
    v_cndmask_b32 v50, v50, 0, vcc
    v_cndmask_b32 v51, v51, 0, vcc
    ds_write_b128 v4, v[44:47]
    ds_write_b128 v4, v[48:51] offset:1024
    s_waitcnt lgkmcnt(0)
    s_barrier
    v_xor_b32 v3, 6144, v4
    ds_read_b128 v[8:11], v3
    ds_read_b128 v[12:15], v3 offset:1024
    v_xor_b32 v3, 4096, v4
    ds_read_b128 v[16:19], v3
    ds_read_b128 v[20:23], v3 offset:1024
    v_xor_b32 v3, 2048, v4
    ds_read_b128 v[24:27], v3
    ds_read_b128 v[28:31], v3 offset:1024
    v_xor_b32 v3, 0, v4
    ds_read_b128 v[32:35], v3
    ds_read_b128 v[36:39], v3 offset:1024
    s_mov_b32 s38, 0
L_k_Bmain_48:
    s_mul_i32 s31, s35, 16384
    s_add_u32 s31, s31, 86528
    v_add_u32 v5, s31, v2
    v_add_u32 v7, 152064, v2
    v_and_b32 v6, 31, v1
    s_mul_i32 s31, s35, 516
    v_lshl_add_u32 v6, v6, 4, s31
    s_waitcnt lgkmcnt(0)
    v_mfma_f32_32x32x16_bf16 v[40:55], v[124:127], v[8:11], 0
    v_mfma_f32_32x32x16_bf16 v[40:55], v[128:131], v[12:15], v[40:55]
    s_mov_b32 s37, 3
    s_waitcnt lgkmcnt(0)
    s_nop 7
    s_nop 2
    .p2align 6
L_k_Bloop_49:
    v_exp_f32 v40, v40
    v_exp_f32 v41, v41
    v_exp_f32 v42, v42
    v_cvt_pk_bf16_f32 v72, v40, v41
    v_exp_f32 v43, v43
    v_exp_f32 v44, v44
    v_mfma_f32_32x32x16_bf16 v[56:71], v[124:127], v[16:19], 0
    v_cvt_pk_bf16_f32 v73, v42, v43
    v_exp_f32 v45, v45
    v_exp_f32 v46, v46
    v_cvt_pk_bf16_f32 v74, v44, v45
    v_exp_f32 v47, v47
    v_exp_f32 v48, v48
    v_mfma_f32_32x32x16_bf16 v[56:71], v[128:131], v[20:23], v[56:71]
    v_cvt_pk_bf16_f32 v75, v46, v47
    v_exp_f32 v49, v49
    v_exp_f32 v50, v50
    v_cvt_pk_bf16_f32 v76, v48, v49
    v_exp_f32 v51, v51
    v_exp_f32 v52, v52
    v_mfma_f32_32x32x16_bf16 v[188:203], v[96:99], v[80:83], v[188:203]
    v_cvt_pk_bf16_f32 v77, v50, v51
    v_exp_f32 v53, v53
    v_exp_f32 v54, v54
    v_cvt_pk_bf16_f32 v78, v52, v53
    v_exp_f32 v55, v55
    v_mfma_f32_32x32x16_bf16 v[188:203], v[100:103], v[84:87], v[188:203]
    v_cvt_pk_bf16_f32 v79, v54, v55
    v_exp_f32 v56, v56
    v_exp_f32 v57, v57
    v_exp_f32 v58, v58
    v_cvt_pk_bf16_f32 v80, v56, v57
    v_exp_f32 v59, v59
    v_exp_f32 v60, v60
    v_mfma_f32_32x32x16_bf16 v[40:55], v[124:127], v[24:27], 0
    v_cvt_pk_bf16_f32 v81, v58, v59
    v_exp_f32 v61, v61
    v_exp_f32 v62, v62
    v_cvt_pk_bf16_f32 v82, v60, v61
    v_exp_f32 v63, v63
    v_exp_f32 v64, v64
    v_mfma_f32_32x32x16_bf16 v[40:55], v[128:131], v[28:31], v[40:55]
    v_cvt_pk_bf16_f32 v83, v62, v63
    v_exp_f32 v65, v65
    v_exp_f32 v66, v66
    v_cvt_pk_bf16_f32 v84, v64, v65
    v_exp_f32 v67, v67
    v_exp_f32 v68, v68
    v_mfma_f32_32x32x16_bf16 v[140:155], v[132:135], v[72:75], v[140:155]
    v_cvt_pk_bf16_f32 v85, v66, v67
    v_exp_f32 v69, v69
    v_exp_f32 v70, v70
    v_cvt_pk_bf16_f32 v86, v68, v69
    v_exp_f32 v71, v71
    v_mfma_f32_32x32x16_bf16 v[140:155], v[136:139], v[76:79], v[140:155]
    s_barrier
    v_cvt_pk_bf16_f32 v87, v70, v71
    v_exp_f32 v40, v40
    v_exp_f32 v41, v41
    v_exp_f32 v42, v42
    v_cvt_pk_bf16_f32 v72, v40, v41
    v_exp_f32 v43, v43
    v_exp_f32 v44, v44
    v_mfma_f32_32x32x16_bf16 v[56:71], v[124:127], v[32:35], 0
    ds_read_b128 v[88:91], v5 offset:4096
    v_cvt_pk_bf16_f32 v73, v42, v43
    v_exp_f32 v45, v45
    v_exp_f32 v46, v46
    v_cvt_pk_bf16_f32 v74, v44, v45
    v_exp_f32 v47, v47
    v_exp_f32 v48, v48
    v_mfma_f32_32x32x16_bf16 v[56:71], v[128:131], v[36:39], v[56:71]
    ds_read_b128 v[92:95], v5 offset:5120
    v_cvt_pk_bf16_f32 v75, v46, v47
    v_exp_f32 v49, v49
    v_exp_f32 v50, v50
    v_cvt_pk_bf16_f32 v76, v48, v49
    v_exp_f32 v51, v51
    v_exp_f32 v52, v52
    v_mfma_f32_32x32x16_bf16 v[156:171], v[132:135], v[80:83], v[156:171]
    ds_read_b128 v[96:99], v5 offset:6144
    v_cvt_pk_bf16_f32 v77, v50, v51
    v_exp_f32 v53, v53
    v_exp_f32 v54, v54
    v_cvt_pk_bf16_f32 v78, v52, v53
    v_exp_f32 v55, v55
    v_mfma_f32_32x32x16_bf16 v[156:171], v[136:139], v[84:87], v[156:171]
    ds_read_b128 v[100:103], v5 offset:7168
    s_waitcnt lgkmcnt(2)
    v_cvt_pk_bf16_f32 v79, v54, v55
    v_exp_f32 v56, v56
    v_exp_f32 v57, v57
    v_exp_f32 v58, v58
    v_cvt_pk_bf16_f32 v80, v56, v57
    v_exp_f32 v59, v59
    v_exp_f32 v60, v60
    v_mfma_f32_32x32x16_bf16 v[40:55], v[88:91], v[8:11], 0
    v_cvt_pk_bf16_f32 v81, v58, v59
    v_exp_f32 v61, v61
    v_exp_f32 v62, v62
    v_cvt_pk_bf16_f32 v82, v60, v61
    v_exp_f32 v63, v63
    v_exp_f32 v64, v64
    v_mfma_f32_32x32x16_bf16 v[40:55], v[92:95], v[12:15], v[40:55]
    s_waitcnt lgkmcnt(0)
    v_cvt_pk_bf16_f32 v83, v62, v63
    v_exp_f32 v65, v65
    v_exp_f32 v66, v66
    v_cvt_pk_bf16_f32 v84, v64, v65
    v_exp_f32 v67, v67
    v_exp_f32 v68, v68
    v_mfma_f32_32x32x16_bf16 v[172:187], v[132:135], v[72:75], v[172:187]
    v_cvt_pk_bf16_f32 v85, v66, v67
    v_exp_f32 v69, v69
    v_exp_f32 v70, v70
    v_cvt_pk_bf16_f32 v86, v68, v69
    v_exp_f32 v71, v71
    v_mfma_f32_32x32x16_bf16 v[172:187], v[136:139], v[76:79], v[172:187]
    v_cvt_pk_bf16_f32 v87, v70, v71
    v_exp_f32 v40, v40
    v_exp_f32 v41, v41
    v_exp_f32 v42, v42
    v_cvt_pk_bf16_f32 v72, v40, v41
    v_exp_f32 v43, v43
    v_exp_f32 v44, v44
    v_mfma_f32_32x32x16_bf16 v[56:71], v[88:91], v[16:19], 0
    v_cvt_pk_bf16_f32 v73, v42, v43
    v_exp_f32 v45, v45
    v_exp_f32 v46, v46
    v_cvt_pk_bf16_f32 v74, v44, v45
    v_exp_f32 v47, v47
    v_exp_f32 v48, v48
    v_mfma_f32_32x32x16_bf16 v[56:71], v[92:95], v[20:23], v[56:71]
    v_cvt_pk_bf16_f32 v75, v46, v47
    v_exp_f32 v49, v49
    v_exp_f32 v50, v50
    v_cvt_pk_bf16_f32 v76, v48, v49
    v_exp_f32 v51, v51
    v_exp_f32 v52, v52
    v_mfma_f32_32x32x16_bf16 v[188:203], v[132:135], v[80:83], v[188:203]
    v_cvt_pk_bf16_f32 v77, v50, v51
    v_exp_f32 v53, v53
    v_exp_f32 v54, v54
    v_cvt_pk_bf16_f32 v78, v52, v53
    v_exp_f32 v55, v55
    v_mfma_f32_32x32x16_bf16 v[188:203], v[136:139], v[84:87], v[188:203]
    v_cvt_pk_bf16_f32 v79, v54, v55
    v_exp_f32 v56, v56
    v_exp_f32 v57, v57
    v_exp_f32 v58, v58
    v_cvt_pk_bf16_f32 v80, v56, v57
    v_exp_f32 v59, v59
    v_exp_f32 v60, v60
    v_mfma_f32_32x32x16_bf16 v[40:55], v[88:91], v[24:27], 0
    v_cvt_pk_bf16_f32 v81, v58, v59
    v_exp_f32 v61, v61
    v_exp_f32 v62, v62
    v_cvt_pk_bf16_f32 v82, v60, v61
    v_exp_f32 v63, v63
    v_exp_f32 v64, v64
    v_mfma_f32_32x32x16_bf16 v[40:55], v[92:95], v[28:31], v[40:55]
    v_cvt_pk_bf16_f32 v83, v62, v63
    v_exp_f32 v65, v65
    v_exp_f32 v66, v66
    v_cvt_pk_bf16_f32 v84, v64, v65
    v_exp_f32 v67, v67
    v_exp_f32 v68, v68
    v_mfma_f32_32x32x16_bf16 v[140:155], v[96:99], v[72:75], v[140:155]
    v_cvt_pk_bf16_f32 v85, v66, v67
    v_exp_f32 v69, v69
    v_exp_f32 v70, v70
    v_cvt_pk_bf16_f32 v86, v68, v69
    v_exp_f32 v71, v71
    v_mfma_f32_32x32x16_bf16 v[140:155], v[100:103], v[76:79], v[140:155]
    s_barrier
    v_cvt_pk_bf16_f32 v87, v70, v71
    v_exp_f32 v40, v40
    v_exp_f32 v41, v41
    v_exp_f32 v42, v42
    v_cvt_pk_bf16_f32 v72, v40, v41
    v_exp_f32 v43, v43
    v_exp_f32 v44, v44
    v_mfma_f32_32x32x16_bf16 v[56:71], v[88:91], v[32:35], 0
    ds_read_b128 v[124:127], v5 offset:8192
    v_cvt_pk_bf16_f32 v73, v42, v43
    v_exp_f32 v45, v45
    v_exp_f32 v46, v46
    v_cvt_pk_bf16_f32 v74, v44, v45
    v_exp_f32 v47, v47
    v_exp_f32 v48, v48
    v_mfma_f32_32x32x16_bf16 v[56:71], v[92:95], v[36:39], v[56:71]
    ds_read_b128 v[128:131], v5 offset:9216
    v_cvt_pk_bf16_f32 v75, v46, v47
    v_exp_f32 v49, v49
    v_exp_f32 v50, v50
    v_cvt_pk_bf16_f32 v76, v48, v49
    v_exp_f32 v51, v51
    v_exp_f32 v52, v52
    v_mfma_f32_32x32x16_bf16 v[156:171], v[96:99], v[80:83], v[156:171]
    ds_read_b128 v[132:135], v5 offset:10240
    v_cvt_pk_bf16_f32 v77, v50, v51
    v_exp_f32 v53, v53
    v_exp_f32 v54, v54
    v_cvt_pk_bf16_f32 v78, v52, v53
    v_exp_f32 v55, v55
    v_mfma_f32_32x32x16_bf16 v[156:171], v[100:103], v[84:87], v[156:171]
    ds_read_b128 v[136:139], v5 offset:11264
    s_waitcnt lgkmcnt(2)
    v_cvt_pk_bf16_f32 v79, v54, v55
    v_exp_f32 v56, v56
    v_exp_f32 v57, v57
    v_exp_f32 v58, v58
    v_cvt_pk_bf16_f32 v80, v56, v57
    v_exp_f32 v59, v59
    v_exp_f32 v60, v60
    v_mfma_f32_32x32x16_bf16 v[40:55], v[124:127], v[8:11], 0
    v_cvt_pk_bf16_f32 v81, v58, v59
    v_exp_f32 v61, v61
    v_exp_f32 v62, v62
    v_cvt_pk_bf16_f32 v82, v60, v61
    v_exp_f32 v63, v63
    v_exp_f32 v64, v64
    v_mfma_f32_32x32x16_bf16 v[40:55], v[128:131], v[12:15], v[40:55]
    s_waitcnt lgkmcnt(0)
    v_cvt_pk_bf16_f32 v83, v62, v63
    v_exp_f32 v65, v65
    v_exp_f32 v66, v66
    v_cvt_pk_bf16_f32 v84, v64, v65
    v_exp_f32 v67, v67
    v_exp_f32 v68, v68
    v_mfma_f32_32x32x16_bf16 v[172:187], v[96:99], v[72:75], v[172:187]
    v_cvt_pk_bf16_f32 v85, v66, v67
    v_exp_f32 v69, v69
    v_exp_f32 v70, v70
    v_cvt_pk_bf16_f32 v86, v68, v69
    v_exp_f32 v71, v71
    v_mfma_f32_32x32x16_bf16 v[172:187], v[100:103], v[76:79], v[172:187]
    v_cvt_pk_bf16_f32 v87, v70, v71
    v_exp_f32 v40, v40
    v_exp_f32 v41, v41
    v_exp_f32 v42, v42
    v_cvt_pk_bf16_f32 v72, v40, v41
    v_exp_f32 v43, v43
    v_exp_f32 v44, v44
    v_mfma_f32_32x32x16_bf16 v[56:71], v[124:127], v[16:19], 0
    v_cvt_pk_bf16_f32 v73, v42, v43
    v_exp_f32 v45, v45
    v_exp_f32 v46, v46
    v_cvt_pk_bf16_f32 v74, v44, v45
    v_exp_f32 v47, v47
    v_exp_f32 v48, v48
    v_mfma_f32_32x32x16_bf16 v[56:71], v[128:131], v[20:23], v[56:71]
    v_cvt_pk_bf16_f32 v75, v46, v47
    v_exp_f32 v49, v49
    v_exp_f32 v50, v50
    v_cvt_pk_bf16_f32 v76, v48, v49
    v_exp_f32 v51, v51
    v_exp_f32 v52, v52
    v_mfma_f32_32x32x16_bf16 v[188:203], v[96:99], v[80:83], v[188:203]
    v_cvt_pk_bf16_f32 v77, v50, v51
    v_exp_f32 v53, v53
    v_exp_f32 v54, v54
    v_cvt_pk_bf16_f32 v78, v52, v53
    v_exp_f32 v55, v55
    v_mfma_f32_32x32x16_bf16 v[188:203], v[100:103], v[84:87], v[188:203]
    v_cvt_pk_bf16_f32 v79, v54, v55
    v_exp_f32 v56, v56
    v_exp_f32 v57, v57
    v_exp_f32 v58, v58
    v_cvt_pk_bf16_f32 v80, v56, v57
    v_exp_f32 v59, v59
    v_exp_f32 v60, v60
    v_mfma_f32_32x32x16_bf16 v[40:55], v[124:127], v[24:27], 0
    v_cvt_pk_bf16_f32 v81, v58, v59
    v_exp_f32 v61, v61
    v_exp_f32 v62, v62
    v_cvt_pk_bf16_f32 v82, v60, v61
    v_exp_f32 v63, v63
    v_exp_f32 v64, v64
    v_mfma_f32_32x32x16_bf16 v[40:55], v[128:131], v[28:31], v[40:55]
    v_cvt_pk_bf16_f32 v83, v62, v63
    v_exp_f32 v65, v65
    v_exp_f32 v66, v66
    v_cvt_pk_bf16_f32 v84, v64, v65
    v_exp_f32 v67, v67
    v_exp_f32 v68, v68
    v_mfma_f32_32x32x16_bf16 v[140:155], v[132:135], v[72:75], v[140:155]
    v_cvt_pk_bf16_f32 v85, v66, v67
    v_exp_f32 v69, v69
    v_exp_f32 v70, v70
    v_cvt_pk_bf16_f32 v86, v68, v69
    v_exp_f32 v71, v71
    v_mfma_f32_32x32x16_bf16 v[140:155], v[136:139], v[76:79], v[140:155]
    s_barrier
    v_cvt_pk_bf16_f32 v87, v70, v71
    v_exp_f32 v40, v40
    v_exp_f32 v41, v41
    v_exp_f32 v42, v42
    v_cvt_pk_bf16_f32 v72, v40, v41
    v_exp_f32 v43, v43
    v_exp_f32 v44, v44
    v_mfma_f32_32x32x16_bf16 v[56:71], v[124:127], v[32:35], 0
    ds_read_b128 v[88:91], v5 offset:12288
    v_cvt_pk_bf16_f32 v73, v42, v43
    v_exp_f32 v45, v45
    v_exp_f32 v46, v46
    v_cvt_pk_bf16_f32 v74, v44, v45
    v_exp_f32 v47, v47
    v_exp_f32 v48, v48
    v_mfma_f32_32x32x16_bf16 v[56:71], v[128:131], v[36:39], v[56:71]
    ds_read_b128 v[92:95], v5 offset:13312
    v_cvt_pk_bf16_f32 v75, v46, v47
    v_exp_f32 v49, v49
    v_exp_f32 v50, v50
    v_cvt_pk_bf16_f32 v76, v48, v49
    v_exp_f32 v51, v51
    v_exp_f32 v52, v52
    v_mfma_f32_32x32x16_bf16 v[156:171], v[132:135], v[80:83], v[156:171]
    ds_read_b128 v[96:99], v5 offset:14336
    v_cvt_pk_bf16_f32 v77, v50, v51
    v_exp_f32 v53, v53
    v_exp_f32 v54, v54
    v_cvt_pk_bf16_f32 v78, v52, v53
    v_exp_f32 v55, v55
    v_mfma_f32_32x32x16_bf16 v[156:171], v[136:139], v[84:87], v[156:171]
    ds_read_b128 v[100:103], v5 offset:15360
    s_waitcnt lgkmcnt(2)
    v_cvt_pk_bf16_f32 v79, v54, v55
    v_exp_f32 v56, v56
    v_exp_f32 v57, v57
    v_exp_f32 v58, v58
    v_cvt_pk_bf16_f32 v80, v56, v57
    v_exp_f32 v59, v59
    v_exp_f32 v60, v60
    v_mfma_f32_32x32x16_bf16 v[40:55], v[88:91], v[8:11], 0
    v_cvt_pk_bf16_f32 v81, v58, v59
    v_exp_f32 v61, v61
    v_exp_f32 v62, v62
    v_cvt_pk_bf16_f32 v82, v60, v61
    v_exp_f32 v63, v63
    v_exp_f32 v64, v64
    v_mfma_f32_32x32x16_bf16 v[40:55], v[92:95], v[12:15], v[40:55]
    s_waitcnt lgkmcnt(0)
    v_cvt_pk_bf16_f32 v83, v62, v63
    v_exp_f32 v65, v65
    v_exp_f32 v66, v66
    v_cvt_pk_bf16_f32 v84, v64, v65
    v_exp_f32 v67, v67
    v_exp_f32 v68, v68
    v_mfma_f32_32x32x16_bf16 v[172:187], v[132:135], v[72:75], v[172:187]
    v_cvt_pk_bf16_f32 v85, v66, v67
    v_exp_f32 v69, v69
    v_exp_f32 v70, v70
    v_cvt_pk_bf16_f32 v86, v68, v69
    v_exp_f32 v71, v71
    v_mfma_f32_32x32x16_bf16 v[172:187], v[136:139], v[76:79], v[172:187]
    v_cvt_pk_bf16_f32 v87, v70, v71
    v_exp_f32 v40, v40
    v_exp_f32 v41, v41
    v_exp_f32 v42, v42
    v_cvt_pk_bf16_f32 v72, v40, v41
    v_exp_f32 v43, v43
    v_exp_f32 v44, v44
    v_mfma_f32_32x32x16_bf16 v[56:71], v[88:91], v[16:19], 0
    v_cvt_pk_bf16_f32 v73, v42, v43
    v_exp_f32 v45, v45
    v_exp_f32 v46, v46
    v_cvt_pk_bf16_f32 v74, v44, v45
    v_exp_f32 v47, v47
    v_exp_f32 v48, v48
    v_mfma_f32_32x32x16_bf16 v[56:71], v[92:95], v[20:23], v[56:71]
    v_cvt_pk_bf16_f32 v75, v46, v47
    v_exp_f32 v49, v49
    v_exp_f32 v50, v50
    v_cvt_pk_bf16_f32 v76, v48, v49
    v_exp_f32 v51, v51
    v_exp_f32 v52, v52
    v_mfma_f32_32x32x16_bf16 v[188:203], v[132:135], v[80:83], v[188:203]
    v_cvt_pk_bf16_f32 v77, v50, v51
    v_exp_f32 v53, v53
    v_exp_f32 v54, v54
    v_cvt_pk_bf16_f32 v78, v52, v53
    v_exp_f32 v55, v55
    v_mfma_f32_32x32x16_bf16 v[188:203], v[136:139], v[84:87], v[188:203]
    v_cvt_pk_bf16_f32 v79, v54, v55
    v_exp_f32 v56, v56
    v_exp_f32 v57, v57
    v_exp_f32 v58, v58
    v_cvt_pk_bf16_f32 v80, v56, v57
    v_exp_f32 v59, v59
    v_exp_f32 v60, v60
    v_mfma_f32_32x32x16_bf16 v[40:55], v[88:91], v[24:27], 0
    v_cvt_pk_bf16_f32 v81, v58, v59
    v_exp_f32 v61, v61
    v_exp_f32 v62, v62
    v_cvt_pk_bf16_f32 v82, v60, v61
    v_exp_f32 v63, v63
    v_exp_f32 v64, v64
    v_mfma_f32_32x32x16_bf16 v[40:55], v[92:95], v[28:31], v[40:55]
    v_cvt_pk_bf16_f32 v83, v62, v63
    v_exp_f32 v65, v65
    v_exp_f32 v66, v66
    v_cvt_pk_bf16_f32 v84, v64, v65
    v_exp_f32 v67, v67
    v_exp_f32 v68, v68
    v_mfma_f32_32x32x16_bf16 v[140:155], v[96:99], v[72:75], v[140:155]
    v_cvt_pk_bf16_f32 v85, v66, v67
    v_exp_f32 v69, v69
    v_exp_f32 v70, v70
    v_cvt_pk_bf16_f32 v86, v68, v69
    v_exp_f32 v71, v71
    v_mfma_f32_32x32x16_bf16 v[140:155], v[100:103], v[76:79], v[140:155]
    s_barrier
    v_cvt_pk_bf16_f32 v87, v70, v71
    v_exp_f32 v40, v40
    v_exp_f32 v41, v41
    v_exp_f32 v42, v42
    v_cvt_pk_bf16_f32 v72, v40, v41
    v_exp_f32 v43, v43
    v_exp_f32 v44, v44
    v_mfma_f32_32x32x16_bf16 v[56:71], v[88:91], v[32:35], 0
    ds_read_b128 v[124:127], v5 offset:0
    v_cvt_pk_bf16_f32 v73, v42, v43
    v_exp_f32 v45, v45
    v_exp_f32 v46, v46
    v_cvt_pk_bf16_f32 v74, v44, v45
    v_exp_f32 v47, v47
    v_exp_f32 v48, v48
    v_mfma_f32_32x32x16_bf16 v[56:71], v[92:95], v[36:39], v[56:71]
    ds_read_b128 v[128:131], v5 offset:1024
    v_cvt_pk_bf16_f32 v75, v46, v47
    v_exp_f32 v49, v49
    v_exp_f32 v50, v50
    v_cvt_pk_bf16_f32 v76, v48, v49
    v_exp_f32 v51, v51
    v_exp_f32 v52, v52
    v_mfma_f32_32x32x16_bf16 v[156:171], v[96:99], v[80:83], v[156:171]
    ds_read_b128 v[132:135], v5 offset:2048
    v_cvt_pk_bf16_f32 v77, v50, v51
    v_exp_f32 v53, v53
    v_exp_f32 v54, v54
    v_cvt_pk_bf16_f32 v78, v52, v53
    v_exp_f32 v55, v55
    v_mfma_f32_32x32x16_bf16 v[156:171], v[100:103], v[84:87], v[156:171]
    ds_read_b128 v[136:139], v5 offset:3072
    s_waitcnt lgkmcnt(2)
    v_cvt_pk_bf16_f32 v79, v54, v55
    v_exp_f32 v56, v56
    v_exp_f32 v57, v57
    v_exp_f32 v58, v58
    v_cvt_pk_bf16_f32 v80, v56, v57
    v_exp_f32 v59, v59
    v_exp_f32 v60, v60
    v_mfma_f32_32x32x16_bf16 v[40:55], v[124:127], v[8:11], 0
    v_cvt_pk_bf16_f32 v81, v58, v59
    v_exp_f32 v61, v61
    v_exp_f32 v62, v62
    v_cvt_pk_bf16_f32 v82, v60, v61
    v_exp_f32 v63, v63
    v_exp_f32 v64, v64
    v_mfma_f32_32x32x16_bf16 v[40:55], v[128:131], v[12:15], v[40:55]
    s_waitcnt lgkmcnt(0)
    v_cvt_pk_bf16_f32 v83, v62, v63
    v_exp_f32 v65, v65
    v_exp_f32 v66, v66
    v_cvt_pk_bf16_f32 v84, v64, v65
    v_exp_f32 v67, v67
    v_exp_f32 v68, v68
    v_mfma_f32_32x32x16_bf16 v[172:187], v[96:99], v[72:75], v[172:187]
    s_sub_u32 s37, s37, 1
    v_cvt_pk_bf16_f32 v85, v66, v67
    v_exp_f32 v69, v69
    v_exp_f32 v70, v70
    v_cvt_pk_bf16_f32 v86, v68, v69
    v_exp_f32 v71, v71
    v_mfma_f32_32x32x16_bf16 v[172:187], v[100:103], v[76:79], v[172:187]
    s_cmp_lg_u32 s37, 0
    v_cvt_pk_bf16_f32 v87, v70, v71
    s_cbranch_scc1 L_k_Bloop_49
    v_exp_f32 v40, v40
    v_exp_f32 v41, v41
    v_exp_f32 v42, v42
    v_cvt_pk_bf16_f32 v72, v40, v41
    v_exp_f32 v43, v43
    v_exp_f32 v44, v44
    v_mfma_f32_32x32x16_bf16 v[56:71], v[124:127], v[16:19], 0
    v_cvt_pk_bf16_f32 v73, v42, v43
    v_exp_f32 v45, v45
    v_exp_f32 v46, v46
    v_cvt_pk_bf16_f32 v74, v44, v45
    v_exp_f32 v47, v47
    v_exp_f32 v48, v48
    v_mfma_f32_32x32x16_bf16 v[56:71], v[128:131], v[20:23], v[56:71]
    v_cvt_pk_bf16_f32 v75, v46, v47
    v_exp_f32 v49, v49
    v_exp_f32 v50, v50
    v_cvt_pk_bf16_f32 v76, v48, v49
    v_exp_f32 v51, v51
    v_exp_f32 v52, v52
    v_mfma_f32_32x32x16_bf16 v[188:203], v[96:99], v[80:83], v[188:203]
    v_cvt_pk_bf16_f32 v77, v50, v51
    v_exp_f32 v53, v53
    v_exp_f32 v54, v54
    v_cvt_pk_bf16_f32 v78, v52, v53
    v_exp_f32 v55, v55
    v_mfma_f32_32x32x16_bf16 v[188:203], v[100:103], v[84:87], v[188:203]
    v_cvt_pk_bf16_f32 v79, v54, v55
    v_exp_f32 v56, v56
    v_exp_f32 v57, v57
    v_exp_f32 v58, v58
    v_cvt_pk_bf16_f32 v80, v56, v57
    v_exp_f32 v59, v59
    v_exp_f32 v60, v60
    v_mfma_f32_32x32x16_bf16 v[40:55], v[124:127], v[24:27], 0
    v_cvt_pk_bf16_f32 v81, v58, v59
    v_exp_f32 v61, v61
    v_exp_f32 v62, v62
    v_cvt_pk_bf16_f32 v82, v60, v61
    v_exp_f32 v63, v63
    v_exp_f32 v64, v64
    v_mfma_f32_32x32x16_bf16 v[40:55], v[128:131], v[28:31], v[40:55]
    v_cvt_pk_bf16_f32 v83, v62, v63
    v_exp_f32 v65, v65
    v_exp_f32 v66, v66
    v_cvt_pk_bf16_f32 v84, v64, v65
    v_exp_f32 v67, v67
    v_exp_f32 v68, v68
    v_mfma_f32_32x32x16_bf16 v[140:155], v[132:135], v[72:75], v[140:155]
    v_cvt_pk_bf16_f32 v85, v66, v67
    v_exp_f32 v69, v69
    v_exp_f32 v70, v70
    v_cvt_pk_bf16_f32 v86, v68, v69
    v_exp_f32 v71, v71
    v_mfma_f32_32x32x16_bf16 v[140:155], v[136:139], v[76:79], v[140:155]
    s_barrier
    v_cvt_pk_bf16_f32 v87, v70, v71
    v_exp_f32 v40, v40
    v_exp_f32 v41, v41
    v_exp_f32 v42, v42
    v_cvt_pk_bf16_f32 v72, v40, v41
    v_exp_f32 v43, v43
    v_exp_f32 v44, v44
    v_mfma_f32_32x32x16_bf16 v[56:71], v[124:127], v[32:35], 0
    ds_read_b128 v[88:91], v5 offset:4096
    v_cvt_pk_bf16_f32 v73, v42, v43
    v_exp_f32 v45, v45
    v_exp_f32 v46, v46
    v_cvt_pk_bf16_f32 v74, v44, v45
    v_exp_f32 v47, v47
    v_exp_f32 v48, v48
    v_mfma_f32_32x32x16_bf16 v[56:71], v[128:131], v[36:39], v[56:71]
    ds_read_b128 v[92:95], v5 offset:5120
    v_cvt_pk_bf16_f32 v75, v46, v47
    v_exp_f32 v49, v49
    v_exp_f32 v50, v50
    v_cvt_pk_bf16_f32 v76, v48, v49
    v_exp_f32 v51, v51
    v_exp_f32 v52, v52
    v_mfma_f32_32x32x16_bf16 v[156:171], v[132:135], v[80:83], v[156:171]
    ds_read_b128 v[96:99], v5 offset:6144
    v_cvt_pk_bf16_f32 v77, v50, v51
    v_exp_f32 v53, v53
    v_exp_f32 v54, v54
    v_cvt_pk_bf16_f32 v78, v52, v53
    v_exp_f32 v55, v55
    v_mfma_f32_32x32x16_bf16 v[156:171], v[136:139], v[84:87], v[156:171]
    ds_read_b128 v[100:103], v5 offset:7168
    s_waitcnt lgkmcnt(2)
    v_cvt_pk_bf16_f32 v79, v54, v55
    v_exp_f32 v56, v56
    v_exp_f32 v57, v57
    v_exp_f32 v58, v58
    v_cvt_pk_bf16_f32 v80, v56, v57
    v_exp_f32 v59, v59
    v_exp_f32 v60, v60
    v_mfma_f32_32x32x16_bf16 v[40:55], v[88:91], v[8:11], 0
    v_cvt_pk_bf16_f32 v81, v58, v59
    v_exp_f32 v61, v61
    v_exp_f32 v62, v62
    v_cvt_pk_bf16_f32 v82, v60, v61
    v_exp_f32 v63, v63
    v_exp_f32 v64, v64
    v_mfma_f32_32x32x16_bf16 v[40:55], v[92:95], v[12:15], v[40:55]
    s_waitcnt lgkmcnt(0)
    v_cvt_pk_bf16_f32 v83, v62, v63
    v_exp_f32 v65, v65
    v_exp_f32 v66, v66
    v_cvt_pk_bf16_f32 v84, v64, v65
    v_exp_f32 v67, v67
    v_exp_f32 v68, v68
    v_mfma_f32_32x32x16_bf16 v[172:187], v[132:135], v[72:75], v[172:187]
    v_cvt_pk_bf16_f32 v85, v66, v67
    v_exp_f32 v69, v69
    v_exp_f32 v70, v70
    v_cvt_pk_bf16_f32 v86, v68, v69
    v_exp_f32 v71, v71
    v_mfma_f32_32x32x16_bf16 v[172:187], v[136:139], v[76:79], v[172:187]
    v_cvt_pk_bf16_f32 v87, v70, v71
    v_exp_f32 v40, v40
    v_exp_f32 v41, v41
    v_exp_f32 v42, v42
    v_cvt_pk_bf16_f32 v72, v40, v41
    v_exp_f32 v43, v43
    v_exp_f32 v44, v44
    v_mfma_f32_32x32x16_bf16 v[56:71], v[88:91], v[16:19], 0
    v_cvt_pk_bf16_f32 v73, v42, v43
    v_exp_f32 v45, v45
    v_exp_f32 v46, v46
    v_cvt_pk_bf16_f32 v74, v44, v45
    v_exp_f32 v47, v47
    v_exp_f32 v48, v48
    v_mfma_f32_32x32x16_bf16 v[56:71], v[92:95], v[20:23], v[56:71]
    v_cvt_pk_bf16_f32 v75, v46, v47
    v_exp_f32 v49, v49
    v_exp_f32 v50, v50
    v_cvt_pk_bf16_f32 v76, v48, v49
    v_exp_f32 v51, v51
    v_exp_f32 v52, v52
    v_mfma_f32_32x32x16_bf16 v[188:203], v[132:135], v[80:83], v[188:203]
    v_cvt_pk_bf16_f32 v77, v50, v51
    v_exp_f32 v53, v53
    v_exp_f32 v54, v54
    v_cvt_pk_bf16_f32 v78, v52, v53
    v_exp_f32 v55, v55
    v_mfma_f32_32x32x16_bf16 v[188:203], v[136:139], v[84:87], v[188:203]
    v_cvt_pk_bf16_f32 v79, v54, v55
    v_exp_f32 v56, v56
    v_exp_f32 v57, v57
    v_exp_f32 v58, v58
    v_cvt_pk_bf16_f32 v80, v56, v57
    v_exp_f32 v59, v59
    v_exp_f32 v60, v60
    v_mfma_f32_32x32x16_bf16 v[40:55], v[88:91], v[24:27], 0
    v_cvt_pk_bf16_f32 v81, v58, v59
    v_exp_f32 v61, v61
    v_exp_f32 v62, v62
    v_cvt_pk_bf16_f32 v82, v60, v61
    v_exp_f32 v63, v63
    v_exp_f32 v64, v64
    v_mfma_f32_32x32x16_bf16 v[40:55], v[92:95], v[28:31], v[40:55]
    v_cvt_pk_bf16_f32 v83, v62, v63
    v_exp_f32 v65, v65
    v_exp_f32 v66, v66
    v_cvt_pk_bf16_f32 v84, v64, v65
    v_exp_f32 v67, v67
    v_exp_f32 v68, v68
    v_mfma_f32_32x32x16_bf16 v[140:155], v[96:99], v[72:75], v[140:155]
    v_cvt_pk_bf16_f32 v85, v66, v67
    v_exp_f32 v69, v69
    v_exp_f32 v70, v70
    v_cvt_pk_bf16_f32 v86, v68, v69
    v_exp_f32 v71, v71
    v_mfma_f32_32x32x16_bf16 v[140:155], v[100:103], v[76:79], v[140:155]
    s_barrier
    v_cvt_pk_bf16_f32 v87, v70, v71
    v_exp_f32 v40, v40
    v_exp_f32 v41, v41
    v_exp_f32 v42, v42
    v_cvt_pk_bf16_f32 v72, v40, v41
    v_exp_f32 v43, v43
    v_exp_f32 v44, v44
    v_mfma_f32_32x32x16_bf16 v[56:71], v[88:91], v[32:35], 0
    ds_read_b128 v[124:127], v5 offset:8192
    v_cvt_pk_bf16_f32 v73, v42, v43
    v_exp_f32 v45, v45
    v_exp_f32 v46, v46
    v_cvt_pk_bf16_f32 v74, v44, v45
    v_exp_f32 v47, v47
    v_exp_f32 v48, v48
    v_mfma_f32_32x32x16_bf16 v[56:71], v[92:95], v[36:39], v[56:71]
    ds_read_b128 v[128:131], v5 offset:9216
    v_cvt_pk_bf16_f32 v75, v46, v47
    v_exp_f32 v49, v49
    v_exp_f32 v50, v50
    v_cvt_pk_bf16_f32 v76, v48, v49
    v_exp_f32 v51, v51
    v_exp_f32 v52, v52
    v_mfma_f32_32x32x16_bf16 v[156:171], v[96:99], v[80:83], v[156:171]
    ds_read_b128 v[132:135], v5 offset:10240
    v_cvt_pk_bf16_f32 v77, v50, v51
    v_exp_f32 v53, v53
    v_exp_f32 v54, v54
    v_cvt_pk_bf16_f32 v78, v52, v53
    v_exp_f32 v55, v55
    v_mfma_f32_32x32x16_bf16 v[156:171], v[100:103], v[84:87], v[156:171]
    ds_read_b128 v[136:139], v5 offset:11264
    s_waitcnt lgkmcnt(2)
    v_cvt_pk_bf16_f32 v79, v54, v55
    v_exp_f32 v56, v56
    v_exp_f32 v57, v57
    v_exp_f32 v58, v58
    v_cvt_pk_bf16_f32 v80, v56, v57
    v_exp_f32 v59, v59
    v_exp_f32 v60, v60
    v_mfma_f32_32x32x16_bf16 v[40:55], v[124:127], v[8:11], 0
    v_cvt_pk_bf16_f32 v81, v58, v59
    v_exp_f32 v61, v61
    v_exp_f32 v62, v62
    v_cvt_pk_bf16_f32 v82, v60, v61
    v_exp_f32 v63, v63
    v_exp_f32 v64, v64
    v_mfma_f32_32x32x16_bf16 v[40:55], v[128:131], v[12:15], v[40:55]
    s_waitcnt lgkmcnt(0)
    v_cvt_pk_bf16_f32 v83, v62, v63
    v_exp_f32 v65, v65
    v_exp_f32 v66, v66
    v_cvt_pk_bf16_f32 v84, v64, v65
    v_exp_f32 v67, v67
    v_exp_f32 v68, v68
    v_mfma_f32_32x32x16_bf16 v[172:187], v[96:99], v[72:75], v[172:187]
    v_cvt_pk_bf16_f32 v85, v66, v67
    v_exp_f32 v69, v69
    v_exp_f32 v70, v70
    v_cvt_pk_bf16_f32 v86, v68, v69
    v_exp_f32 v71, v71
    v_mfma_f32_32x32x16_bf16 v[172:187], v[100:103], v[76:79], v[172:187]
    v_cvt_pk_bf16_f32 v87, v70, v71
    v_exp_f32 v40, v40
    v_exp_f32 v41, v41
    v_exp_f32 v42, v42
    v_cvt_pk_bf16_f32 v72, v40, v41
    v_exp_f32 v43, v43
    v_exp_f32 v44, v44
    v_mfma_f32_32x32x16_bf16 v[56:71], v[124:127], v[16:19], 0
    v_cvt_pk_bf16_f32 v73, v42, v43
    v_exp_f32 v45, v45
    v_exp_f32 v46, v46
    v_cvt_pk_bf16_f32 v74, v44, v45
    v_exp_f32 v47, v47
    v_exp_f32 v48, v48
    v_mfma_f32_32x32x16_bf16 v[56:71], v[128:131], v[20:23], v[56:71]
    v_cvt_pk_bf16_f32 v75, v46, v47
    v_exp_f32 v49, v49
    v_exp_f32 v50, v50
    v_cvt_pk_bf16_f32 v76, v48, v49
    v_exp_f32 v51, v51
    v_exp_f32 v52, v52
    v_mfma_f32_32x32x16_bf16 v[188:203], v[96:99], v[80:83], v[188:203]
    v_cvt_pk_bf16_f32 v77, v50, v51
    v_exp_f32 v53, v53
    v_exp_f32 v54, v54
    v_cvt_pk_bf16_f32 v78, v52, v53
    v_exp_f32 v55, v55
    v_mfma_f32_32x32x16_bf16 v[188:203], v[100:103], v[84:87], v[188:203]
    v_cvt_pk_bf16_f32 v79, v54, v55
    v_exp_f32 v56, v56
    v_exp_f32 v57, v57
    v_exp_f32 v58, v58
    v_cvt_pk_bf16_f32 v80, v56, v57
    v_exp_f32 v59, v59
    v_exp_f32 v60, v60
    v_mfma_f32_32x32x16_bf16 v[40:55], v[124:127], v[24:27], 0
    v_cvt_pk_bf16_f32 v81, v58, v59
    v_exp_f32 v61, v61
    v_exp_f32 v62, v62
    v_cvt_pk_bf16_f32 v82, v60, v61
    v_exp_f32 v63, v63
    v_exp_f32 v64, v64
    v_mfma_f32_32x32x16_bf16 v[40:55], v[128:131], v[28:31], v[40:55]
    v_cvt_pk_bf16_f32 v83, v62, v63
    v_exp_f32 v65, v65
    v_exp_f32 v66, v66
    v_cvt_pk_bf16_f32 v84, v64, v65
    v_exp_f32 v67, v67
    v_exp_f32 v68, v68
    v_mfma_f32_32x32x16_bf16 v[140:155], v[132:135], v[72:75], v[140:155]
    v_cvt_pk_bf16_f32 v85, v66, v67
    v_exp_f32 v69, v69
    v_exp_f32 v70, v70
    v_cvt_pk_bf16_f32 v86, v68, v69
    v_exp_f32 v71, v71
    v_mfma_f32_32x32x16_bf16 v[140:155], v[136:139], v[76:79], v[140:155]
    s_barrier
    v_cvt_pk_bf16_f32 v87, v70, v71
    v_exp_f32 v40, v40
    v_exp_f32 v41, v41
    v_exp_f32 v42, v42
    v_cvt_pk_bf16_f32 v72, v40, v41
    v_exp_f32 v43, v43
    v_exp_f32 v44, v44
    v_mfma_f32_32x32x16_bf16 v[56:71], v[124:127], v[32:35], 0
    ds_read_b128 v[88:91], v5 offset:12288
    v_cvt_pk_bf16_f32 v73, v42, v43
    v_exp_f32 v45, v45
    v_exp_f32 v46, v46
    v_cvt_pk_bf16_f32 v74, v44, v45
    v_exp_f32 v47, v47
    v_exp_f32 v48, v48
    v_mfma_f32_32x32x16_bf16 v[56:71], v[128:131], v[36:39], v[56:71]
    ds_read_b128 v[92:95], v5 offset:13312
    v_cvt_pk_bf16_f32 v75, v46, v47
    v_exp_f32 v49, v49
    v_exp_f32 v50, v50
    v_cvt_pk_bf16_f32 v76, v48, v49
    v_exp_f32 v51, v51
    v_exp_f32 v52, v52
    v_mfma_f32_32x32x16_bf16 v[156:171], v[132:135], v[80:83], v[156:171]
    ds_read_b128 v[96:99], v5 offset:14336
    v_cvt_pk_bf16_f32 v77, v50, v51
    v_exp_f32 v53, v53
    v_exp_f32 v54, v54
    v_cvt_pk_bf16_f32 v78, v52, v53
    v_exp_f32 v55, v55
    v_mfma_f32_32x32x16_bf16 v[156:171], v[136:139], v[84:87], v[156:171]
    ds_read_b128 v[100:103], v5 offset:15360
    s_waitcnt lgkmcnt(2)
    v_cvt_pk_bf16_f32 v79, v54, v55
    v_exp_f32 v56, v56
    v_exp_f32 v57, v57
    v_exp_f32 v58, v58
    v_cvt_pk_bf16_f32 v80, v56, v57
    v_exp_f32 v59, v59
    v_exp_f32 v60, v60
    v_mfma_f32_32x32x16_bf16 v[40:55], v[88:91], v[8:11], 0
    v_cvt_pk_bf16_f32 v81, v58, v59
    v_exp_f32 v61, v61
    v_exp_f32 v62, v62
    v_cvt_pk_bf16_f32 v82, v60, v61
    v_exp_f32 v63, v63
    v_exp_f32 v64, v64
    v_mfma_f32_32x32x16_bf16 v[40:55], v[92:95], v[12:15], v[40:55]
    s_waitcnt lgkmcnt(0)
    v_cvt_pk_bf16_f32 v83, v62, v63
    v_exp_f32 v65, v65
    v_exp_f32 v66, v66
    v_cvt_pk_bf16_f32 v84, v64, v65
    v_exp_f32 v67, v67
    v_exp_f32 v68, v68
    v_mfma_f32_32x32x16_bf16 v[172:187], v[132:135], v[72:75], v[172:187]
    v_cvt_pk_bf16_f32 v85, v66, v67
    v_exp_f32 v69, v69
    v_exp_f32 v70, v70
    v_cvt_pk_bf16_f32 v86, v68, v69
    v_exp_f32 v71, v71
    v_mfma_f32_32x32x16_bf16 v[172:187], v[136:139], v[76:79], v[172:187]
    v_cvt_pk_bf16_f32 v87, v70, v71
    v_exp_f32 v40, v40
    v_exp_f32 v41, v41
    v_exp_f32 v42, v42
    v_cvt_pk_bf16_f32 v72, v40, v41
    v_exp_f32 v43, v43
    v_exp_f32 v44, v44
    v_mfma_f32_32x32x16_bf16 v[56:71], v[88:91], v[16:19], 0
    v_cvt_pk_bf16_f32 v73, v42, v43
    v_exp_f32 v45, v45
    v_exp_f32 v46, v46
    v_cvt_pk_bf16_f32 v74, v44, v45
    v_exp_f32 v47, v47
    v_exp_f32 v48, v48
    v_mfma_f32_32x32x16_bf16 v[56:71], v[92:95], v[20:23], v[56:71]
    v_cvt_pk_bf16_f32 v75, v46, v47
    v_exp_f32 v49, v49
    v_exp_f32 v50, v50
    v_cvt_pk_bf16_f32 v76, v48, v49
    v_exp_f32 v51, v51
    v_exp_f32 v52, v52
    v_mfma_f32_32x32x16_bf16 v[188:203], v[132:135], v[80:83], v[188:203]
    v_cvt_pk_bf16_f32 v77, v50, v51
    v_exp_f32 v53, v53
    v_exp_f32 v54, v54
    v_cvt_pk_bf16_f32 v78, v52, v53
    v_exp_f32 v55, v55
    v_mfma_f32_32x32x16_bf16 v[188:203], v[136:139], v[84:87], v[188:203]
    v_cvt_pk_bf16_f32 v79, v54, v55
    v_exp_f32 v56, v56
    v_exp_f32 v57, v57
    v_exp_f32 v58, v58
    v_cvt_pk_bf16_f32 v80, v56, v57
    v_exp_f32 v59, v59
    v_exp_f32 v60, v60
    v_mfma_f32_32x32x16_bf16 v[40:55], v[88:91], v[24:27], 0
    v_cvt_pk_bf16_f32 v81, v58, v59
    v_exp_f32 v61, v61
    v_exp_f32 v62, v62
    v_cvt_pk_bf16_f32 v82, v60, v61
    v_exp_f32 v63, v63
    v_exp_f32 v64, v64
    v_mfma_f32_32x32x16_bf16 v[40:55], v[92:95], v[28:31], v[40:55]
    v_cvt_pk_bf16_f32 v83, v62, v63
    v_exp_f32 v65, v65
    v_exp_f32 v66, v66
    v_cvt_pk_bf16_f32 v84, v64, v65
    v_exp_f32 v67, v67
    v_exp_f32 v68, v68
    v_mfma_f32_32x32x16_bf16 v[140:155], v[96:99], v[72:75], v[140:155]
    v_cvt_pk_bf16_f32 v85, v66, v67
    v_exp_f32 v69, v69
    v_exp_f32 v70, v70
    v_cvt_pk_bf16_f32 v86, v68, v69
    v_exp_f32 v71, v71
    v_mfma_f32_32x32x16_bf16 v[140:155], v[100:103], v[76:79], v[140:155]
    v_cvt_pk_bf16_f32 v87, v70, v71
    v_exp_f32 v40, v40
    v_exp_f32 v41, v41
    v_exp_f32 v42, v42
    v_cvt_pk_bf16_f32 v72, v40, v41
    v_exp_f32 v43, v43
    v_exp_f32 v44, v44
    v_mfma_f32_32x32x16_bf16 v[56:71], v[88:91], v[32:35], 0
    v_cvt_pk_bf16_f32 v73, v42, v43
    v_exp_f32 v45, v45
    v_exp_f32 v46, v46
    v_cvt_pk_bf16_f32 v74, v44, v45
    v_exp_f32 v47, v47
    v_exp_f32 v48, v48
    v_mfma_f32_32x32x16_bf16 v[56:71], v[92:95], v[36:39], v[56:71]
    ds_write_b128 v5, v[140:143] offset:0
    v_cvt_pk_bf16_f32 v75, v46, v47
    v_exp_f32 v49, v49
    v_exp_f32 v50, v50
    v_cvt_pk_bf16_f32 v76, v48, v49
    v_exp_f32 v51, v51
    v_exp_f32 v52, v52
    v_mfma_f32_32x32x16_bf16 v[156:171], v[96:99], v[80:83], v[156:171]
    ds_write_b128 v5, v[144:147] offset:1024
    v_cvt_pk_bf16_f32 v77, v50, v51
    v_exp_f32 v53, v53
    v_exp_f32 v54, v54
    v_cvt_pk_bf16_f32 v78, v52, v53
    v_exp_f32 v55, v55
    v_mfma_f32_32x32x16_bf16 v[156:171], v[100:103], v[84:87], v[156:171]
    ds_write_b128 v5, v[148:151] offset:2048
    ds_write_b128 v5, v[152:155] offset:3072
    v_cvt_pk_bf16_f32 v79, v54, v55
    v_exp_f32 v56, v56
    v_exp_f32 v57, v57
    v_exp_f32 v58, v58
    v_cvt_pk_bf16_f32 v80, v56, v57
    v_exp_f32 v59, v59
    v_exp_f32 v60, v60
    v_cvt_pk_bf16_f32 v81, v58, v59
    v_exp_f32 v61, v61
    v_exp_f32 v62, v62
    v_cvt_pk_bf16_f32 v82, v60, v61
    v_exp_f32 v63, v63
    v_exp_f32 v64, v64
    v_cvt_pk_bf16_f32 v83, v62, v63
    v_exp_f32 v65, v65
    v_exp_f32 v66, v66
    v_cvt_pk_bf16_f32 v84, v64, v65
    v_exp_f32 v67, v67
    v_exp_f32 v68, v68
    v_mfma_f32_32x32x16_bf16 v[172:187], v[96:99], v[72:75], v[172:187]
    ds_write_b128 v5, v[156:159] offset:4096
    ds_write_b128 v5, v[160:163] offset:5120
    v_cvt_pk_bf16_f32 v85, v66, v67
    v_exp_f32 v69, v69
    v_exp_f32 v70, v70
    v_cvt_pk_bf16_f32 v86, v68, v69
    v_exp_f32 v71, v71
    v_mfma_f32_32x32x16_bf16 v[172:187], v[100:103], v[76:79], v[172:187]
    ds_write_b128 v5, v[164:167] offset:6144
    ds_write_b128 v5, v[168:171] offset:7168
    v_cvt_pk_bf16_f32 v87, v70, v71
    s_nop 1
    v_mfma_f32_32x32x16_bf16 v[188:203], v[96:99], v[80:83], v[188:203]
    v_mfma_f32_32x32x16_bf16 v[188:203], v[100:103], v[84:87], v[188:203]
    v_xor_b32 v40, 1536, v6
    v_add_u32 v40, 152064, v40
    v_xor_b32 v41, 1024, v6
    v_add_u32 v41, 152064, v41
    v_xor_b32 v42, 512, v6
    v_add_u32 v42, 152064, v42
    v_xor_b32 v43, 0, v6
    v_add_u32 v43, 152064, v43
    ds_write_b128 v5, v[172:175] offset:8192
    ds_write_b128 v5, v[176:179] offset:9216
    ds_write_b128 v5, v[180:183] offset:10240
    ds_write_b128 v5, v[184:187] offset:11264
    s_mov_b32 exec_lo, 0
    ds_write_b32 v40, v152
    ds_write_b32 v41, v168
    ds_write_b32 v42, v184
    ds_write_b32 v43, v200
    s_mov_b64 exec, -1
    s_xor_b32 s31, s35, 3
    s_mul_i32 s31, s31, 16384
    s_add_u32 s31, s31, 86528
    v_add_u32 v44, s31, v2
    s_xor_b32 s31, s35, 2
    s_mul_i32 s31, s31, 16384
    s_add_u32 s31, s31, 90624
    v_add_u32 v45, s31, v2
    s_xor_b32 s31, s35, 1
    s_mul_i32 s31, s31, 16384
    s_add_u32 s31, s31, 94720
    v_add_u32 v46, s31, v2
    s_waitcnt lgkmcnt(0)
    s_barrier
    ds_read_b128 v[72:75], v7
    ds_read_b128 v[76:79], v7 offset:1024
    ds_read_b128 v[204:207], v44 offset:0
    ds_read_b128 v[208:211], v44 offset:1024
    ds_read_b128 v[212:215], v44 offset:2048
    ds_read_b128 v[216:219], v44 offset:3072
    ds_read_b128 v[220:223], v45 offset:0
    ds_read_b128 v[224:227], v45 offset:1024
    ds_read_b128 v[228:231], v45 offset:2048
    ds_read_b128 v[232:235], v45 offset:3072
    ds_read_b128 v[236:239], v46 offset:0
    ds_read_b128 v[240:243], v46 offset:1024
    ds_read_b128 v[244:247], v46 offset:2048
    ds_read_b128 v[248:251], v46 offset:3072
    s_waitcnt lgkmcnt(12)
    v_add_f32 v72, v72, v73
    v_add_f32 v74, v74, v75
    v_add_f32 v72, v72, v74
    v_add_f32 v76, v76, v77
    v_add_f32 v78, v78, v79
    v_add_f32 v76, v76, v78
    v_mov_b32 v73, 0x1f800000
    v_mov_b32 v74, 0x5f800000
    v_cmp_nle_f32 vcc, v73, v72
    v_cmp_nle_f32 s[62:63], v73, v76
    v_cmp_nge_f32 s[64:65], v74, v72
    v_cmp_nge_f32 s[66:67], v74, v76
    s_nop 0
    s_or_b64 vcc, vcc, s[62:63]
    s_or_b64 s[64:65], s[64:65], s[66:67]
    s_or_b64 vcc, vcc, s[64:65]
    s_cbranch_scc0 L_k_Bok_51
    s_cmp_eq_u32 s38, 0
    s_cbranch_scc1 L_k_Bfb_50
L_k_Bok_51:
    s_mul_i32 s32, s30, 131072
    s_mul_i32 s34, s35, 32768
    s_add_u32 s32, s32, s34
    s_mul_i32 s34, s29, 2048
    s_add_u32 s32, s32, s34
    s_add_u32 s32, s32, 6291456
    s_waitcnt lgkmcnt(8)
    v_add_f32 v188, v188, v204
    v_add_f32 v189, v189, v205
    v_add_f32 v190, v190, v206
    v_add_f32 v191, v191, v207
    v_add_f32 v192, v192, v208
    v_add_f32 v193, v193, v209
    v_add_f32 v194, v194, v210
    v_add_f32 v195, v195, v211
    v_add_f32 v196, v196, v212
    v_add_f32 v197, v197, v213
    v_add_f32 v198, v198, v214
    v_add_f32 v199, v199, v215
    v_add_f32 v200, v200, v216
    v_add_f32 v201, v201, v217
    v_add_f32 v202, v202, v218
    v_add_f32 v203, v203, v219
    s_waitcnt lgkmcnt(0)
    s_barrier
    v_add_f32 v232, v232, v248
    v_add_f32 v200, v200, v232
    v_mov_b32 v3, v200
    v_mov_b32 v4, v200
    v_add_f32 v220, v220, v236
    v_add_f32 v188, v188, v220
    v_add_f32 v221, v221, v237
    v_add_f32 v189, v189, v221
    v_permlane32_swap_b32 v3, v4
    v_add_f32 v222, v222, v238
    v_add_f32 v190, v190, v222
    v_add_f32 v223, v223, v239
    v_add_f32 v191, v191, v223
    v_rcp_f32 v4, v4
    v_cmp_lt_u32 vcc, 31, v1
    v_add_f32 v224, v224, v240
    v_add_f32 v192, v192, v224
    v_add_f32 v225, v225, v241
    v_add_f32 v193, v193, v225
    v_add_f32 v226, v226, v242
    v_add_f32 v194, v194, v226
    v_add_f32 v227, v227, v243
    v_add_f32 v195, v195, v227
    v_add_f32 v228, v228, v244
    v_add_f32 v196, v196, v228
    v_add_f32 v229, v229, v245
    v_add_f32 v197, v197, v229
    v_add_f32 v230, v230, v246
    v_add_f32 v198, v198, v230
    v_add_f32 v231, v231, v247
    v_add_f32 v199, v199, v231
    v_add_f32 v233, v233, v249
    v_add_f32 v201, v201, v233
    v_add_f32 v234, v234, v250
    v_add_f32 v202, v202, v234
    v_add_f32 v235, v235, v251
    v_add_f32 v203, v203, v235
    v_mul_f32 v188, v188, v4
    v_mul_f32 v189, v189, v4
    v_mul_f32 v190, v190, v4
    v_mul_f32 v191, v191, v4
    v_mul_f32 v192, v192, v4
    v_mul_f32 v193, v193, v4
    v_mul_f32 v194, v194, v4
    v_mul_f32 v195, v195, v4
    v_cvt_pk_bf16_f32 v72, v188, v189
    v_cvt_pk_bf16_f32 v73, v190, v191
    v_cvt_pk_bf16_f32 v74, v192, v193
    v_cvt_pk_bf16_f32 v75, v194, v195
    buffer_store_dwordx4 v[72:75], v2, s[20:23], s32 offen offset:0 sc1
    v_mul_f32 v196, v196, v4
    v_mul_f32 v197, v197, v4
    v_mul_f32 v198, v198, v4
    v_mul_f32 v199, v199, v4
    v_mul_f32 v200, v200, v4
    v_mul_f32 v201, v201, v4
    v_mul_f32 v202, v202, v4
    v_mul_f32 v203, v203, v4
    v_cvt_pk_bf16_f32 v76, v196, v197
    v_cvt_pk_bf16_f32 v77, v198, v199
    v_cvt_pk_bf16_f32 v78, v200, v201
    v_cvt_pk_bf16_f32 v79, v202, v203
    v_cndmask_b32 v78, v78, 0, vcc
    v_cndmask_b32 v79, v79, 0, vcc
    buffer_store_dwordx4 v[76:79], v2, s[20:23], s32 offen offset:1024 sc1
    s_mul_i32 s32, s30, 512
    s_mul_i32 s34, s35, 128
    s_add_u32 s32, s32, s34
    s_mul_i32 s34, s29, 4
    s_add_u32 s32, s32, s34
    s_add_u32 s32, s32, 18894848
    v_mov_b32 v3, s24
    s_waitcnt vmcnt(0)
    s_mov_b64 exec, 1
    buffer_store_dword v3, off, s[20:23], s32 sc1
    s_mov_b64 exec, -1
    s_bitcmp1_b32 s35, 0
    s_cselect_b32 s16, s50, s48
    s_cselect_b32 s17, s51, s49
    s_cselect_b32 s37, 14496, 0
    s_mov_b32 s18, 1605632
    s_mov_b32 s19, 0x20000
    s_lshr_b32 s31, s35, 1
    s_mul_i32 s32, s31, 7168
    s_add_u32 s37, s37, s32
    s_mul_i32 s36, s31, 114688
    s_mul_i32 s34, s30, 224
    s_add_u32 s36, s36, s34
    s_and_b32 s31, s30, 1
    s_lshl_b32 s32, s31, 5
    s_mul_i32 s31, s31, 192
    s_sub_u32 s31, 192, s31
    v_add_u32 v3, 0, v1
    v_mul_u32_u24 v240, 1171, v3
    v_lshrrev_b32 v240, 16, v240
    v_mul_u32_u24 v4, 56, v240
    v_sub_u32 v3, v3, v4
    v_mul_u32_u24 v240, 14336, v240
    v_cmp_gt_u32 vcc, 48, v3
    v_mul_u32_u24 v4, 5462, v3
    v_lshrrev_b32 v4, 16, v4
    v_mul_u32_u24 v4, 3392, v4
    v_lshl_add_u32 v4, v3, 4, v4
    v_add_u32 v4, s32, v4
    v_bfe_u32 v5, v3, 1, 2
    v_mul_u32_u24 v5, 3584, v5
    v_and_b32 v3, 1, v3
    v_lshl_add_u32 v5, v3, 4, v5
    v_add_u32 v5, s31, v5
    v_cndmask_b32 v3, v5, v4, vcc
    v_add_u32 v240, v240, v3
    v_add_u32 v3, 64, v1
    v_mul_u32_u24 v241, 1171, v3
    v_lshrrev_b32 v241, 16, v241
    v_mul_u32_u24 v4, 56, v241
    v_sub_u32 v3, v3, v4
    v_mul_u32_u24 v241, 14336, v241
    v_cmp_gt_u32 vcc, 48, v3
    v_mul_u32_u24 v4, 5462, v3
    v_lshrrev_b32 v4, 16, v4
    v_mul_u32_u24 v4, 3392, v4
    v_lshl_add_u32 v4, v3, 4, v4
    v_add_u32 v4, s32, v4
    v_bfe_u32 v5, v3, 1, 2
    v_mul_u32_u24 v5, 3584, v5
    v_and_b32 v3, 1, v3
    v_lshl_add_u32 v5, v3, 4, v5
    v_add_u32 v5, s31, v5
    v_cndmask_b32 v3, v5, v4, vcc
    v_add_u32 v241, v241, v3
    v_add_u32 v3, 128, v1
    v_mul_u32_u24 v242, 1171, v3
    v_lshrrev_b32 v242, 16, v242
    v_mul_u32_u24 v4, 56, v242
    v_sub_u32 v3, v3, v4
    v_mul_u32_u24 v242, 14336, v242
    v_cmp_gt_u32 vcc, 48, v3
    v_mul_u32_u24 v4, 5462, v3
    v_lshrrev_b32 v4, 16, v4
    v_mul_u32_u24 v4, 3392, v4
    v_lshl_add_u32 v4, v3, 4, v4
    v_add_u32 v4, s32, v4
    v_bfe_u32 v5, v3, 1, 2
    v_mul_u32_u24 v5, 3584, v5
    v_and_b32 v3, 1, v3
    v_lshl_add_u32 v5, v3, 4, v5
    v_add_u32 v5, s31, v5
    v_cndmask_b32 v3, v5, v4, vcc
    v_add_u32 v242, v242, v3
    v_add_u32 v3, 192, v1
    v_mul_u32_u24 v243, 1171, v3
    v_lshrrev_b32 v243, 16, v243
    v_mul_u32_u24 v4, 56, v243
    v_sub_u32 v3, v3, v4
    v_mul_u32_u24 v243, 14336, v243
    v_cmp_gt_u32 vcc, 48, v3
    v_mul_u32_u24 v4, 5462, v3
    v_lshrrev_b32 v4, 16, v4
    v_mul_u32_u24 v4, 3392, v4
    v_lshl_add_u32 v4, v3, 4, v4
    v_add_u32 v4, s32, v4
    v_bfe_u32 v5, v3, 1, 2
    v_mul_u32_u24 v5, 3584, v5
    v_and_b32 v3, 1, v3
    v_lshl_add_u32 v5, v3, 4, v5
    v_add_u32 v5, s31, v5
    v_cndmask_b32 v3, v5, v4, vcc
    v_add_u32 v243, v243, v3
    v_add_u32 v3, 256, v1
    v_mul_u32_u24 v244, 1171, v3
    v_lshrrev_b32 v244, 16, v244
    v_mul_u32_u24 v4, 56, v244
    v_sub_u32 v3, v3, v4
    v_mul_u32_u24 v244, 14336, v244
    v_cmp_gt_u32 vcc, 48, v3
    v_mul_u32_u24 v4, 5462, v3
    v_lshrrev_b32 v4, 16, v4
    v_mul_u32_u24 v4, 3392, v4
    v_lshl_add_u32 v4, v3, 4, v4
    v_add_u32 v4, s32, v4
    v_bfe_u32 v5, v3, 1, 2
    v_mul_u32_u24 v5, 3584, v5
    v_and_b32 v3, 1, v3
    v_lshl_add_u32 v5, v3, 4, v5
    v_add_u32 v5, s31, v5
    v_cndmask_b32 v3, v5, v4, vcc
    v_add_u32 v244, v244, v3
    v_add_u32 v3, 320, v1
    v_mul_u32_u24 v245, 1171, v3
    v_lshrrev_b32 v245, 16, v245
    v_mul_u32_u24 v4, 56, v245
    v_sub_u32 v3, v3, v4
    v_mul_u32_u24 v245, 14336, v245
    v_cmp_gt_u32 vcc, 48, v3
    v_mul_u32_u24 v4, 5462, v3
    v_lshrrev_b32 v4, 16, v4
    v_mul_u32_u24 v4, 3392, v4
    v_lshl_add_u32 v4, v3, 4, v4
    v_add_u32 v4, s32, v4
    v_bfe_u32 v5, v3, 1, 2
    v_mul_u32_u24 v5, 3584, v5
    v_and_b32 v3, 1, v3
    v_lshl_add_u32 v5, v3, 4, v5
    v_add_u32 v5, s31, v5
    v_cndmask_b32 v3, v5, v4, vcc
    v_add_u32 v245, v245, v3
    v_add_u32 v3, 384, v1
    v_mul_u32_u24 v246, 1171, v3
    v_lshrrev_b32 v246, 16, v246
    v_mul_u32_u24 v4, 56, v246
    v_sub_u32 v3, v3, v4
    v_mul_u32_u24 v246, 14336, v246
    v_cmp_gt_u32 vcc, 48, v3
    v_mul_u32_u24 v4, 5462, v3
    v_lshrrev_b32 v4, 16, v4
    v_mul_u32_u24 v4, 3392, v4
    v_lshl_add_u32 v4, v3, 4, v4
    v_add_u32 v4, s32, v4
    v_bfe_u32 v5, v3, 1, 2
    v_mul_u32_u24 v5, 3584, v5
    v_and_b32 v3, 1, v3
    v_lshl_add_u32 v5, v3, 4, v5
    v_add_u32 v5, s31, v5
    v_cndmask_b32 v3, v5, v4, vcc
    v_add_u32 v246, v246, v3
    s_add_u32 m0, s37, 57664
    s_add_u32 s31, s36, 458752
    buffer_load_dwordx4 v240, s[16:19], s31 offen  lds
    s_add_u32 m0, s37, 58688
    s_add_u32 s31, s36, 458752
    buffer_load_dwordx4 v241, s[16:19], s31 offen  lds
    s_add_u32 m0, s37, 59712
    s_add_u32 s31, s36, 458752
    buffer_load_dwordx4 v242, s[16:19], s31 offen  lds
    s_add_u32 m0, s37, 60736
    s_add_u32 s31, s36, 458752
    buffer_load_dwordx4 v243, s[16:19], s31 offen  lds
    s_add_u32 m0, s37, 61760
    s_add_u32 s31, s36, 458752
    buffer_load_dwordx4 v244, s[16:19], s31 offen  lds
    s_add_u32 m0, s37, 62784
    s_add_u32 s31, s36, 458752
    buffer_load_dwordx4 v245, s[16:19], s31 offen  lds
    s_add_u32 m0, s37, 63808
    s_add_u32 s31, s36, 458752
    buffer_load_dwordx4 v246, s[16:19], s31 offen  lds
    s_add_u32 m0, s37, 86496
    s_add_u32 s31, s36, 688128
    buffer_load_dwordx4 v240, s[16:19], s31 offen  lds
    s_add_u32 m0, s37, 87520
    s_add_u32 s31, s36, 688128
    buffer_load_dwordx4 v241, s[16:19], s31 offen  lds
    s_add_u32 m0, s37, 88544
    s_add_u32 s31, s36, 688128
    buffer_load_dwordx4 v242, s[16:19], s31 offen  lds
    s_add_u32 m0, s37, 89568
    s_add_u32 s31, s36, 688128
    buffer_load_dwordx4 v243, s[16:19], s31 offen  lds
    s_add_u32 m0, s37, 90592
    s_add_u32 s31, s36, 688128
    buffer_load_dwordx4 v244, s[16:19], s31 offen  lds
    s_add_u32 m0, s37, 91616
    s_add_u32 s31, s36, 688128
    buffer_load_dwordx4 v245, s[16:19], s31 offen  lds
    s_add_u32 m0, s37, 92640
    s_add_u32 s31, s36, 688128
    buffer_load_dwordx4 v246, s[16:19], s31 offen  lds
    v_lshrrev_b32 v3, 5, v1
    v_mul_u32_u24 v52, 896, v3
    v_bfe_u32 v3, v1, 4, 1
    v_mul_u32_u24 v3, 14496, v3
    v_add_u32 v52, v52, v3
    v_and_b32 v3, 3, v1
    v_lshl_add_u32 v52, v3, 3, v52
    v_bfe_u32 v3, v1, 2, 2
    v_lshl_add_u32 v53, v3, 5, v52
    v_mul_u32_u24 v3, 192, v3
    v_add_u32 v52, v52, v3
    s_mul_i32 s31, s35, 3584
    s_mul_i32 s32, s35, 4096
    s_add_u32 s32, s32, 149504
    v_add_u32 v52, s31, v52
    v_add_u32 v53, s31, v53
    v_lshl_add_u32 v54, v1, 2, s32
    v_mov_b32 v4, 0x3f803f80
    v_lshrrev_b32 v3, 2, v1
    v_xor_b32 v3, v3, v1
    v_and_b32 v3, 4, v3
    v_cmp_eq_u32 vcc, 0, v3
    s_nop 1
    v_cndmask_b32 v48, 0, v4, vcc
    v_cndmask_b32 v49, 0, v4, vcc
    v_cndmask_b32 v50, 0, v4, vcc
    v_cndmask_b32 v51, 0, v4, vcc
    s_setprio 2
    ds_read_b64_tr_b16 v[128:129], v52 offset:0
    ds_read_b64_tr_b16 v[130:131], v52 offset:1792
    ds_read_b64_tr_b16 v[132:133], v52 offset:32
    ds_read_b64_tr_b16 v[134:135], v52 offset:1824
    ds_read_b64_tr_b16 v[136:137], v52 offset:64
    ds_read_b64_tr_b16 v[138:139], v52 offset:1856
    ds_read_b64_tr_b16 v[140:141], v52 offset:96
    ds_read_b64_tr_b16 v[142:143], v52 offset:1888
    ds_read_b64_tr_b16 v[144:145], v52 offset:128
    ds_read_b64_tr_b16 v[146:147], v52 offset:1920
    ds_read_b64_tr_b16 v[148:149], v52 offset:160
    ds_read_b64_tr_b16 v[150:151], v52 offset:1952
    ds_read_b64_tr_b16 v[152:153], v53 offset:768
    ds_read_b64_tr_b16 v[154:155], v53 offset:2560
    s_waitcnt lgkmcnt(0)
    v_mfma_f32_16x16x32_bf16 v[20:23], v[48:51], v[128:131], 0
    v_mfma_f32_16x16x32_bf16 v[24:27], v[48:51], v[132:135], 0
    v_mfma_f32_16x16x32_bf16 v[28:31], v[48:51], v[136:139], 0
    v_mfma_f32_16x16x32_bf16 v[32:35], v[48:51], v[140:143], 0
    v_mfma_f32_16x16x32_bf16 v[36:39], v[48:51], v[144:147], 0
    v_mfma_f32_16x16x32_bf16 v[40:43], v[48:51], v[148:151], 0
    v_mfma_f32_16x16x32_bf16 v[44:47], v[48:51], v[152:155], 0
    s_setprio 1
    s_setprio 2
    ds_read_b64_tr_b16 v[128:129], v52 offset:28832
    ds_read_b64_tr_b16 v[130:131], v52 offset:30624
    ds_read_b64_tr_b16 v[132:133], v52 offset:28864
    ds_read_b64_tr_b16 v[134:135], v52 offset:30656
    ds_read_b64_tr_b16 v[136:137], v52 offset:28896
    ds_read_b64_tr_b16 v[138:139], v52 offset:30688
    ds_read_b64_tr_b16 v[140:141], v52 offset:28928
    ds_read_b64_tr_b16 v[142:143], v52 offset:30720
    ds_read_b64_tr_b16 v[144:145], v52 offset:28960
    ds_read_b64_tr_b16 v[146:147], v52 offset:30752
    ds_read_b64_tr_b16 v[148:149], v52 offset:28992
    ds_read_b64_tr_b16 v[150:151], v52 offset:30784
    ds_read_b64_tr_b16 v[152:153], v53 offset:29600
    ds_read_b64_tr_b16 v[154:155], v53 offset:31392
    s_waitcnt lgkmcnt(0)
    v_mfma_f32_16x16x32_bf16 v[20:23], v[48:51], v[128:131], v[20:23]
    v_mfma_f32_16x16x32_bf16 v[24:27], v[48:51], v[132:135], v[24:27]
    v_mfma_f32_16x16x32_bf16 v[28:31], v[48:51], v[136:139], v[28:31]
    v_mfma_f32_16x16x32_bf16 v[32:35], v[48:51], v[140:143], v[32:35]
    v_mfma_f32_16x16x32_bf16 v[36:39], v[48:51], v[144:147], v[36:39]
    v_mfma_f32_16x16x32_bf16 v[40:43], v[48:51], v[148:151], v[40:43]
    v_mfma_f32_16x16x32_bf16 v[44:47], v[48:51], v[152:155], v[44:47]
    s_setprio 1
    s_waitcnt vmcnt(0)
    s_barrier
    s_setprio 0
    ds_read_b64_tr_b16 v[128:129], v52 offset:57664
    ds_read_b64_tr_b16 v[130:131], v52 offset:59456
    ds_read_b64_tr_b16 v[132:133], v52 offset:57696
    ds_read_b64_tr_b16 v[134:135], v52 offset:59488
    ds_read_b64_tr_b16 v[136:137], v52 offset:57728
    ds_read_b64_tr_b16 v[138:139], v52 offset:59520
    ds_read_b64_tr_b16 v[140:141], v52 offset:57760
    ds_read_b64_tr_b16 v[142:143], v52 offset:59552
    ds_read_b64_tr_b16 v[144:145], v52 offset:57792
    ds_read_b64_tr_b16 v[146:147], v52 offset:59584
    ds_read_b64_tr_b16 v[148:149], v52 offset:57824
    ds_read_b64_tr_b16 v[150:151], v52 offset:59616
    ds_read_b64_tr_b16 v[152:153], v53 offset:58432
    ds_read_b64_tr_b16 v[154:155], v53 offset:60224
    s_waitcnt lgkmcnt(0)
    v_mfma_f32_16x16x32_bf16 v[20:23], v[48:51], v[128:131], v[20:23]
    v_mfma_f32_16x16x32_bf16 v[24:27], v[48:51], v[132:135], v[24:27]
    v_mfma_f32_16x16x32_bf16 v[28:31], v[48:51], v[136:139], v[28:31]
    v_mfma_f32_16x16x32_bf16 v[32:35], v[48:51], v[140:143], v[32:35]
    v_mfma_f32_16x16x32_bf16 v[36:39], v[48:51], v[144:147], v[36:39]
    v_mfma_f32_16x16x32_bf16 v[40:43], v[48:51], v[148:151], v[40:43]
    v_mfma_f32_16x16x32_bf16 v[44:47], v[48:51], v[152:155], v[44:47]
    s_setprio 1
    s_setprio 0
    v_add_u32 v52, 86496, v52
    v_add_u32 v53, 86496, v53
    ds_read_b64_tr_b16 v[128:129], v52 offset:0
    ds_read_b64_tr_b16 v[130:131], v52 offset:1792
    ds_read_b64_tr_b16 v[132:133], v52 offset:32
    ds_read_b64_tr_b16 v[134:135], v52 offset:1824
    ds_read_b64_tr_b16 v[136:137], v52 offset:64
    ds_read_b64_tr_b16 v[138:139], v52 offset:1856
    ds_read_b64_tr_b16 v[140:141], v52 offset:96
    ds_read_b64_tr_b16 v[142:143], v52 offset:1888
    ds_read_b64_tr_b16 v[144:145], v52 offset:128
    ds_read_b64_tr_b16 v[146:147], v52 offset:1920
    ds_read_b64_tr_b16 v[148:149], v52 offset:160
    ds_read_b64_tr_b16 v[150:151], v52 offset:1952
    ds_read_b64_tr_b16 v[152:153], v53 offset:768
    ds_read_b64_tr_b16 v[154:155], v53 offset:2560
    s_waitcnt lgkmcnt(0)
    v_mfma_f32_16x16x32_bf16 v[20:23], v[48:51], v[128:131], v[20:23]
    v_mfma_f32_16x16x32_bf16 v[24:27], v[48:51], v[132:135], v[24:27]
    v_mfma_f32_16x16x32_bf16 v[28:31], v[48:51], v[136:139], v[28:31]
    v_mfma_f32_16x16x32_bf16 v[32:35], v[48:51], v[140:143], v[32:35]
    v_mfma_f32_16x16x32_bf16 v[36:39], v[48:51], v[144:147], v[36:39]
    v_mfma_f32_16x16x32_bf16 v[40:43], v[48:51], v[148:151], v[40:43]
    v_mfma_f32_16x16x32_bf16 v[44:47], v[48:51], v[152:155], v[44:47]
    s_setprio 1
    v_lshrrev_b32 v3, 5, v1
    v_mul_u32_u24 v5, 896, v3
    v_bfe_u32 v3, v1, 4, 1
    v_mul_u32_u24 v3, 14496, v3
    v_add_u32 v5, v5, v3
    v_and_b32 v3, 3, v1
    v_lshl_add_u32 v5, v3, 3, v5
    v_bfe_u32 v3, v1, 2, 2
    v_lshl_add_u32 v0, v3, 5, v5
    v_mul_u32_u24 v3, 192, v3
    v_add_u32 v5, v5, v3
    ds_write_b32 v54, v20 offset:0
    ds_write_b32 v54, v24 offset:256
    ds_write_b32 v54, v28 offset:512
    ds_write_b32 v54, v32 offset:768
    ds_write_b32 v54, v36 offset:1024
    ds_write_b32 v54, v40 offset:1280
    ds_write_b32 v54, v44 offset:1536
    s_waitcnt lgkmcnt(0)
    s_barrier
    s_add_u32 m0, s37, 115328
    s_add_u32 s31, s36, 917504
    buffer_load_dwordx4 v240, s[16:19], s31 offen  lds
    s_add_u32 m0, s37, 116352
    s_add_u32 s31, s36, 917504
    buffer_load_dwordx4 v241, s[16:19], s31 offen  lds
    s_add_u32 m0, s37, 117376
    s_add_u32 s31, s36, 917504
    buffer_load_dwordx4 v242, s[16:19], s31 offen  lds
    s_add_u32 m0, s37, 118400
    s_add_u32 s31, s36, 917504
    buffer_load_dwordx4 v243, s[16:19], s31 offen  lds
    s_add_u32 m0, s37, 119424
    s_add_u32 s31, s36, 917504
    buffer_load_dwordx4 v244, s[16:19], s31 offen  lds
    s_add_u32 m0, s37, 120448
    s_add_u32 s31, s36, 917504
    buffer_load_dwordx4 v245, s[16:19], s31 offen  lds
    s_add_u32 m0, s37, 121472
    s_add_u32 s31, s36, 917504
    buffer_load_dwordx4 v246, s[16:19], s31 offen  lds
    v_lshlrev_b32 v4, 2, v1
    s_mul_i32 s32, s29, 512
    s_mul_i32 s34, s35, 128
    s_add_u32 s32, s32, s34
    s_add_u32 s32, s32, 18907136
    s_mul_i32 s38, s29, 114688
    s_mul_i32 s34, s35, 28672
    s_add_u32 s38, s38, s34
    s_add_u32 s38, s38, 8388608
    s_mul_i32 s33, s29, 16384
    s_mul_i32 s34, s35, 4096
    s_add_u32 s33, s33, s34
    s_add_u32 s33, s33, 19660800
    ds_read_b64_tr_b16 v[120:121], v5 offset:0
    ds_read_b64_tr_b16 v[122:123], v5 offset:1792
    ds_read_b64_tr_b16 v[124:125], v5 offset:32
    ds_read_b64_tr_b16 v[126:127], v5 offset:1824
    ds_read_b64_tr_b16 v[128:129], v5 offset:64
    ds_read_b64_tr_b16 v[130:131], v5 offset:1856
    ds_read_b64_tr_b16 v[132:133], v5 offset:96
    ds_read_b64_tr_b16 v[134:135], v5 offset:1888
    ds_read_b64_tr_b16 v[136:137], v5 offset:128
    ds_read_b64_tr_b16 v[138:139], v5 offset:1920
    ds_read_b64_tr_b16 v[140:141], v5 offset:160
    ds_read_b64_tr_b16 v[142:143], v5 offset:1952
    ds_read_b64_tr_b16 v[144:145], v0 offset:768
    ds_read_b64_tr_b16 v[146:147], v0 offset:2560
    s_mov_b32 exec_lo, 0xffff
    s_mov_b32 exec_hi, 0
    s_mov_b32 s26, 0
L_k_poll_52:
    buffer_load_dword v3, v4, s[20:23], s32 offen sc1
    s_add_u32 s26, s26, 1
    s_cmp_gt_u32 s26, 0x40000
    s_waitcnt vmcnt(0)
    s_cbranch_scc1 L_k_pd_53
    v_cmp_ne_u32 vcc, s24, v3
    s_cbranch_vccnz L_k_poll_52
L_k_pd_53:
    s_cmp_eq_u32 s25, 0
    s_cbranch_scc1 L_k_pf_54
    buffer_inv sc1
    s_waitcnt vmcnt(0)
L_k_pf_54:
    s_mov_b64 exec, -1
    buffer_load_dwordx4 v[148:151], v2, s[20:23], s38 offen offset:0 sc1
    buffer_load_dwordx4 v[152:155], v2, s[20:23], s38 offen offset:1024 sc1
    buffer_load_dwordx4 v[156:159], v2, s[20:23], s38 offen offset:2048 sc1
    buffer_load_dwordx4 v[160:163], v2, s[20:23], s38 offen offset:3072 sc1
    s_add_u32 s38, s38, 4096
    v_add_u32 v4, 147456, v2
    s_waitcnt vmcnt(3) lgkmcnt(12)
    v_mfma_f32_32x32x16_bf16 v[8:23], v[120:123], v[148:151], 0
    ds_read_b64_tr_b16 v[120:121], v5 offset:3584
    ds_read_b64_tr_b16 v[122:123], v5 offset:5376
    s_waitcnt lgkmcnt(10)
    v_mfma_f32_32x32x16_bf16 v[24:39], v[124:127], v[148:151], 0
    ds_read_b64_tr_b16 v[124:125], v5 offset:3616
    ds_read_b64_tr_b16 v[126:127], v5 offset:5408
    buffer_load_dwordx4 v[164:167], v2, s[20:23], s38 offen offset:0 sc1
    v_mfma_f32_32x32x16_bf16 v[40:55], v[128:131], v[148:151], 0
    ds_read_b64_tr_b16 v[128:129], v5 offset:3648
    ds_read_b64_tr_b16 v[130:131], v5 offset:5440
    buffer_load_dwordx4 v[236:239], v2, s[20:23], s33 offen offset:0 sc1
    s_waitcnt lgkmcnt(10)
    v_mfma_f32_32x32x16_bf16 v[56:71], v[132:135], v[148:151], 0
    ds_read_b64_tr_b16 v[132:133], v5 offset:3680
    ds_read_b64_tr_b16 v[134:135], v5 offset:5472
    buffer_load_dwordx4 v[168:171], v2, s[20:23], s38 offen offset:1024 sc1
    v_mfma_f32_32x32x16_bf16 v[72:87], v[136:139], v[148:151], 0
    ds_read_b64_tr_b16 v[136:137], v5 offset:3712
    ds_read_b64_tr_b16 v[138:139], v5 offset:5504
    buffer_load_dwordx4 v[240:243], v2, s[20:23], s33 offen offset:1024 sc1
    s_waitcnt lgkmcnt(10)
    v_mfma_f32_32x32x16_bf16 v[88:103], v[140:143], v[148:151], 0
    ds_read_b64_tr_b16 v[140:141], v5 offset:3744
    ds_read_b64_tr_b16 v[142:143], v5 offset:5536
    buffer_load_dwordx4 v[172:175], v2, s[20:23], s38 offen offset:2048 sc1
    v_mfma_f32_32x32x16_bf16 v[104:119], v[144:147], v[148:151], 0
    ds_read_b64_tr_b16 v[144:145], v0 offset:4352
    ds_read_b64_tr_b16 v[146:147], v0 offset:6144
    s_waitcnt vmcnt(7) lgkmcnt(12)
    v_mfma_f32_32x32x16_bf16 v[8:23], v[120:123], v[152:155], v[8:23]
    ds_read_b64_tr_b16 v[120:121], v5 offset:7168
    ds_read_b64_tr_b16 v[122:123], v5 offset:8960
    s_waitcnt lgkmcnt(10)
    v_mfma_f32_32x32x16_bf16 v[24:39], v[124:127], v[152:155], v[24:39]
    ds_read_b64_tr_b16 v[124:125], v5 offset:7200
    ds_read_b64_tr_b16 v[126:127], v5 offset:8992
    buffer_load_dwordx4 v[176:179], v2, s[20:23], s38 offen offset:3072 sc1
    s_add_u32 s38, s38, 4096
    v_mfma_f32_32x32x16_bf16 v[40:55], v[128:131], v[152:155], v[40:55]
    ds_read_b64_tr_b16 v[128:129], v5 offset:7232
    ds_read_b64_tr_b16 v[130:131], v5 offset:9024
    buffer_load_dwordx4 v[244:247], v2, s[20:23], s33 offen offset:2048 sc1
    s_waitcnt lgkmcnt(10)
    v_mfma_f32_32x32x16_bf16 v[56:71], v[132:135], v[152:155], v[56:71]
    ds_read_b64_tr_b16 v[132:133], v5 offset:7264
    ds_read_b64_tr_b16 v[134:135], v5 offset:9056
    buffer_load_dwordx4 v[180:183], v2, s[20:23], s38 offen offset:0 sc1
    v_mfma_f32_32x32x16_bf16 v[72:87], v[136:139], v[152:155], v[72:87]
    ds_read_b64_tr_b16 v[136:137], v5 offset:7296
    ds_read_b64_tr_b16 v[138:139], v5 offset:9088
    buffer_load_dwordx4 v[248:251], v2, s[20:23], s33 offen offset:3072 sc1
    s_waitcnt lgkmcnt(10)
    v_mfma_f32_32x32x16_bf16 v[88:103], v[140:143], v[152:155], v[88:103]
    ds_read_b64_tr_b16 v[140:141], v5 offset:7328
    ds_read_b64_tr_b16 v[142:143], v5 offset:9120
    buffer_load_dwordx4 v[184:187], v2, s[20:23], s38 offen offset:1024 sc1
    v_mfma_f32_32x32x16_bf16 v[104:119], v[144:147], v[152:155], v[104:119]
    ds_read_b64_tr_b16 v[144:145], v0 offset:7936
    ds_read_b64_tr_b16 v[146:147], v0 offset:9728
    s_waitcnt vmcnt(11) lgkmcnt(12)
    v_mfma_f32_32x32x16_bf16 v[8:23], v[120:123], v[156:159], v[8:23]
    ds_read_b64_tr_b16 v[120:121], v5 offset:10752
    ds_read_b64_tr_b16 v[122:123], v5 offset:12544
    s_waitcnt lgkmcnt(10)
    v_mfma_f32_32x32x16_bf16 v[24:39], v[124:127], v[156:159], v[24:39]
    ds_read_b64_tr_b16 v[124:125], v5 offset:10784
    ds_read_b64_tr_b16 v[126:127], v5 offset:12576
    buffer_load_dwordx4 v[188:191], v2, s[20:23], s38 offen offset:2048 sc1
    v_mfma_f32_32x32x16_bf16 v[40:55], v[128:131], v[156:159], v[40:55]
    ds_read_b64_tr_b16 v[128:129], v5 offset:10816
    ds_read_b64_tr_b16 v[130:131], v5 offset:12608
    s_waitcnt lgkmcnt(10)
    v_mfma_f32_32x32x16_bf16 v[56:71], v[132:135], v[156:159], v[56:71]
    ds_read_b64_tr_b16 v[132:133], v5 offset:10848
    ds_read_b64_tr_b16 v[134:135], v5 offset:12640
    buffer_load_dwordx4 v[192:195], v2, s[20:23], s38 offen offset:3072 sc1
    s_add_u32 s38, s38, 4096
    v_mfma_f32_32x32x16_bf16 v[72:87], v[136:139], v[156:159], v[72:87]
    ds_read_b64_tr_b16 v[136:137], v5 offset:10880
    ds_read_b64_tr_b16 v[138:139], v5 offset:12672
    s_waitcnt lgkmcnt(10)
    v_mfma_f32_32x32x16_bf16 v[88:103], v[140:143], v[156:159], v[88:103]
    ds_read_b64_tr_b16 v[140:141], v5 offset:10912
    ds_read_b64_tr_b16 v[142:143], v5 offset:12704
    buffer_load_dwordx4 v[196:199], v2, s[20:23], s38 offen offset:0 sc1
    v_mfma_f32_32x32x16_bf16 v[104:119], v[144:147], v[156:159], v[104:119]
    ds_read_b64_tr_b16 v[144:145], v0 offset:11520
    ds_read_b64_tr_b16 v[146:147], v0 offset:13312
    s_waitcnt vmcnt(13) lgkmcnt(12)
    v_mfma_f32_32x32x16_bf16 v[8:23], v[120:123], v[160:163], v[8:23]
    v_add_u32 v5, 28832, v5
    v_add_u32 v0, 28832, v0
    s_waitcnt lgkmcnt(8)
    v_mfma_f32_32x32x16_bf16 v[24:39], v[124:127], v[160:163], v[24:39]
    buffer_load_dwordx4 v[200:203], v2, s[20:23], s38 offen offset:1024 sc1
    v_mfma_f32_32x32x16_bf16 v[40:55], v[128:131], v[160:163], v[40:55]
    s_waitcnt lgkmcnt(0)
    s_barrier
    ds_read_b64_tr_b16 v[120:121], v5 offset:0
    ds_read_b64_tr_b16 v[122:123], v5 offset:1792
    ds_read_b64_tr_b16 v[124:125], v5 offset:32
    ds_read_b64_tr_b16 v[126:127], v5 offset:1824
    v_mfma_f32_32x32x16_bf16 v[56:71], v[132:135], v[160:163], v[56:71]
    ds_read_b64_tr_b16 v[128:129], v5 offset:64
    ds_read_b64_tr_b16 v[130:131], v5 offset:1856
    ds_read_b64_tr_b16 v[132:133], v5 offset:96
    ds_read_b64_tr_b16 v[134:135], v5 offset:1888
    buffer_load_dwordx4 v[204:207], v2, s[20:23], s38 offen offset:2048 sc1
    v_mfma_f32_32x32x16_bf16 v[72:87], v[136:139], v[160:163], v[72:87]
    ds_read_b64_tr_b16 v[136:137], v5 offset:128
    ds_read_b64_tr_b16 v[138:139], v5 offset:1920
    v_mfma_f32_32x32x16_bf16 v[88:103], v[140:143], v[160:163], v[88:103]
    ds_read_b64_tr_b16 v[140:141], v5 offset:160
    ds_read_b64_tr_b16 v[142:143], v5 offset:1952
    buffer_load_dwordx4 v[208:211], v2, s[20:23], s38 offen offset:3072 sc1
    s_add_u32 s38, s38, 4096
    v_mfma_f32_32x32x16_bf16 v[104:119], v[144:147], v[160:163], v[104:119]
    ds_read_b64_tr_b16 v[144:145], v0 offset:768
    ds_read_b64_tr_b16 v[146:147], v0 offset:2560
    s_waitcnt vmcnt(15) lgkmcnt(12)
    v_mfma_f32_32x32x16_bf16 v[8:23], v[120:123], v[164:167], v[8:23]
    ds_read_b64_tr_b16 v[120:121], v5 offset:3584
    ds_read_b64_tr_b16 v[122:123], v5 offset:5376
    s_waitcnt lgkmcnt(10)
    v_mfma_f32_32x32x16_bf16 v[24:39], v[124:127], v[164:167], v[24:39]
    ds_read_b64_tr_b16 v[124:125], v5 offset:3616
    ds_read_b64_tr_b16 v[126:127], v5 offset:5408
    buffer_load_dwordx4 v[212:215], v2, s[20:23], s38 offen offset:0 sc1
    v_mfma_f32_32x32x16_bf16 v[40:55], v[128:131], v[164:167], v[40:55]
    ds_read_b64_tr_b16 v[128:129], v5 offset:3648
    ds_read_b64_tr_b16 v[130:131], v5 offset:5440
    s_waitcnt lgkmcnt(10)
    v_mfma_f32_32x32x16_bf16 v[56:71], v[132:135], v[164:167], v[56:71]
    ds_read_b64_tr_b16 v[132:133], v5 offset:3680
    ds_read_b64_tr_b16 v[134:135], v5 offset:5472
    buffer_load_dwordx4 v[216:219], v2, s[20:23], s38 offen offset:1024 sc1
    v_mfma_f32_32x32x16_bf16 v[72:87], v[136:139], v[164:167], v[72:87]
    ds_read_b64_tr_b16 v[136:137], v5 offset:3712
    ds_read_b64_tr_b16 v[138:139], v5 offset:5504
    s_waitcnt lgkmcnt(10)
    v_mfma_f32_32x32x16_bf16 v[88:103], v[140:143], v[164:167], v[88:103]
    ds_read_b64_tr_b16 v[140:141], v5 offset:3744
    ds_read_b64_tr_b16 v[142:143], v5 offset:5536
    buffer_load_dwordx4 v[220:223], v2, s[20:23], s38 offen offset:2048 sc1
    v_mfma_f32_32x32x16_bf16 v[104:119], v[144:147], v[164:167], v[104:119]
    ds_read_b64_tr_b16 v[144:145], v0 offset:4352
    ds_read_b64_tr_b16 v[146:147], v0 offset:6144
    s_waitcnt vmcnt(10) lgkmcnt(12)
    v_mfma_f32_32x32x16_bf16 v[8:23], v[120:123], v[168:171], v[8:23]
    ds_read_b64_tr_b16 v[120:121], v5 offset:7168
    ds_read_b64_tr_b16 v[122:123], v5 offset:8960
    v_add_f32 v236, v236, v244
    v_add_f32 v238, v238, v246
    v_add_f32 v240, v240, v248
    v_add_f32 v242, v242, v250
    s_waitcnt lgkmcnt(10)
    v_mfma_f32_32x32x16_bf16 v[24:39], v[124:127], v[168:171], v[24:39]
    ds_read_b64_tr_b16 v[124:125], v5 offset:7200
    ds_read_b64_tr_b16 v[126:127], v5 offset:8992
    buffer_load_dwordx4 v[224:227], v2, s[20:23], s38 offen offset:3072 sc1
    s_add_u32 s38, s38, 4096
    v_add_f32 v236, v236, v240
    v_add_f32 v238, v238, v242
    v_add_f32 v236, v236, v238
    v_mov_b32 v6, v236
    v_mfma_f32_32x32x16_bf16 v[40:55], v[128:131], v[168:171], v[40:55]
    ds_read_b64_tr_b16 v[128:129], v5 offset:7232
    ds_read_b64_tr_b16 v[130:131], v5 offset:9024
    v_permlane32_swap_b32 v6, v236
    v_add_f32 v6, v6, v236
    v_mul_f32 v6, 0xbb124925, v6
    v_cvt_pk_bf16_f32 v156, v6, v6
    s_waitcnt lgkmcnt(10)
    v_mfma_f32_32x32x16_bf16 v[56:71], v[132:135], v[168:171], v[56:71]
    ds_read_b64_tr_b16 v[132:133], v5 offset:7264
    ds_read_b64_tr_b16 v[134:135], v5 offset:9056
    buffer_load_dwordx4 v[228:231], v2, s[20:23], s38 offen offset:0 sc1
    v_and_b32 v3, 0xffff0000, v156
    v_sub_f32 v3, v6, v3
    v_cvt_pk_bf16_f32 v157, v3, 0
    v_mov_b32 v158, v156
    v_mfma_f32_32x32x16_bf16 v[72:87], v[136:139], v[168:171], v[72:87]
    ds_read_b64_tr_b16 v[136:137], v5 offset:7296
    ds_read_b64_tr_b16 v[138:139], v5 offset:9088
    v_mov_b32 v159, v157
    s_waitcnt lgkmcnt(10)
    v_mfma_f32_32x32x16_bf16 v[88:103], v[140:143], v[168:171], v[88:103]
    ds_read_b64_tr_b16 v[140:141], v5 offset:7328
    ds_read_b64_tr_b16 v[142:143], v5 offset:9120
    buffer_load_dwordx4 v[232:235], v2, s[20:23], s38 offen offset:1024 sc1
    v_mfma_f32_32x32x16_bf16 v[104:119], v[144:147], v[168:171], v[104:119]
    ds_read_b64_tr_b16 v[144:145], v0 offset:7936
    ds_read_b64_tr_b16 v[146:147], v0 offset:9728
    s_waitcnt vmcnt(17) lgkmcnt(12)
    v_mfma_f32_32x32x16_bf16 v[8:23], v[120:123], v[172:175], v[8:23]
    ds_read_b64_tr_b16 v[120:121], v5 offset:10752
    ds_read_b64_tr_b16 v[122:123], v5 offset:12544
    s_waitcnt lgkmcnt(10)
    v_mfma_f32_32x32x16_bf16 v[24:39], v[124:127], v[172:175], v[24:39]
    ds_read_b64_tr_b16 v[124:125], v5 offset:10784
    ds_read_b64_tr_b16 v[126:127], v5 offset:12576
    buffer_load_dwordx4 v[236:239], v2, s[20:23], s38 offen offset:2048 sc1
    v_mfma_f32_32x32x16_bf16 v[40:55], v[128:131], v[172:175], v[40:55]
    ds_read_b64_tr_b16 v[128:129], v5 offset:10816
    ds_read_b64_tr_b16 v[130:131], v5 offset:12608
    s_waitcnt lgkmcnt(10)
    v_mfma_f32_32x32x16_bf16 v[56:71], v[132:135], v[172:175], v[56:71]
    ds_read_b64_tr_b16 v[132:133], v5 offset:10848
    ds_read_b64_tr_b16 v[134:135], v5 offset:12640
    buffer_load_dwordx4 v[240:243], v2, s[20:23], s38 offen offset:3072 sc1
    s_add_u32 s38, s38, 4096
    v_mfma_f32_32x32x16_bf16 v[72:87], v[136:139], v[172:175], v[72:87]
    ds_read_b64_tr_b16 v[136:137], v5 offset:10880
    ds_read_b64_tr_b16 v[138:139], v5 offset:12672
    s_waitcnt lgkmcnt(10)
    v_mfma_f32_32x32x16_bf16 v[88:103], v[140:143], v[172:175], v[88:103]
    ds_read_b64_tr_b16 v[140:141], v5 offset:10912
    ds_read_b64_tr_b16 v[142:143], v5 offset:12704
    buffer_load_dwordx4 v[244:247], v2, s[20:23], s38 offen offset:0 sc1
    v_mfma_f32_32x32x16_bf16 v[104:119], v[144:147], v[172:175], v[104:119]
    ds_read_b64_tr_b16 v[144:145], v0 offset:11520
    ds_read_b64_tr_b16 v[146:147], v0 offset:13312
    s_waitcnt vmcnt(19) lgkmcnt(12)
    v_mfma_f32_32x32x16_bf16 v[8:23], v[120:123], v[176:179], v[8:23]
    v_add_u32 v5, 28832, v5
    v_add_u32 v0, 28832, v0
    s_waitcnt lgkmcnt(8)
    v_mfma_f32_32x32x16_bf16 v[24:39], v[124:127], v[176:179], v[24:39]
    buffer_load_dwordx4 v[248:251], v2, s[20:23], s38 offen offset:1024 sc1
    v_mfma_f32_32x32x16_bf16 v[40:55], v[128:131], v[176:179], v[40:55]
    s_waitcnt lgkmcnt(0)
    s_barrier
    ds_read_b64_tr_b16 v[120:121], v5 offset:0
    ds_read_b64_tr_b16 v[122:123], v5 offset:1792
    ds_read_b64_tr_b16 v[124:125], v5 offset:32
    ds_read_b64_tr_b16 v[126:127], v5 offset:1824
    v_mfma_f32_32x32x16_bf16 v[56:71], v[132:135], v[176:179], v[56:71]
    ds_read_b64_tr_b16 v[128:129], v5 offset:64
    ds_read_b64_tr_b16 v[130:131], v5 offset:1856
    ds_read_b64_tr_b16 v[132:133], v5 offset:96
    ds_read_b64_tr_b16 v[134:135], v5 offset:1888
    buffer_load_dwordx4 v[252:255], v2, s[20:23], s38 offen offset:2048 sc1
    v_mfma_f32_32x32x16_bf16 v[72:87], v[136:139], v[176:179], v[72:87]
    ds_read_b64_tr_b16 v[136:137], v5 offset:128
    ds_read_b64_tr_b16 v[138:139], v5 offset:1920
    v_mfma_f32_32x32x16_bf16 v[88:103], v[140:143], v[176:179], v[88:103]
    ds_read_b64_tr_b16 v[140:141], v5 offset:160
    ds_read_b64_tr_b16 v[142:143], v5 offset:1952
    buffer_load_dwordx4 v[148:151], v2, s[20:23], s38 offen offset:3072 sc1
    s_add_u32 s38, s38, 4096
    v_mfma_f32_32x32x16_bf16 v[104:119], v[144:147], v[176:179], v[104:119]
    ds_read_b64_tr_b16 v[144:145], v0 offset:768
    ds_read_b64_tr_b16 v[146:147], v0 offset:2560
    s_waitcnt vmcnt(20) lgkmcnt(12)
    v_mfma_f32_32x32x16_bf16 v[8:23], v[120:123], v[180:183], v[8:23]
    ds_read_b64_tr_b16 v[120:121], v5 offset:3584
    ds_read_b64_tr_b16 v[122:123], v5 offset:5376
    s_waitcnt lgkmcnt(10)
    v_mfma_f32_32x32x16_bf16 v[24:39], v[124:127], v[180:183], v[24:39]
    ds_read_b64_tr_b16 v[124:125], v5 offset:3616
    ds_read_b64_tr_b16 v[126:127], v5 offset:5408
    v_mfma_f32_32x32x16_bf16 v[40:55], v[128:131], v[180:183], v[40:55]
    ds_read_b64_tr_b16 v[128:129], v5 offset:3648
    ds_read_b64_tr_b16 v[130:131], v5 offset:5440
    s_waitcnt lgkmcnt(10)
    v_mfma_f32_32x32x16_bf16 v[56:71], v[132:135], v[180:183], v[56:71]
    ds_read_b64_tr_b16 v[132:133], v5 offset:3680
    ds_read_b64_tr_b16 v[134:135], v5 offset:5472
    v_mfma_f32_32x32x16_bf16 v[72:87], v[136:139], v[180:183], v[72:87]
    ds_read_b64_tr_b16 v[136:137], v5 offset:3712
    ds_read_b64_tr_b16 v[138:139], v5 offset:5504
    s_waitcnt lgkmcnt(10)
    v_mfma_f32_32x32x16_bf16 v[88:103], v[140:143], v[180:183], v[88:103]
    ds_read_b64_tr_b16 v[140:141], v5 offset:3744
    ds_read_b64_tr_b16 v[142:143], v5 offset:5536
    v_mfma_f32_32x32x16_bf16 v[104:119], v[144:147], v[180:183], v[104:119]
    ds_read_b64_tr_b16 v[144:145], v0 offset:4352
    ds_read_b64_tr_b16 v[146:147], v0 offset:6144
    s_waitcnt vmcnt(18) lgkmcnt(12)
    v_mfma_f32_32x32x16_bf16 v[8:23], v[120:123], v[184:187], v[8:23]
    ds_read_b64_tr_b16 v[120:121], v5 offset:7168
    ds_read_b64_tr_b16 v[122:123], v5 offset:8960
    s_waitcnt lgkmcnt(10)
    v_mfma_f32_32x32x16_bf16 v[24:39], v[124:127], v[184:187], v[24:39]
    ds_read_b64_tr_b16 v[124:125], v5 offset:7200
    ds_read_b64_tr_b16 v[126:127], v5 offset:8992
    v_mfma_f32_32x32x16_bf16 v[40:55], v[128:131], v[184:187], v[40:55]
    ds_read_b64_tr_b16 v[128:129], v5 offset:7232
    ds_read_b64_tr_b16 v[130:131], v5 offset:9024
    s_waitcnt lgkmcnt(10)
    v_mfma_f32_32x32x16_bf16 v[56:71], v[132:135], v[184:187], v[56:71]
    ds_read_b64_tr_b16 v[132:133], v5 offset:7264
    ds_read_b64_tr_b16 v[134:135], v5 offset:9056
    v_mfma_f32_32x32x16_bf16 v[72:87], v[136:139], v[184:187], v[72:87]
    ds_read_b64_tr_b16 v[136:137], v5 offset:7296
    ds_read_b64_tr_b16 v[138:139], v5 offset:9088
    s_waitcnt lgkmcnt(10)
    v_mfma_f32_32x32x16_bf16 v[88:103], v[140:143], v[184:187], v[88:103]
    ds_read_b64_tr_b16 v[140:141], v5 offset:7328
    ds_read_b64_tr_b16 v[142:143], v5 offset:9120
    v_mfma_f32_32x32x16_bf16 v[104:119], v[144:147], v[184:187], v[104:119]
    ds_read_b64_tr_b16 v[144:145], v0 offset:7936
    ds_read_b64_tr_b16 v[146:147], v0 offset:9728
    s_waitcnt vmcnt(17) lgkmcnt(12)
    v_mfma_f32_32x32x16_bf16 v[8:23], v[120:123], v[188:191], v[8:23]
    ds_read_b64_tr_b16 v[120:121], v5 offset:10752
    ds_read_b64_tr_b16 v[122:123], v5 offset:12544
    s_waitcnt lgkmcnt(10)
    v_mfma_f32_32x32x16_bf16 v[24:39], v[124:127], v[188:191], v[24:39]
    ds_read_b64_tr_b16 v[124:125], v5 offset:10784
    ds_read_b64_tr_b16 v[126:127], v5 offset:12576
    v_mfma_f32_32x32x16_bf16 v[40:55], v[128:131], v[188:191], v[40:55]
    ds_read_b64_tr_b16 v[128:129], v5 offset:10816
    ds_read_b64_tr_b16 v[130:131], v5 offset:12608
    s_waitcnt lgkmcnt(10)
    v_mfma_f32_32x32x16_bf16 v[56:71], v[132:135], v[188:191], v[56:71]
    ds_read_b64_tr_b16 v[132:133], v5 offset:10848
    ds_read_b64_tr_b16 v[134:135], v5 offset:12640
    v_mfma_f32_32x32x16_bf16 v[72:87], v[136:139], v[188:191], v[72:87]
    ds_read_b64_tr_b16 v[136:137], v5 offset:10880
    ds_read_b64_tr_b16 v[138:139], v5 offset:12672
    s_waitcnt lgkmcnt(10)
    v_mfma_f32_32x32x16_bf16 v[88:103], v[140:143], v[188:191], v[88:103]
    ds_read_b64_tr_b16 v[140:141], v5 offset:10912
    ds_read_b64_tr_b16 v[142:143], v5 offset:12704
    v_mfma_f32_32x32x16_bf16 v[104:119], v[144:147], v[188:191], v[104:119]
    ds_read_b64_tr_b16 v[144:145], v0 offset:11520
    ds_read_b64_tr_b16 v[146:147], v0 offset:13312
    s_waitcnt vmcnt(16) lgkmcnt(12)
    v_mfma_f32_32x32x16_bf16 v[8:23], v[120:123], v[192:195], v[8:23]
    v_add_u32 v5, 28832, v5
    v_add_u32 v0, 28832, v0
    s_waitcnt lgkmcnt(8)
    v_mfma_f32_32x32x16_bf16 v[24:39], v[124:127], v[192:195], v[24:39]
    v_mfma_f32_32x32x16_bf16 v[40:55], v[128:131], v[192:195], v[40:55]
    s_waitcnt lgkmcnt(0)
    s_barrier
    ds_read_b64_tr_b16 v[120:121], v5 offset:0
    ds_read_b64_tr_b16 v[122:123], v5 offset:1792
    ds_read_b64_tr_b16 v[124:125], v5 offset:32
    ds_read_b64_tr_b16 v[126:127], v5 offset:1824
    v_mfma_f32_32x32x16_bf16 v[56:71], v[132:135], v[192:195], v[56:71]
    ds_read_b64_tr_b16 v[128:129], v5 offset:64
    ds_read_b64_tr_b16 v[130:131], v5 offset:1856
    ds_read_b64_tr_b16 v[132:133], v5 offset:96
    ds_read_b64_tr_b16 v[134:135], v5 offset:1888
    v_mfma_f32_32x32x16_bf16 v[72:87], v[136:139], v[192:195], v[72:87]
    ds_read_b64_tr_b16 v[136:137], v5 offset:128
    ds_read_b64_tr_b16 v[138:139], v5 offset:1920
    v_mfma_f32_32x32x16_bf16 v[88:103], v[140:143], v[192:195], v[88:103]
    ds_read_b64_tr_b16 v[140:141], v5 offset:160
    ds_read_b64_tr_b16 v[142:143], v5 offset:1952
    v_mfma_f32_32x32x16_bf16 v[104:119], v[144:147], v[192:195], v[104:119]
    ds_read_b64_tr_b16 v[144:145], v0 offset:768
    ds_read_b64_tr_b16 v[146:147], v0 offset:2560
    s_waitcnt vmcnt(15) lgkmcnt(12)
    v_mfma_f32_32x32x16_bf16 v[8:23], v[120:123], v[196:199], v[8:23]
    ds_read_b64_tr_b16 v[120:121], v5 offset:3584
    ds_read_b64_tr_b16 v[122:123], v5 offset:5376
    s_waitcnt lgkmcnt(10)
    v_mfma_f32_32x32x16_bf16 v[24:39], v[124:127], v[196:199], v[24:39]
    ds_read_b64_tr_b16 v[124:125], v5 offset:3616
    ds_read_b64_tr_b16 v[126:127], v5 offset:5408
    v_mfma_f32_32x32x16_bf16 v[40:55], v[128:131], v[196:199], v[40:55]
    ds_read_b64_tr_b16 v[128:129], v5 offset:3648
    ds_read_b64_tr_b16 v[130:131], v5 offset:5440
    s_waitcnt lgkmcnt(10)
    v_mfma_f32_32x32x16_bf16 v[56:71], v[132:135], v[196:199], v[56:71]
    ds_read_b64_tr_b16 v[132:133], v5 offset:3680
    ds_read_b64_tr_b16 v[134:135], v5 offset:5472
    v_mfma_f32_32x32x16_bf16 v[72:87], v[136:139], v[196:199], v[72:87]
    ds_read_b64_tr_b16 v[136:137], v5 offset:3712
    ds_read_b64_tr_b16 v[138:139], v5 offset:5504
    s_waitcnt lgkmcnt(10)
    v_mfma_f32_32x32x16_bf16 v[88:103], v[140:143], v[196:199], v[88:103]
    ds_read_b64_tr_b16 v[140:141], v5 offset:3744
    ds_read_b64_tr_b16 v[142:143], v5 offset:5536
    v_mfma_f32_32x32x16_bf16 v[104:119], v[144:147], v[196:199], v[104:119]
    ds_read_b64_tr_b16 v[144:145], v0 offset:4352
    ds_read_b64_tr_b16 v[146:147], v0 offset:6144
    s_waitcnt vmcnt(14) lgkmcnt(12)
    v_mfma_f32_32x32x16_bf16 v[8:23], v[120:123], v[200:203], v[8:23]
    ds_read_b64_tr_b16 v[120:121], v5 offset:7168
    ds_read_b64_tr_b16 v[122:123], v5 offset:8960
    s_waitcnt lgkmcnt(10)
    v_mfma_f32_32x32x16_bf16 v[24:39], v[124:127], v[200:203], v[24:39]
    ds_read_b64_tr_b16 v[124:125], v5 offset:7200
    ds_read_b64_tr_b16 v[126:127], v5 offset:8992
    v_mfma_f32_32x32x16_bf16 v[40:55], v[128:131], v[200:203], v[40:55]
    ds_read_b64_tr_b16 v[128:129], v5 offset:7232
    ds_read_b64_tr_b16 v[130:131], v5 offset:9024
    s_waitcnt lgkmcnt(10)
    v_mfma_f32_32x32x16_bf16 v[56:71], v[132:135], v[200:203], v[56:71]
    ds_read_b64_tr_b16 v[132:133], v5 offset:7264
    ds_read_b64_tr_b16 v[134:135], v5 offset:9056
    v_mfma_f32_32x32x16_bf16 v[72:87], v[136:139], v[200:203], v[72:87]
    ds_read_b64_tr_b16 v[136:137], v5 offset:7296
    ds_read_b64_tr_b16 v[138:139], v5 offset:9088
    s_waitcnt lgkmcnt(10)
    v_mfma_f32_32x32x16_bf16 v[88:103], v[140:143], v[200:203], v[88:103]
    ds_read_b64_tr_b16 v[140:141], v5 offset:7328
    ds_read_b64_tr_b16 v[142:143], v5 offset:9120
    v_mfma_f32_32x32x16_bf16 v[104:119], v[144:147], v[200:203], v[104:119]
    ds_read_b64_tr_b16 v[144:145], v0 offset:7936
    ds_read_b64_tr_b16 v[146:147], v0 offset:9728
    s_waitcnt vmcnt(13) lgkmcnt(12)
    v_mfma_f32_32x32x16_bf16 v[8:23], v[120:123], v[204:207], v[8:23]
    ds_read_b64_tr_b16 v[120:121], v5 offset:10752
    ds_read_b64_tr_b16 v[122:123], v5 offset:12544
    s_waitcnt lgkmcnt(10)
    v_mfma_f32_32x32x16_bf16 v[24:39], v[124:127], v[204:207], v[24:39]
    ds_read_b64_tr_b16 v[124:125], v5 offset:10784
    ds_read_b64_tr_b16 v[126:127], v5 offset:12576
    v_mfma_f32_32x32x16_bf16 v[40:55], v[128:131], v[204:207], v[40:55]
    ds_read_b64_tr_b16 v[128:129], v5 offset:10816
    ds_read_b64_tr_b16 v[130:131], v5 offset:12608
    s_waitcnt lgkmcnt(10)
    v_mfma_f32_32x32x16_bf16 v[56:71], v[132:135], v[204:207], v[56:71]
    ds_read_b64_tr_b16 v[132:133], v5 offset:10848
    ds_read_b64_tr_b16 v[134:135], v5 offset:12640
    v_mfma_f32_32x32x16_bf16 v[72:87], v[136:139], v[204:207], v[72:87]
    ds_read_b64_tr_b16 v[136:137], v5 offset:10880
    ds_read_b64_tr_b16 v[138:139], v5 offset:12672
    s_waitcnt lgkmcnt(10)
    v_mfma_f32_32x32x16_bf16 v[88:103], v[140:143], v[204:207], v[88:103]
    ds_read_b64_tr_b16 v[140:141], v5 offset:10912
    ds_read_b64_tr_b16 v[142:143], v5 offset:12704
    v_mfma_f32_32x32x16_bf16 v[104:119], v[144:147], v[204:207], v[104:119]
    ds_read_b64_tr_b16 v[144:145], v0 offset:11520
    ds_read_b64_tr_b16 v[146:147], v0 offset:13312
    s_waitcnt vmcnt(12) lgkmcnt(12)
    v_mfma_f32_32x32x16_bf16 v[8:23], v[120:123], v[208:211], v[8:23]
    v_add_u32 v5, 28832, v5
    v_add_u32 v0, 28832, v0
    s_waitcnt lgkmcnt(8)
    v_mfma_f32_32x32x16_bf16 v[24:39], v[124:127], v[208:211], v[24:39]
    v_mfma_f32_32x32x16_bf16 v[40:55], v[128:131], v[208:211], v[40:55]
    s_waitcnt lgkmcnt(0)
    s_barrier
    ds_read_b64_tr_b16 v[120:121], v5 offset:0
    ds_read_b64_tr_b16 v[122:123], v5 offset:1792
    ds_read_b64_tr_b16 v[124:125], v5 offset:32
    ds_read_b64_tr_b16 v[126:127], v5 offset:1824
    v_mfma_f32_32x32x16_bf16 v[56:71], v[132:135], v[208:211], v[56:71]
    ds_read_b64_tr_b16 v[128:129], v5 offset:64
    ds_read_b64_tr_b16 v[130:131], v5 offset:1856
    ds_read_b64_tr_b16 v[132:133], v5 offset:96
    ds_read_b64_tr_b16 v[134:135], v5 offset:1888
    v_mfma_f32_32x32x16_bf16 v[72:87], v[136:139], v[208:211], v[72:87]
    ds_read_b64_tr_b16 v[136:137], v5 offset:128
    ds_read_b64_tr_b16 v[138:139], v5 offset:1920
    v_mfma_f32_32x32x16_bf16 v[88:103], v[140:143], v[208:211], v[88:103]
    ds_read_b64_tr_b16 v[140:141], v5 offset:160
    ds_read_b64_tr_b16 v[142:143], v5 offset:1952
    v_mfma_f32_32x32x16_bf16 v[104:119], v[144:147], v[208:211], v[104:119]
    ds_read_b64_tr_b16 v[144:145], v0 offset:768
    ds_read_b64_tr_b16 v[146:147], v0 offset:2560
    s_waitcnt vmcnt(11) lgkmcnt(12)
    v_mfma_f32_32x32x16_bf16 v[8:23], v[120:123], v[212:215], v[8:23]
    ds_read_b64_tr_b16 v[120:121], v5 offset:3584
    ds_read_b64_tr_b16 v[122:123], v5 offset:5376
    s_waitcnt lgkmcnt(10)
    v_mfma_f32_32x32x16_bf16 v[24:39], v[124:127], v[212:215], v[24:39]
    ds_read_b64_tr_b16 v[124:125], v5 offset:3616
    ds_read_b64_tr_b16 v[126:127], v5 offset:5408
    v_mfma_f32_32x32x16_bf16 v[40:55], v[128:131], v[212:215], v[40:55]
    ds_read_b64_tr_b16 v[128:129], v5 offset:3648
    ds_read_b64_tr_b16 v[130:131], v5 offset:5440
    s_waitcnt lgkmcnt(10)
    v_mfma_f32_32x32x16_bf16 v[56:71], v[132:135], v[212:215], v[56:71]
    ds_read_b64_tr_b16 v[132:133], v5 offset:3680
    ds_read_b64_tr_b16 v[134:135], v5 offset:5472
    v_mfma_f32_32x32x16_bf16 v[72:87], v[136:139], v[212:215], v[72:87]
    ds_read_b64_tr_b16 v[136:137], v5 offset:3712
    ds_read_b64_tr_b16 v[138:139], v5 offset:5504
    s_waitcnt lgkmcnt(10)
    v_mfma_f32_32x32x16_bf16 v[88:103], v[140:143], v[212:215], v[88:103]
    ds_read_b64_tr_b16 v[140:141], v5 offset:3744
    ds_read_b64_tr_b16 v[142:143], v5 offset:5536
    v_mfma_f32_32x32x16_bf16 v[104:119], v[144:147], v[212:215], v[104:119]
    ds_read_b64_tr_b16 v[144:145], v0 offset:4352
    ds_read_b64_tr_b16 v[146:147], v0 offset:6144
    s_waitcnt vmcnt(10) lgkmcnt(12)
    v_mfma_f32_32x32x16_bf16 v[8:23], v[120:123], v[216:219], v[8:23]
    ds_read_b64_tr_b16 v[120:121], v5 offset:7168
    ds_read_b64_tr_b16 v[122:123], v5 offset:8960
    s_waitcnt lgkmcnt(10)
    v_mfma_f32_32x32x16_bf16 v[24:39], v[124:127], v[216:219], v[24:39]
    ds_read_b64_tr_b16 v[124:125], v5 offset:7200
    ds_read_b64_tr_b16 v[126:127], v5 offset:8992
    v_mfma_f32_32x32x16_bf16 v[40:55], v[128:131], v[216:219], v[40:55]
    ds_read_b64_tr_b16 v[128:129], v5 offset:7232
    ds_read_b64_tr_b16 v[130:131], v5 offset:9024
    s_waitcnt lgkmcnt(10)
    v_mfma_f32_32x32x16_bf16 v[56:71], v[132:135], v[216:219], v[56:71]
    ds_read_b64_tr_b16 v[132:133], v5 offset:7264
    ds_read_b64_tr_b16 v[134:135], v5 offset:9056
    v_mfma_f32_32x32x16_bf16 v[72:87], v[136:139], v[216:219], v[72:87]
    ds_read_b64_tr_b16 v[136:137], v5 offset:7296
    ds_read_b64_tr_b16 v[138:139], v5 offset:9088
    s_waitcnt lgkmcnt(10)
    v_mfma_f32_32x32x16_bf16 v[88:103], v[140:143], v[216:219], v[88:103]
    ds_read_b64_tr_b16 v[140:141], v5 offset:7328
    ds_read_b64_tr_b16 v[142:143], v5 offset:9120
    v_mfma_f32_32x32x16_bf16 v[104:119], v[144:147], v[216:219], v[104:119]
    ds_read_b64_tr_b16 v[144:145], v0 offset:7936
    ds_read_b64_tr_b16 v[146:147], v0 offset:9728
    s_waitcnt vmcnt(9) lgkmcnt(12)
    v_mfma_f32_32x32x16_bf16 v[8:23], v[120:123], v[220:223], v[8:23]
    ds_read_b64_tr_b16 v[120:121], v5 offset:10752
    ds_read_b64_tr_b16 v[122:123], v5 offset:12544
    s_waitcnt lgkmcnt(10)
    v_mfma_f32_32x32x16_bf16 v[24:39], v[124:127], v[220:223], v[24:39]
    ds_read_b64_tr_b16 v[124:125], v5 offset:10784
    ds_read_b64_tr_b16 v[126:127], v5 offset:12576
    v_mfma_f32_32x32x16_bf16 v[40:55], v[128:131], v[220:223], v[40:55]
    ds_read_b64_tr_b16 v[128:129], v5 offset:10816
    ds_read_b64_tr_b16 v[130:131], v5 offset:12608
    s_waitcnt lgkmcnt(10)
    v_mfma_f32_32x32x16_bf16 v[56:71], v[132:135], v[220:223], v[56:71]
    ds_read_b64_tr_b16 v[132:133], v5 offset:10848
    ds_read_b64_tr_b16 v[134:135], v5 offset:12640
    v_mfma_f32_32x32x16_bf16 v[72:87], v[136:139], v[220:223], v[72:87]
    ds_read_b64_tr_b16 v[136:137], v5 offset:10880
    ds_read_b64_tr_b16 v[138:139], v5 offset:12672
    s_waitcnt lgkmcnt(10)
    v_mfma_f32_32x32x16_bf16 v[88:103], v[140:143], v[220:223], v[88:103]
    ds_read_b64_tr_b16 v[140:141], v5 offset:10912
    ds_read_b64_tr_b16 v[142:143], v5 offset:12704
    v_mfma_f32_32x32x16_bf16 v[104:119], v[144:147], v[220:223], v[104:119]
    ds_read_b64_tr_b16 v[144:145], v0 offset:11520
    ds_read_b64_tr_b16 v[146:147], v0 offset:13312
    s_waitcnt vmcnt(8) lgkmcnt(12)
    v_mfma_f32_32x32x16_bf16 v[8:23], v[120:123], v[224:227], v[8:23]
    v_add_u32 v5, 4294851968, v5
    v_add_u32 v0, 4294851968, v0
    s_waitcnt lgkmcnt(8)
    v_mfma_f32_32x32x16_bf16 v[24:39], v[124:127], v[224:227], v[24:39]
    v_mfma_f32_32x32x16_bf16 v[40:55], v[128:131], v[224:227], v[40:55]
    s_waitcnt lgkmcnt(0)
    s_barrier
    ds_read_b64_tr_b16 v[120:121], v5 offset:0
    ds_read_b64_tr_b16 v[122:123], v5 offset:1792
    ds_read_b64_tr_b16 v[124:125], v5 offset:32
    ds_read_b64_tr_b16 v[126:127], v5 offset:1824
    v_mfma_f32_32x32x16_bf16 v[56:71], v[132:135], v[224:227], v[56:71]
    ds_read_b64_tr_b16 v[128:129], v5 offset:64
    ds_read_b64_tr_b16 v[130:131], v5 offset:1856
    ds_read_b64_tr_b16 v[132:133], v5 offset:96
    ds_read_b64_tr_b16 v[134:135], v5 offset:1888
    v_mfma_f32_32x32x16_bf16 v[72:87], v[136:139], v[224:227], v[72:87]
    ds_read_b64_tr_b16 v[136:137], v5 offset:128
    ds_read_b64_tr_b16 v[138:139], v5 offset:1920
    v_mfma_f32_32x32x16_bf16 v[88:103], v[140:143], v[224:227], v[88:103]
    ds_read_b64_tr_b16 v[140:141], v5 offset:160
    ds_read_b64_tr_b16 v[142:143], v5 offset:1952
    v_mfma_f32_32x32x16_bf16 v[104:119], v[144:147], v[224:227], v[104:119]
    ds_read_b64_tr_b16 v[144:145], v0 offset:768
    ds_read_b64_tr_b16 v[146:147], v0 offset:2560
    s_waitcnt vmcnt(7) lgkmcnt(12)
    v_mfma_f32_32x32x16_bf16 v[8:23], v[120:123], v[228:231], v[8:23]
    ds_read_b64_tr_b16 v[120:121], v5 offset:3584
    ds_read_b64_tr_b16 v[122:123], v5 offset:5376
    s_waitcnt lgkmcnt(10)
    v_mfma_f32_32x32x16_bf16 v[24:39], v[124:127], v[228:231], v[24:39]
    ds_read_b64_tr_b16 v[124:125], v5 offset:3616
    ds_read_b64_tr_b16 v[126:127], v5 offset:5408
    v_mfma_f32_32x32x16_bf16 v[40:55], v[128:131], v[228:231], v[40:55]
    ds_read_b64_tr_b16 v[128:129], v5 offset:3648
    ds_read_b64_tr_b16 v[130:131], v5 offset:5440
    s_waitcnt lgkmcnt(10)
    v_mfma_f32_32x32x16_bf16 v[56:71], v[132:135], v[228:231], v[56:71]
    ds_read_b64_tr_b16 v[132:133], v5 offset:3680
    ds_read_b64_tr_b16 v[134:135], v5 offset:5472
    v_mfma_f32_32x32x16_bf16 v[72:87], v[136:139], v[228:231], v[72:87]
    ds_read_b64_tr_b16 v[136:137], v5 offset:3712
    ds_read_b64_tr_b16 v[138:139], v5 offset:5504
    s_waitcnt lgkmcnt(10)
    v_mfma_f32_32x32x16_bf16 v[88:103], v[140:143], v[228:231], v[88:103]
    ds_read_b64_tr_b16 v[140:141], v5 offset:3744
    ds_read_b64_tr_b16 v[142:143], v5 offset:5536
    v_mfma_f32_32x32x16_bf16 v[104:119], v[144:147], v[228:231], v[104:119]
    ds_read_b64_tr_b16 v[144:145], v0 offset:4352
    ds_read_b64_tr_b16 v[146:147], v0 offset:6144
    s_waitcnt vmcnt(6) lgkmcnt(12)
    v_mfma_f32_32x32x16_bf16 v[8:23], v[120:123], v[232:235], v[8:23]
    ds_read_b64_tr_b16 v[120:121], v5 offset:7168
    ds_read_b64_tr_b16 v[122:123], v5 offset:8960
    s_waitcnt lgkmcnt(10)
    v_mfma_f32_32x32x16_bf16 v[24:39], v[124:127], v[232:235], v[24:39]
    ds_read_b64_tr_b16 v[124:125], v5 offset:7200
    ds_read_b64_tr_b16 v[126:127], v5 offset:8992
    v_mfma_f32_32x32x16_bf16 v[40:55], v[128:131], v[232:235], v[40:55]
    ds_read_b64_tr_b16 v[128:129], v5 offset:7232
    ds_read_b64_tr_b16 v[130:131], v5 offset:9024
    s_waitcnt lgkmcnt(10)
    v_mfma_f32_32x32x16_bf16 v[56:71], v[132:135], v[232:235], v[56:71]
    ds_read_b64_tr_b16 v[132:133], v5 offset:7264
    ds_read_b64_tr_b16 v[134:135], v5 offset:9056
    v_mfma_f32_32x32x16_bf16 v[72:87], v[136:139], v[232:235], v[72:87]
    ds_read_b64_tr_b16 v[136:137], v5 offset:7296
    ds_read_b64_tr_b16 v[138:139], v5 offset:9088
    s_waitcnt lgkmcnt(10)
    v_mfma_f32_32x32x16_bf16 v[88:103], v[140:143], v[232:235], v[88:103]
    ds_read_b64_tr_b16 v[140:141], v5 offset:7328
    ds_read_b64_tr_b16 v[142:143], v5 offset:9120
    v_mfma_f32_32x32x16_bf16 v[104:119], v[144:147], v[232:235], v[104:119]
    ds_read_b64_tr_b16 v[144:145], v0 offset:7936
    ds_read_b64_tr_b16 v[146:147], v0 offset:9728
    s_waitcnt vmcnt(5) lgkmcnt(12)
    v_mfma_f32_32x32x16_bf16 v[8:23], v[120:123], v[236:239], v[8:23]
    ds_read_b64_tr_b16 v[120:121], v5 offset:10752
    ds_read_b64_tr_b16 v[122:123], v5 offset:12544
    s_waitcnt lgkmcnt(10)
    v_mfma_f32_32x32x16_bf16 v[24:39], v[124:127], v[236:239], v[24:39]
    ds_read_b64_tr_b16 v[124:125], v5 offset:10784
    ds_read_b64_tr_b16 v[126:127], v5 offset:12576
    v_mfma_f32_32x32x16_bf16 v[40:55], v[128:131], v[236:239], v[40:55]
    ds_read_b64_tr_b16 v[128:129], v5 offset:10816
    ds_read_b64_tr_b16 v[130:131], v5 offset:12608
    s_waitcnt lgkmcnt(10)
    v_mfma_f32_32x32x16_bf16 v[56:71], v[132:135], v[236:239], v[56:71]
    ds_read_b64_tr_b16 v[132:133], v5 offset:10848
    ds_read_b64_tr_b16 v[134:135], v5 offset:12640
    v_mfma_f32_32x32x16_bf16 v[72:87], v[136:139], v[236:239], v[72:87]
    ds_read_b64_tr_b16 v[136:137], v5 offset:10880
    ds_read_b64_tr_b16 v[138:139], v5 offset:12672
    s_waitcnt lgkmcnt(10)
    v_mfma_f32_32x32x16_bf16 v[88:103], v[140:143], v[236:239], v[88:103]
    ds_read_b64_tr_b16 v[140:141], v5 offset:10912
    ds_read_b64_tr_b16 v[142:143], v5 offset:12704
    v_mfma_f32_32x32x16_bf16 v[104:119], v[144:147], v[236:239], v[104:119]
    ds_read_b64_tr_b16 v[144:145], v0 offset:11520
    ds_read_b64_tr_b16 v[146:147], v0 offset:13312
    s_waitcnt vmcnt(4) lgkmcnt(12)
    v_mfma_f32_32x32x16_bf16 v[8:23], v[120:123], v[240:243], v[8:23]
    v_add_u32 v5, 28832, v5
    v_add_u32 v0, 28832, v0
    s_waitcnt lgkmcnt(8)
    v_mfma_f32_32x32x16_bf16 v[24:39], v[124:127], v[240:243], v[24:39]
    v_mfma_f32_32x32x16_bf16 v[40:55], v[128:131], v[240:243], v[40:55]
    s_waitcnt lgkmcnt(0)
    s_barrier
    ds_read_b64_tr_b16 v[172:173], v5 offset:0
    ds_read_b64_tr_b16 v[174:175], v5 offset:1792
    ds_read_b64_tr_b16 v[176:177], v5 offset:3584
    ds_read_b64_tr_b16 v[178:179], v5 offset:5376
    v_mfma_f32_32x32x16_bf16 v[56:71], v[132:135], v[240:243], v[56:71]
    ds_read_b64_tr_b16 v[180:181], v5 offset:7168
    ds_read_b64_tr_b16 v[182:183], v5 offset:8960
    ds_read_b64_tr_b16 v[184:185], v5 offset:10752
    ds_read_b64_tr_b16 v[186:187], v5 offset:12544
    v_mfma_f32_32x32x16_bf16 v[72:87], v[136:139], v[240:243], v[72:87]
    ds_read_b128 v[188:191], v4 offset:0
    v_mfma_f32_32x32x16_bf16 v[88:103], v[140:143], v[240:243], v[88:103]
    v_mfma_f32_32x32x16_bf16 v[104:119], v[144:147], v[240:243], v[104:119]
    s_and_b32 s31, s30, 1
    s_mul_i32 s33, s29, 458752
    s_mul_i32 s34, s35, 114688
    s_add_u32 s33, s33, s34
    s_mul_i32 s34, s30, 7168
    s_add_u32 s33, s33, s34
    s_mul_i32 s34, s31, 1024
    s_add_u32 s33, s33, s34
    s_add_u32 s33, s33, 10485760
    s_mul_i32 s31, s31, 7168
    s_sub_u32 s39, s33, s31
    s_add_u32 s39, s39, 4096
    s_waitcnt vmcnt(0) lgkmcnt(0)
    v_mfma_f32_32x32x16_bf16 v[8:23], v[172:175], v[244:247], v[8:23]
    ds_read_b64_tr_b16 v[192:193], v5 offset:32
    ds_read_b64_tr_b16 v[194:195], v5 offset:1824
    ds_read_b64_tr_b16 v[196:197], v5 offset:3616
    v_mfma_f32_32x32x16_bf16 v[8:23], v[176:179], v[248:251], v[8:23]
    ds_read_b64_tr_b16 v[198:199], v5 offset:5408
    ds_read_b64_tr_b16 v[200:201], v5 offset:7200
    ds_read_b64_tr_b16 v[202:203], v5 offset:8992
    v_mfma_f32_32x32x16_bf16 v[8:23], v[180:183], v[252:255], v[8:23]
    ds_read_b64_tr_b16 v[204:205], v5 offset:10784
    ds_read_b64_tr_b16 v[206:207], v5 offset:12576
    ds_read_b128 v[208:211], v4 offset:1024
    v_mfma_f32_32x32x16_bf16 v[8:23], v[184:187], v[148:151], v[8:23]
    v_mfma_f32_32x32x16_bf16 v[8:23], v[188:191], v[156:159], v[8:23]
    s_waitcnt lgkmcnt(0)
    v_mfma_f32_32x32x16_bf16 v[24:39], v[192:195], v[244:247], v[24:39]
    ds_read_b64_tr_b16 v[212:213], v5 offset:64
    ds_read_b64_tr_b16 v[214:215], v5 offset:1856
    ds_read_b64_tr_b16 v[216:217], v5 offset:3648
    v_mfma_f32_32x32x16_bf16 v[24:39], v[196:199], v[248:251], v[24:39]
    ds_read_b64_tr_b16 v[218:219], v5 offset:5440
    ds_read_b64_tr_b16 v[220:221], v5 offset:7232
    ds_read_b64_tr_b16 v[222:223], v5 offset:9024
    v_mfma_f32_32x32x16_bf16 v[24:39], v[200:203], v[252:255], v[24:39]
    ds_read_b64_tr_b16 v[224:225], v5 offset:10816
    ds_read_b64_tr_b16 v[226:227], v5 offset:12608
    ds_read_b128 v[228:231], v4 offset:2048
    v_mfma_f32_32x32x16_bf16 v[24:39], v[204:207], v[148:151], v[24:39]
    v_mfma_f32_32x32x16_bf16 v[24:39], v[208:211], v[156:159], v[24:39]
    s_waitcnt lgkmcnt(0)
    v_mfma_f32_32x32x16_bf16 v[40:55], v[212:215], v[244:247], v[40:55]
    ds_read_b64_tr_b16 v[172:173], v5 offset:96
    ds_read_b64_tr_b16 v[174:175], v5 offset:1888
    ds_read_b64_tr_b16 v[176:177], v5 offset:3680
    v_max_f32 v8, 0, v8
    v_max_f32 v9, 0, v9
    v_max_f32 v10, 0, v10
    v_mfma_f32_32x32x16_bf16 v[40:55], v[216:219], v[248:251], v[40:55]
    ds_read_b64_tr_b16 v[178:179], v5 offset:5472
    ds_read_b64_tr_b16 v[180:181], v5 offset:7264
    ds_read_b64_tr_b16 v[182:183], v5 offset:9056
    v_max_f32 v11, 0, v11
    v_max_f32 v12, 0, v12
    v_max_f32 v13, 0, v13
    v_mfma_f32_32x32x16_bf16 v[40:55], v[220:223], v[252:255], v[40:55]
    ds_read_b64_tr_b16 v[184:185], v5 offset:10848
    ds_read_b64_tr_b16 v[186:187], v5 offset:12640
    ds_read_b128 v[188:191], v4 offset:3072
    v_max_f32 v14, 0, v14
    v_max_f32 v15, 0, v15
    v_mul_f32 v8, v8, v16
    v_mfma_f32_32x32x16_bf16 v[40:55], v[224:227], v[148:151], v[40:55]
    v_mul_f32 v9, v9, v17
    v_mul_f32 v10, v10, v18
    v_mul_f32 v11, v11, v19
    v_mul_f32 v12, v12, v20
    v_mul_f32 v13, v13, v21
    v_mfma_f32_32x32x16_bf16 v[40:55], v[228:231], v[156:159], v[40:55]
    v_mul_f32 v14, v14, v22
    v_mul_f32 v15, v15, v23
    v_cvt_pk_bf16_f32 v16, v8, v9
    v_cvt_pk_bf16_f32 v17, v10, v11
    v_cvt_pk_bf16_f32 v18, v12, v13
    v_cvt_pk_bf16_f32 v19, v14, v15
    s_waitcnt lgkmcnt(0)
    v_mfma_f32_32x32x16_bf16 v[56:71], v[172:175], v[244:247], v[56:71]
    ds_read_b64_tr_b16 v[192:193], v5 offset:128
    ds_read_b64_tr_b16 v[194:195], v5 offset:1920
    ds_read_b64_tr_b16 v[196:197], v5 offset:3712
    v_max_f32 v24, 0, v24
    v_max_f32 v25, 0, v25
    v_max_f32 v26, 0, v26
    v_mfma_f32_32x32x16_bf16 v[56:71], v[176:179], v[248:251], v[56:71]
    ds_read_b64_tr_b16 v[198:199], v5 offset:5504
    ds_read_b64_tr_b16 v[200:201], v5 offset:7296
    ds_read_b64_tr_b16 v[202:203], v5 offset:9088
    v_max_f32 v27, 0, v27
    v_max_f32 v28, 0, v28
    v_max_f32 v29, 0, v29
    v_mfma_f32_32x32x16_bf16 v[56:71], v[180:183], v[252:255], v[56:71]
    ds_read_b64_tr_b16 v[204:205], v5 offset:10880
    ds_read_b64_tr_b16 v[206:207], v5 offset:12672
    ds_read_b128 v[208:211], v4 offset:4096
    v_max_f32 v30, 0, v30
    v_max_f32 v31, 0, v31
    v_mul_f32 v24, v24, v32
    v_mfma_f32_32x32x16_bf16 v[56:71], v[184:187], v[148:151], v[56:71]
    buffer_store_dwordx4 v[16:19], v2, s[20:23], s33 offen offset:0 sc1
    v_mul_f32 v25, v25, v33
    v_mul_f32 v26, v26, v34
    v_mul_f32 v27, v27, v35
    v_mul_f32 v28, v28, v36
    v_mul_f32 v29, v29, v37
    v_mfma_f32_32x32x16_bf16 v[56:71], v[188:191], v[156:159], v[56:71]
    v_mul_f32 v30, v30, v38
    v_mul_f32 v31, v31, v39
    v_cvt_pk_bf16_f32 v32, v24, v25
    v_cvt_pk_bf16_f32 v33, v26, v27
    v_cvt_pk_bf16_f32 v34, v28, v29
    v_cvt_pk_bf16_f32 v35, v30, v31
    s_waitcnt lgkmcnt(0)
    v_mfma_f32_32x32x16_bf16 v[72:87], v[192:195], v[244:247], v[72:87]
    ds_read_b64_tr_b16 v[212:213], v5 offset:160
    ds_read_b64_tr_b16 v[214:215], v5 offset:1952
    ds_read_b64_tr_b16 v[216:217], v5 offset:3744
    v_max_f32 v40, 0, v40
    v_max_f32 v41, 0, v41
    v_max_f32 v42, 0, v42
    v_mfma_f32_32x32x16_bf16 v[72:87], v[196:199], v[248:251], v[72:87]
    ds_read_b64_tr_b16 v[218:219], v5 offset:5536
    ds_read_b64_tr_b16 v[220:221], v5 offset:7328
    ds_read_b64_tr_b16 v[222:223], v5 offset:9120
    v_max_f32 v43, 0, v43
    v_max_f32 v44, 0, v44
    v_max_f32 v45, 0, v45
    v_mfma_f32_32x32x16_bf16 v[72:87], v[200:203], v[252:255], v[72:87]
    ds_read_b64_tr_b16 v[224:225], v5 offset:10912
    ds_read_b64_tr_b16 v[226:227], v5 offset:12704
    ds_read_b128 v[228:231], v4 offset:5120
    v_max_f32 v46, 0, v46
    v_max_f32 v47, 0, v47
    v_mul_f32 v40, v40, v48
    v_mfma_f32_32x32x16_bf16 v[72:87], v[204:207], v[148:151], v[72:87]
    buffer_store_dwordx4 v[32:35], v2, s[20:23], s33 offen offset:1024 sc1
    v_mul_f32 v41, v41, v49
    v_mul_f32 v42, v42, v50
    v_mul_f32 v43, v43, v51
    v_mul_f32 v44, v44, v52
    v_mul_f32 v45, v45, v53
    v_mfma_f32_32x32x16_bf16 v[72:87], v[208:211], v[156:159], v[72:87]
    v_mul_f32 v46, v46, v54
    v_mul_f32 v47, v47, v55
    v_cvt_pk_bf16_f32 v48, v40, v41
    v_cvt_pk_bf16_f32 v49, v42, v43
    v_cvt_pk_bf16_f32 v50, v44, v45
    v_cvt_pk_bf16_f32 v51, v46, v47
    s_waitcnt lgkmcnt(0)
    v_mfma_f32_32x32x16_bf16 v[88:103], v[212:215], v[244:247], v[88:103]
    ds_read_b64_tr_b16 v[172:173], v0 offset:768
    ds_read_b64_tr_b16 v[174:175], v0 offset:2560
    ds_read_b64_tr_b16 v[176:177], v0 offset:4352
    v_max_f32 v56, 0, v56
    v_max_f32 v57, 0, v57
    v_max_f32 v58, 0, v58
    v_mfma_f32_32x32x16_bf16 v[88:103], v[216:219], v[248:251], v[88:103]
    ds_read_b64_tr_b16 v[178:179], v0 offset:6144
    ds_read_b64_tr_b16 v[180:181], v0 offset:7936
    ds_read_b64_tr_b16 v[182:183], v0 offset:9728
    v_max_f32 v59, 0, v59
    v_max_f32 v60, 0, v60
    v_max_f32 v61, 0, v61
    v_mfma_f32_32x32x16_bf16 v[88:103], v[220:223], v[252:255], v[88:103]
    ds_read_b64_tr_b16 v[184:185], v0 offset:11520
    ds_read_b64_tr_b16 v[186:187], v0 offset:13312
    ds_read_b128 v[188:191], v4 offset:6144
    v_max_f32 v62, 0, v62
    v_max_f32 v63, 0, v63
    v_mul_f32 v56, v56, v64
    v_mfma_f32_32x32x16_bf16 v[88:103], v[224:227], v[148:151], v[88:103]
    buffer_store_dwordx4 v[48:51], v2, s[20:23], s33 offen offset:2048 sc1
    v_mul_f32 v57, v57, v65
    v_mul_f32 v58, v58, v66
    v_mul_f32 v59, v59, v67
    v_mul_f32 v60, v60, v68
    v_mul_f32 v61, v61, v69
    v_mfma_f32_32x32x16_bf16 v[88:103], v[228:231], v[156:159], v[88:103]
    v_mul_f32 v62, v62, v70
    v_mul_f32 v63, v63, v71
    v_cvt_pk_bf16_f32 v64, v56, v57
    v_cvt_pk_bf16_f32 v65, v58, v59
    v_cvt_pk_bf16_f32 v66, v60, v61
    v_cvt_pk_bf16_f32 v67, v62, v63
    s_waitcnt lgkmcnt(0)
    v_mfma_f32_32x32x16_bf16 v[104:119], v[172:175], v[244:247], v[104:119]
    v_max_f32 v72, 0, v72
    v_max_f32 v73, 0, v73
    v_max_f32 v74, 0, v74
    v_mfma_f32_32x32x16_bf16 v[104:119], v[176:179], v[248:251], v[104:119]
    v_max_f32 v75, 0, v75
    v_max_f32 v76, 0, v76
    v_max_f32 v77, 0, v77
    v_mfma_f32_32x32x16_bf16 v[104:119], v[180:183], v[252:255], v[104:119]
    v_max_f32 v78, 0, v78
    v_max_f32 v79, 0, v79
    v_mul_f32 v72, v72, v80
    v_mfma_f32_32x32x16_bf16 v[104:119], v[184:187], v[148:151], v[104:119]
    buffer_store_dwordx4 v[64:67], v2, s[20:23], s33 offen offset:3072 sc1
    v_mul_f32 v73, v73, v81
    v_mul_f32 v74, v74, v82
    v_mul_f32 v75, v75, v83
    v_mul_f32 v76, v76, v84
    v_mul_f32 v77, v77, v85
    v_mfma_f32_32x32x16_bf16 v[104:119], v[188:191], v[156:159], v[104:119]
    v_mul_f32 v78, v78, v86
    v_mul_f32 v79, v79, v87
    v_cvt_pk_bf16_f32 v80, v72, v73
    v_cvt_pk_bf16_f32 v81, v74, v75
    v_cvt_pk_bf16_f32 v82, v76, v77
    v_cvt_pk_bf16_f32 v83, v78, v79
    s_add_u32 s33, s33, 4096
    buffer_store_dwordx4 v[80:83], v2, s[20:23], s33 offen offset:0 sc1
    v_max_f32 v88, 0, v88
    v_max_f32 v89, 0, v89
    v_max_f32 v90, 0, v90
    v_max_f32 v91, 0, v91
    v_max_f32 v92, 0, v92
    v_max_f32 v93, 0, v93
    v_max_f32 v94, 0, v94
    v_max_f32 v95, 0, v95
    v_mul_f32 v88, v88, v96
    v_mul_f32 v89, v89, v97
    v_mul_f32 v90, v90, v98
    v_mul_f32 v91, v91, v99
    v_mul_f32 v92, v92, v100
    v_mul_f32 v93, v93, v101
    v_mul_f32 v94, v94, v102
    v_mul_f32 v95, v95, v103
    v_cvt_pk_bf16_f32 v96, v88, v89
    v_cvt_pk_bf16_f32 v97, v90, v91
    v_cvt_pk_bf16_f32 v98, v92, v93
    v_cvt_pk_bf16_f32 v99, v94, v95
    buffer_store_dwordx4 v[96:99], v2, s[20:23], s33 offen offset:1024 sc1
    v_max_f32 v104, 0, v104
    v_max_f32 v105, 0, v105
    v_max_f32 v106, 0, v106
    v_max_f32 v107, 0, v107
    v_max_f32 v108, 0, v108
    v_max_f32 v109, 0, v109
    v_max_f32 v110, 0, v110
    v_max_f32 v111, 0, v111
    v_mul_f32 v104, v104, v112
    v_mul_f32 v105, v105, v113
    v_mul_f32 v106, v106, v114
    v_mul_f32 v107, v107, v115
    v_mul_f32 v108, v108, v116
    v_mul_f32 v109, v109, v117
    v_mul_f32 v110, v110, v118
    v_mul_f32 v111, v111, v119
    v_cvt_pk_bf16_f32 v112, v104, v105
    v_cvt_pk_bf16_f32 v113, v106, v107
    v_cvt_pk_bf16_f32 v114, v108, v109
    v_cvt_pk_bf16_f32 v115, v110, v111
    buffer_store_dwordx4 v[112:115], v2, s[20:23], s39 offen offset:2048 sc1
    s_barrier
    s_mul_i32 s32, s29, 512
    s_mul_i32 s34, s35, 128
    s_add_u32 s32, s32, s34
    s_mul_i32 s34, s30, 4
    s_add_u32 s32, s32, s34
    s_add_u32 s32, s32, 18919424
    v_mov_b32 v3, s24
    s_waitcnt vmcnt(0)
    s_mov_b64 exec, 1
    s_cmp_lg_u32 s25, 0
    s_cbranch_scc1 L_k_sl_55
    buffer_store_dword v3, off, s[20:23], s32
    s_branch L_k_sj_56
L_k_sl_55:

    s_waitcnt vmcnt(0)
    buffer_store_dword v3, off, s[20:23], s32 sc1
L_k_sj_56:
    s_mov_b64 exec, -1
    s_endpgm
L_k_Bfb_50:
    s_waitcnt lgkmcnt(0)
    s_barrier
    s_mov_b32 s38, 1
    s_mov_b32 s37, 16
    s_mul_i32 s36, s29, 262144
    s_mul_i32 s34, s35, 65536
    s_add_u32 s36, s36, s34
    s_add_u32 s36, s36, 2097152
    v_mov_b32 v220, 0xff800000
    v_mov_b32 v221, 0xff800000
    v_mov_b32 v222, 0xff800000
    v_mov_b32 v223, 0xff800000
L_k_Bfl_57:
    buffer_load_dwordx4 v[124:127], v2, s[20:23], s36 offen offset:0 sc1
    buffer_load_dwordx4 v[128:131], v2, s[20:23], s36 offen offset:1024 sc1
    s_add_u32 s36, s36, 4096
    s_waitcnt vmcnt(0)
    v_mfma_f32_32x32x16_bf16 v[40:55], v[124:127], v[8:11], 0
    v_mfma_f32_32x32x16_bf16 v[40:55], v[128:131], v[12:15], v[40:55]
    s_nop 7
    s_nop 7
    v_max3_f32 v220, v220, v40, v41
    v_max3_f32 v220, v220, v42, v43
    v_max3_f32 v220, v220, v44, v45
    v_max3_f32 v220, v220, v46, v47
    v_max3_f32 v220, v220, v48, v49
    v_max3_f32 v220, v220, v50, v51
    v_max3_f32 v220, v220, v52, v53
    v_max3_f32 v220, v220, v54, v55
    v_mfma_f32_32x32x16_bf16 v[56:71], v[124:127], v[16:19], 0
    v_mfma_f32_32x32x16_bf16 v[56:71], v[128:131], v[20:23], v[56:71]
    s_nop 7
    s_nop 7
    v_max3_f32 v221, v221, v56, v57
    v_max3_f32 v221, v221, v58, v59
    v_max3_f32 v221, v221, v60, v61
    v_max3_f32 v221, v221, v62, v63
    v_max3_f32 v221, v221, v64, v65
    v_max3_f32 v221, v221, v66, v67
    v_max3_f32 v221, v221, v68, v69
    v_max3_f32 v221, v221, v70, v71
    v_mfma_f32_32x32x16_bf16 v[40:55], v[124:127], v[24:27], 0
    v_mfma_f32_32x32x16_bf16 v[40:55], v[128:131], v[28:31], v[40:55]
    s_nop 7
    s_nop 7
    v_max3_f32 v222, v222, v40, v41
    v_max3_f32 v222, v222, v42, v43
    v_max3_f32 v222, v222, v44, v45
    v_max3_f32 v222, v222, v46, v47
    v_max3_f32 v222, v222, v48, v49
    v_max3_f32 v222, v222, v50, v51
    v_max3_f32 v222, v222, v52, v53
    v_max3_f32 v222, v222, v54, v55
    v_mfma_f32_32x32x16_bf16 v[56:71], v[124:127], v[32:35], 0
    v_mfma_f32_32x32x16_bf16 v[56:71], v[128:131], v[36:39], v[56:71]
    s_nop 7
    s_nop 7
    v_max3_f32 v223, v223, v56, v57
    v_max3_f32 v223, v223, v58, v59
    v_max3_f32 v223, v223, v60, v61
    v_max3_f32 v223, v223, v62, v63
    v_max3_f32 v223, v223, v64, v65
    v_max3_f32 v223, v223, v66, v67
    v_max3_f32 v223, v223, v68, v69
    v_max3_f32 v223, v223, v70, v71
    s_sub_u32 s37, s37, 1
    s_cmp_lg_u32 s37, 0
    s_cbranch_scc1 L_k_Bfl_57
    v_mov_b32 v224, v220
    s_nop 1
    v_permlane32_swap_b32 v220, v224
    s_nop 1
    v_max_f32 v220, v220, v224
    v_xor_b32 v40, 1536, v6
    v_add_u32 v40, 152064, v40
    ds_write_b32 v40, v220
    v_and_b32 v40, -16, v40
    v_mov_b32 v224, v221
    s_nop 1
    v_permlane32_swap_b32 v221, v224
    s_nop 1
    v_max_f32 v221, v221, v224
    v_xor_b32 v41, 1024, v6
    v_add_u32 v41, 152064, v41
    ds_write_b32 v41, v221
    v_and_b32 v41, -16, v41
    v_mov_b32 v224, v222
    s_nop 1
    v_permlane32_swap_b32 v222, v224
    s_nop 1
    v_max_f32 v222, v222, v224
    v_xor_b32 v42, 512, v6
    v_add_u32 v42, 152064, v42
    ds_write_b32 v42, v222
    v_and_b32 v42, -16, v42
    v_mov_b32 v224, v223
    s_nop 1
    v_permlane32_swap_b32 v223, v224
    s_nop 1
    v_max_f32 v223, v223, v224
    v_xor_b32 v43, 0, v6
    v_add_u32 v43, 152064, v43
    ds_write_b32 v43, v223
    v_and_b32 v43, -16, v43
    s_waitcnt lgkmcnt(0)
    s_barrier
    ds_read_b128 v[56:59], v40
    ds_read_b128 v[60:63], v41
    ds_read_b128 v[64:67], v42
    ds_read_b128 v[68:71], v43
    v_cmp_lt_u32 vcc, 31, v1
    s_waitcnt lgkmcnt(0)
    s_barrier
    v_max3_f32 v56, v56, v57, v58
    v_max_f32 v56, v56, v59
    v_sub_f32 v56, 0, v56
    v_and_b32 v48, 0xffff0000, v56
    v_sub_f32 v56, v56, v48
    v_and_b32 v49, 0xffff0000, v56
    v_sub_f32 v56, v56, v49
    v_lshrrev_b32 v50, 16, v56
    v_lshrrev_b32 v48, 16, v48
    v_or_b32 v48, v48, v49
    v_cndmask_b32 v14, v14, v48, vcc
    v_cndmask_b32 v15, v15, v50, vcc
    v_max3_f32 v60, v60, v61, v62
    v_max_f32 v60, v60, v63
    v_sub_f32 v60, 0, v60
    v_and_b32 v48, 0xffff0000, v60
    v_sub_f32 v60, v60, v48
    v_and_b32 v49, 0xffff0000, v60
    v_sub_f32 v60, v60, v49
    v_lshrrev_b32 v50, 16, v60
    v_lshrrev_b32 v48, 16, v48
    v_or_b32 v48, v48, v49
    v_cndmask_b32 v22, v22, v48, vcc
    v_cndmask_b32 v23, v23, v50, vcc
    v_max3_f32 v64, v64, v65, v66
    v_max_f32 v64, v64, v67
    v_sub_f32 v64, 0, v64
    v_and_b32 v48, 0xffff0000, v64
    v_sub_f32 v64, v64, v48
    v_and_b32 v49, 0xffff0000, v64
    v_sub_f32 v64, v64, v49
    v_lshrrev_b32 v50, 16, v64
    v_lshrrev_b32 v48, 16, v48
    v_or_b32 v48, v48, v49
    v_cndmask_b32 v30, v30, v48, vcc
    v_cndmask_b32 v31, v31, v50, vcc
    v_max3_f32 v68, v68, v69, v70
    v_max_f32 v68, v68, v71
    v_sub_f32 v68, 0, v68
    v_and_b32 v48, 0xffff0000, v68
    v_sub_f32 v68, v68, v48
    v_and_b32 v49, 0xffff0000, v68
    v_sub_f32 v68, v68, v49
    v_lshrrev_b32 v50, 16, v68
    v_lshrrev_b32 v48, 16, v48
    v_or_b32 v48, v48, v49
    v_cndmask_b32 v38, v38, v48, vcc
    v_cndmask_b32 v39, v39, v50, vcc
    s_barrier
    ds_read_b128 v[124:127], v5 offset:0
    ds_read_b128 v[128:131], v5 offset:1024
    ds_read_b128 v[132:135], v5 offset:2048
    ds_read_b128 v[136:139], v5 offset:3072
    v_mov_b32 v80, 0
    v_mov_b32 v81, 0
    v_mov_b32 v82, 0
    v_mov_b32 v83, 0
    v_mov_b32 v84, 0
    v_mov_b32 v85, 0
    v_mov_b32 v86, 0
    v_mov_b32 v87, 0
    v_mov_b32 v96, 0
    v_mov_b32 v97, 0
    v_mov_b32 v98, 0
    v_mov_b32 v99, 0
    v_mov_b32 v100, 0
    v_mov_b32 v101, 0
    v_mov_b32 v102, 0
    v_mov_b32 v103, 0
    v_mov_b32 v140, 0
    v_mov_b32 v141, 0
    v_mov_b32 v142, 0
    v_mov_b32 v143, 0
    v_mov_b32 v144, 0
    v_mov_b32 v145, 0
    v_mov_b32 v146, 0
    v_mov_b32 v147, 0
    v_mov_b32 v148, 0
    v_mov_b32 v149, 0
    v_mov_b32 v150, 0
    v_mov_b32 v151, 0
    v_mov_b32 v152, 0
    v_mov_b32 v153, 0
    v_mov_b32 v154, 0
    v_mov_b32 v155, 0
    v_mov_b32 v156, 0
    v_mov_b32 v157, 0
    v_mov_b32 v158, 0
    v_mov_b32 v159, 0
    v_mov_b32 v160, 0
    v_mov_b32 v161, 0
    v_mov_b32 v162, 0
    v_mov_b32 v163, 0
    v_mov_b32 v164, 0
    v_mov_b32 v165, 0
    v_mov_b32 v166, 0
    v_mov_b32 v167, 0
    v_mov_b32 v168, 0
    v_mov_b32 v169, 0
    v_mov_b32 v170, 0
    v_mov_b32 v171, 0
    v_mov_b32 v172, 0
    v_mov_b32 v173, 0
    v_mov_b32 v174, 0
    v_mov_b32 v175, 0
    v_mov_b32 v176, 0
    v_mov_b32 v177, 0
    v_mov_b32 v178, 0
    v_mov_b32 v179, 0
    v_mov_b32 v180, 0
    v_mov_b32 v181, 0
    v_mov_b32 v182, 0
    v_mov_b32 v183, 0
    v_mov_b32 v184, 0
    v_mov_b32 v185, 0
    v_mov_b32 v186, 0
    v_mov_b32 v187, 0
    v_mov_b32 v188, 0
    v_mov_b32 v189, 0
    v_mov_b32 v190, 0
    v_mov_b32 v191, 0
    v_mov_b32 v192, 0
    v_mov_b32 v193, 0
    v_mov_b32 v194, 0
    v_mov_b32 v195, 0
    v_mov_b32 v196, 0
    v_mov_b32 v197, 0
    v_mov_b32 v198, 0
    v_mov_b32 v199, 0
    v_mov_b32 v200, 0
    v_mov_b32 v201, 0
    v_mov_b32 v202, 0
    v_mov_b32 v203, 0
    s_branch L_k_Bmain_48
L_k_Hfb_31:
    s_mov_b32 s39, 0
    s_barrier
    s_barrier
    s_barrier
L_k_Hfl_58:
    s_and_b32 s32, s39, 3
    s_lshl_b32 s32, s32, 12
    s_add_u32 m0, s7, s32
    s_lshl_b32 s31, s39, 14
    s_add_u32 s31, s31, s6
    buffer_load_dwordx4 v2, s[20:23], s31 offen offset:0 sc1 lds
    buffer_load_dwordx4 v2, s[20:23], s31 offen offset:1024 sc1 lds
    buffer_load_dwordx4 v2, s[20:23], s31 offen offset:2048 sc1 lds
    buffer_load_dwordx4 v2, s[20:23], s31 offen offset:3072 sc1 lds
    s_add_u32 s39, s39, 1
    s_cmp_lt_u32 s39, 16
    s_waitcnt vmcnt(0)
    s_barrier
    s_cbranch_scc1 L_k_Hfl_58
    s_branch L_k_Hre_29
L_k_end:
.section .rodata,"a"
.p2align 6
.amdhsa_kernel sequential_preLN__mha_block__glu_gated_reglu__prompt_kernel
  .amdhsa_next_free_vgpr 256
  .amdhsa_next_free_sgpr 102
  .amdhsa_accum_offset 256
  .amdhsa_group_segment_fixed_size 0
  .amdhsa_kernarg_size 80
  .amdhsa_user_sgpr_count 2
  .amdhsa_user_sgpr_kernarg_segment_ptr 1
  .amdhsa_system_sgpr_workgroup_id_x 1
  .amdhsa_float_denorm_mode_32 3
.end_amdhsa_kernel
```
